```python
import torch

def _softmax(x, axis=-1):
    return torch.softmax(x, dim=axis)
def _gelu(x):
    return torch.nn.functional.gelu(x, approximate="tanh")
def _silu(x):
    return torch.nn.functional.silu(x)
def _sigmoid(x):
    return torch.sigmoid(x)
def _layernorm(x, axis=-1, eps=1e-5):
    m = x.mean(dim=axis, keepdim=True)
    v = x.var(dim=axis, keepdim=True, unbiased=False)
    return (x - m) / torch.sqrt(v + eps)
def _scatter_add(tgt, idx, src, axis=0):
    return tgt.clone().index_add_(axis, idx, src)
def _segment_sum(src, seg, n):
    out = torch.zeros((n,) + src.shape[1:], dtype=src.dtype)
    return out.index_add_(0, seg, src)
def _pad(x, pw):
    flat = tuple(v for pair in reversed(pw) for v in pair)
    return torch.nn.functional.pad(x, flat)

kernel_name = 'gather_scatter__molecular_angular_gemnet__graph'

def setup_inputs():

    _w = (lambda a: (lambda t: t.to(torch.bfloat16) if t.is_floating_point() else t)(torch.as_tensor(a)))
    N, deg, De, L = 50000, 16, 4, 1
    E = N * deg
    T = E * deg
    NR = 8
    dist = torch.rand(E).to(float)
    angle = (torch.rand(T) * torch.pi).to(float)
    centers = torch.linspace(0.0, 1.0, NR).to(float)
    ang_freq = torch.arange(1, L + 1).to(float)
    return {
        "m": _w((lambda *s: torch.randn(*s, dtype=torch.bfloat16) * 0.05)(E, De)),
        "idx_in": _w((lambda lo, hi, *s: torch.randint(lo, hi, s))(0, E, T).to(torch.int64)),
        "idx_out": _w((lambda lo, hi, *s: torch.randint(lo, hi, s))(0, E, T).to(torch.int64)),
        "dist": _w(dist),
        "angle": _w(angle),
        "centers": _w(centers),
        "ang_freq": _w(ang_freq),
        "w_rbf": _w((lambda *s: torch.randn(*s, dtype=torch.bfloat16) * 0.4)(NR, De)),
        "w_sbf": _w((lambda *s: torch.randn(*s, dtype=torch.bfloat16) * 0.4)(NR * L, De)),
        "w_down": _w((lambda *s: torch.randn(*s, dtype=torch.bfloat16) * 0.4)(De, De)),
        "w_up": _w((lambda *s: torch.randn(*s, dtype=torch.bfloat16) * 0.4)(De, De)),
    }

def reference(m, idx_in, idx_out, dist, angle, centers, ang_freq, w_rbf, w_sbf, w_down, w_up):
    E, De = m.shape[0], m.shape[1]
    NR = centers.shape[0]
    L = ang_freq.shape[0]
    rbf = torch.exp(-10.0 * (dist[:, None] - centers[None, :]) ** 2)
    cbf = torch.cos(ang_freq[None, :] * angle[:, None])
    rbf_t = rbf[idx_out]
    sbf = torch.reshape(rbf_t[:, :, None] * cbf[:, None, :], (-1, NR * L))
    x = (m[idx_in] @ w_down) * (sbf @ w_sbf)
    agg = _segment_sum(x, idx_out, E)
    return m + (agg @ w_up) * (rbf @ w_rbf)
```

```asm
; @launch kernel=part_in_kernel grid=(256,1,1) block=(1024,1,1) lds=82048
; @launch kernel=gather_part_kernel grid=(256,1,1) block=(1024,1,1) lds=159744
; @launch kernel=accum_out_kernel grid=(256,1,1) block=(1024,1,1) lds=131072
.amdgcn_target "amdgcn-amd-amdhsa--gfx950"
.text
.globl part_in_kernel
.p2align 8
.type part_in_kernel,@function
part_in_kernel:
    s_cmp_ge_u32 s2, 256
    s_cbranch_scc1 L_k1_end
    v_readfirstlane_b32 s42, v0
    s_lshr_b32 s43, s2, 3
    s_cmp_lg_u32 s42, 960
    s_cbranch_scc1 L_cpf_1
    s_cmp_ge_u32 s43, 7
    s_cbranch_scc1 L_cpf_1
    s_getpc_b64 s[40:41]
L_cpa_2:
    s_sub_u32 s40, s40, L_cpa_2-part_in_kernel
    s_subb_u32 s41, s41, 0
    v_and_b32 v118, 63, v0
    v_lshlrev_b32 v118, 7, v118
    s_lshl_b32 s43, s43, 13
    v_add_u32 v118, s43, v118
    v_min_u32 v118, L_text_end-part_in_kernel-4, v118
    global_load_dword v118, v118, s[40:41]
L_cpf_1:
    s_load_dwordx4 s[4:7], s[0:1], 8
    s_load_dwordx2 s[8:9], s[0:1], 32
    s_load_dwordx2 s[10:11], s[0:1], 104
    s_load_dwordx2 s[38:39], s[0:1], 0
    s_load_dwordx2 s[44:45], s[0:1], 48
    s_load_dwordx2 s[50:51], s[0:1], 96
    v_lshrrev_b32 v6, 6, v0
    v_lshlrev_b32 v1, 4, v0
    v_readfirstlane_b32 s3, v6
    v_add_u32 v2, 0x10000, v1
    v_lshlrev_b32 v3, 3, v0
    v_lshlrev_b32 v4, 2, v0
    v_lshlrev_b32 v5, 1, v0
    v_mov_b32 v94, 0
    v_mov_b32 v57, 0
    s_mov_b32 s28, 5497560
    v_mov_b32 v6, 4
    v_mul_u32_u24 v93, 16896, v0
    s_mov_b32 s32, s2
    s_add_u32 s33, s2, 256
    s_add_u32 s34, s2, 512
    s_mul_i32 s35, s2, 12288
    s_add_u32 s35, s35, 10223616
    s_mov_b32 s48, 0
    s_waitcnt lgkmcnt(0)
    s_load_dword s46, s[44:45], 0
    s_mov_b32 s12, s4
    s_and_b32 s13, s5, 0xffff
    s_mov_b32 s14, 51200000
    s_mov_b32 s15, 0x20000
    s_mov_b32 s16, s6
    s_and_b32 s17, s7, 0xffff
    s_mov_b32 s18, 51200000
    s_mov_b32 s19, 0x20000
    s_mov_b32 s20, s8
    s_and_b32 s21, s9, 0xffff
    s_mov_b32 s22, 25600000
    s_mov_b32 s23, 0x20000
    s_mov_b32 s24, s10
    s_and_b32 s25, s11, 0xffff
    s_mov_b32 s26, 268435456
    s_mov_b32 s27, 0x20000
    s_mov_b32 s40, s38
    s_and_b32 s41, s39, 0xffff
    s_mov_b32 s42, 6400000
    s_mov_b32 s43, 0x20000
    s_mul_i32 s31, s32, 26624
    s_add_u32 s31, s31, 0
    s_lshl_b32 s30, s31, 1
    buffer_load_dwordx4 v[8:11], v1, s[12:15], s30 offen nt
    buffer_load_dwordx4 v[22:25], v1, s[16:19], s30 offen nt
    buffer_load_dwordx2 v[36:37], v3, s[20:23], s31 offen nt
    s_mul_i32 s31, s32, 26624
    s_add_u32 s31, s31, 8192
    s_lshl_b32 s30, s31, 1
    buffer_load_dwordx4 v[12:15], v1, s[12:15], s30 offen nt
    buffer_load_dwordx4 v[26:29], v1, s[16:19], s30 offen nt
    buffer_load_dwordx2 v[38:39], v3, s[20:23], s31 offen nt
    s_mul_i32 s31, s32, 26624
    s_add_u32 s31, s31, 16384
    s_lshl_b32 s30, s31, 1
    buffer_load_dwordx4 v[16:19], v1, s[12:15], s30 offen nt
    buffer_load_dwordx4 v[30:33], v1, s[16:19], s30 offen nt
    buffer_load_dwordx2 v[40:41], v3, s[20:23], s31 offen nt
    s_mul_i32 s31, s32, 26624
    s_add_u32 s31, s31, 24576
    s_lshl_b32 s30, s31, 1
    buffer_load_dword v20, v4, s[12:15], s30 offen nt
    buffer_load_dword v34, v4, s[16:19], s30 offen nt
    buffer_load_ushort v42, v5, s[20:23], s31 offen nt
    s_cmp_lg_u32 s3, 0
    s_cbranch_scc1 L_k1_noinit
    v_mov_b32 v95, 0
    v_mov_b32 v96, 0
    v_mov_b32 v97, 0
    ds_write_b128 v1, v[94:97] offset:0
    ds_write_b32 v94, v94 offset:2048
    s_cmp_lg_u32 s2, 0
    s_cbranch_scc1 L_k1_noinit
    s_mov_b32 s29, 81297408
    buffer_store_dword v94, v4, s[24:27], s29 offen
L_k1_noinit:
    s_waitcnt lgkmcnt(0)
    s_lshl_b32 s46, s46, 16
    v_mov_b32 v7, s46
    s_barrier
    s_mul_i32 s31, s33, 26624
    s_add_u32 s31, s31, 0
    s_lshl_b32 s30, s31, 1
    buffer_load_dwordx4 v[44:47], v1, s[12:15], s30 offen nt
    buffer_load_dwordx4 v[58:61], v1, s[16:19], s30 offen nt
    buffer_load_dwordx2 v[72:73], v3, s[20:23], s31 offen nt
    s_mul_i32 s31, s33, 26624
    s_add_u32 s31, s31, 8192
    s_lshl_b32 s30, s31, 1
    buffer_load_dwordx4 v[48:51], v1, s[12:15], s30 offen nt
    buffer_load_dwordx4 v[62:65], v1, s[16:19], s30 offen nt
    buffer_load_dwordx2 v[74:75], v3, s[20:23], s31 offen nt
    s_mul_i32 s31, s33, 26624
    s_add_u32 s31, s31, 16384
    s_lshl_b32 s30, s31, 1
    buffer_load_dwordx4 v[52:55], v1, s[12:15], s30 offen nt
    buffer_load_dwordx4 v[66:69], v1, s[16:19], s30 offen nt
    buffer_load_dwordx2 v[76:77], v3, s[20:23], s31 offen nt
    s_mul_i32 s31, s33, 26624
    s_add_u32 s31, s31, 24576
    s_lshl_b32 s30, s31, 1
    buffer_load_dword v56, v4, s[12:15], s30 offen nt
    buffer_load_dword v70, v4, s[16:19], s30 offen nt
    buffer_load_ushort v78, v5, s[20:23], s31 offen nt
    s_waitcnt vmcnt(22)
    v_mul_hi_u32_u24 v80, s28, v8
    v_mul_hi_u32_u24 v81, s28, v9
    v_mul_hi_u32_u24 v82, s28, v10
    v_mul_hi_u32_u24 v83, s28, v11
    v_lshl_or_b32 v22, v8, 20, v22
    v_lshl_or_b32 v23, v9, 20, v23
    v_lshl_or_b32 v24, v10, 20, v24
    v_lshl_or_b32 v25, v11, 20, v25
    v_and_b32 v8, 0x3fc, v80
    v_and_b32 v9, 0x3fc, v81
    v_and_b32 v10, 0x3fc, v82
    v_and_b32 v11, 0x3fc, v83
    ds_add_rtn_u32 v80, v8, v6 offset:0
    ds_add_rtn_u32 v81, v9, v6 offset:0
    ds_add_rtn_u32 v82, v10, v6 offset:0
    ds_add_rtn_u32 v83, v11, v6 offset:0
    s_waitcnt vmcnt(21)
    v_lshlrev_b32 v114, 16, v36
    v_lshlrev_b32 v116, 16, v37
    v_and_b32 v115, 0xffff0000, v36
    v_and_b32 v117, 0xffff0000, v37
    v_mul_f32 v114, v7, v114
    v_mul_f32 v116, v7, v116
    v_mul_f32 v115, v7, v115
    v_mul_f32 v117, v7, v117
    v_cvt_pk_bf16_f32 v36, v114, v115
    v_cvt_pk_bf16_f32 v37, v116, v117
    v_lshlrev_b32 v114, 16, v36
    v_lshlrev_b32 v116, 16, v37
    v_and_b32 v115, 0xffff0000, v36
    v_and_b32 v117, 0xffff0000, v37
    v_mul_f32 v114, 0.15915494, v114
    v_mul_f32 v116, 0.15915494, v116
    v_mul_f32 v115, 0.15915494, v115
    v_mul_f32 v117, 0.15915494, v117
    v_fract_f32 v114, v114
    v_fract_f32 v116, v116
    v_fract_f32 v115, v115
    v_fract_f32 v117, v117
    v_cos_f32 v114, v114
    v_cos_f32 v116, v116
    v_cos_f32 v115, v115
    v_cos_f32 v117, v117
    s_nop 0
    v_cvt_pk_bf16_f32 v36, v114, v115
    v_cvt_pk_bf16_f32 v37, v116, v117
    v_lshlrev_b32 v114, 16, v36
    v_lshlrev_b32 v116, 16, v37
    v_and_b32 v115, 0xffff0000, v36
    v_and_b32 v117, 0xffff0000, v37
    v_cvt_pk_f16_f32 v36, v114, v115
    v_cvt_pk_f16_f32 v37, v116, v117
    s_waitcnt vmcnt(19)
    v_mul_hi_u32_u24 v84, s28, v12
    v_mul_hi_u32_u24 v85, s28, v13
    v_mul_hi_u32_u24 v86, s28, v14
    v_mul_hi_u32_u24 v87, s28, v15
    v_lshl_or_b32 v26, v12, 20, v26
    v_lshl_or_b32 v27, v13, 20, v27
    v_lshl_or_b32 v28, v14, 20, v28
    v_lshl_or_b32 v29, v15, 20, v29
    v_and_b32 v12, 0x3fc, v84
    v_and_b32 v13, 0x3fc, v85
    v_and_b32 v14, 0x3fc, v86
    v_and_b32 v15, 0x3fc, v87
    ds_add_rtn_u32 v84, v12, v6 offset:0
    ds_add_rtn_u32 v85, v13, v6 offset:0
    ds_add_rtn_u32 v86, v14, v6 offset:0
    ds_add_rtn_u32 v87, v15, v6 offset:0
    s_waitcnt vmcnt(18)
    v_lshlrev_b32 v114, 16, v38
    v_lshlrev_b32 v116, 16, v39
    v_and_b32 v115, 0xffff0000, v38
    v_and_b32 v117, 0xffff0000, v39
    v_mul_f32 v114, v7, v114
    v_mul_f32 v116, v7, v116
    v_mul_f32 v115, v7, v115
    v_mul_f32 v117, v7, v117
    v_cvt_pk_bf16_f32 v38, v114, v115
    v_cvt_pk_bf16_f32 v39, v116, v117
    v_lshlrev_b32 v114, 16, v38
    v_lshlrev_b32 v116, 16, v39
    v_and_b32 v115, 0xffff0000, v38
    v_and_b32 v117, 0xffff0000, v39
    v_mul_f32 v114, 0.15915494, v114
    v_mul_f32 v116, 0.15915494, v116
    v_mul_f32 v115, 0.15915494, v115
    v_mul_f32 v117, 0.15915494, v117
    v_fract_f32 v114, v114
    v_fract_f32 v116, v116
    v_fract_f32 v115, v115
    v_fract_f32 v117, v117
    v_cos_f32 v114, v114
    v_cos_f32 v116, v116
    v_cos_f32 v115, v115
    v_cos_f32 v117, v117
    s_nop 0
    v_cvt_pk_bf16_f32 v38, v114, v115
    v_cvt_pk_bf16_f32 v39, v116, v117
    v_lshlrev_b32 v114, 16, v38
    v_lshlrev_b32 v116, 16, v39
    v_and_b32 v115, 0xffff0000, v38
    v_and_b32 v117, 0xffff0000, v39
    v_cvt_pk_f16_f32 v38, v114, v115
    v_cvt_pk_f16_f32 v39, v116, v117
    s_waitcnt vmcnt(16)
    v_mul_hi_u32_u24 v88, s28, v16
    v_mul_hi_u32_u24 v89, s28, v17
    v_mul_hi_u32_u24 v90, s28, v18
    v_mul_hi_u32_u24 v91, s28, v19
    v_lshl_or_b32 v30, v16, 20, v30
    v_lshl_or_b32 v31, v17, 20, v31
    v_lshl_or_b32 v32, v18, 20, v32
    v_lshl_or_b32 v33, v19, 20, v33
    v_and_b32 v16, 0x3fc, v88
    v_and_b32 v17, 0x3fc, v89
    v_and_b32 v18, 0x3fc, v90
    v_and_b32 v19, 0x3fc, v91
    ds_add_rtn_u32 v88, v16, v6 offset:0
    ds_add_rtn_u32 v89, v17, v6 offset:0
    ds_add_rtn_u32 v90, v18, v6 offset:0
    ds_add_rtn_u32 v91, v19, v6 offset:0
    s_waitcnt vmcnt(15)
    v_lshlrev_b32 v114, 16, v40
    v_lshlrev_b32 v116, 16, v41
    v_and_b32 v115, 0xffff0000, v40
    v_and_b32 v117, 0xffff0000, v41
    v_mul_f32 v114, v7, v114
    v_mul_f32 v116, v7, v116
    v_mul_f32 v115, v7, v115
    v_mul_f32 v117, v7, v117
    v_cvt_pk_bf16_f32 v40, v114, v115
    v_cvt_pk_bf16_f32 v41, v116, v117
    v_lshlrev_b32 v114, 16, v40
    v_lshlrev_b32 v116, 16, v41
    v_and_b32 v115, 0xffff0000, v40
    v_and_b32 v117, 0xffff0000, v41
    v_mul_f32 v114, 0.15915494, v114
    v_mul_f32 v116, 0.15915494, v116
    v_mul_f32 v115, 0.15915494, v115
    v_mul_f32 v117, 0.15915494, v117
    v_fract_f32 v114, v114
    v_fract_f32 v116, v116
    v_fract_f32 v115, v115
    v_fract_f32 v117, v117
    v_cos_f32 v114, v114
    v_cos_f32 v116, v116
    v_cos_f32 v115, v115
    v_cos_f32 v117, v117
    s_nop 0
    v_cvt_pk_bf16_f32 v40, v114, v115
    v_cvt_pk_bf16_f32 v41, v116, v117
    v_lshlrev_b32 v114, 16, v40
    v_lshlrev_b32 v116, 16, v41
    v_and_b32 v115, 0xffff0000, v40
    v_and_b32 v117, 0xffff0000, v41
    v_cvt_pk_f16_f32 v40, v114, v115
    v_cvt_pk_f16_f32 v41, v116, v117
    s_waitcnt vmcnt(12)
    v_mul_hi_u32_u24 v92, s28, v20
    v_lshl_or_b32 v34, v20, 20, v34
    v_and_b32 v20, 0x3fc, v92
    ds_add_rtn_u32 v92, v20, v6 offset:0
    v_lshlrev_b32 v114, 16, v42
    v_and_b32 v115, 0xffff0000, v42
    v_mul_f32 v114, v7, v114
    v_mul_f32 v115, v7, v115
    v_cvt_pk_bf16_f32 v42, v114, v115
    v_lshlrev_b32 v114, 16, v42
    v_and_b32 v115, 0xffff0000, v42
    v_mul_f32 v114, 0.15915494, v114
    v_mul_f32 v115, 0.15915494, v115
    v_fract_f32 v114, v114
    v_fract_f32 v115, v115
    v_cos_f32 v114, v114
    v_cos_f32 v115, v115
    s_nop 0
    v_cvt_pk_bf16_f32 v42, v114, v115
    v_lshlrev_b32 v114, 16, v42
    v_and_b32 v115, 0xffff0000, v42
    v_cvt_pk_f16_f32 v42, v114, v115
    s_waitcnt lgkmcnt(0)
    s_barrier
    s_cmp_lg_u32 s3, 0
    s_cbranch_scc1 L_p_6
    ds_read_b128 v[94:97], v1 offset:0
    v_mov_b32 v98, 0
    v_mov_b32 v99, 0
    v_mov_b32 v100, 0
    v_mov_b32 v101, 0
    s_waitcnt lgkmcnt(0)
    ds_write_b128 v1, v[98:101] offset:0
    v_add_u32 v104, v94, v95
    v_add_u32 v105, v104, v96
    v_add_u32 v107, v105, v97
    v_mov_b32 v106, v107
    s_nop 1
    v_add_u32_dpp v106, v106, v106 row_shr:1 row_mask:0xf bank_mask:0xf
    s_nop 1
    v_add_u32_dpp v106, v106, v106 row_shr:2 row_mask:0xf bank_mask:0xf
    s_nop 1
    v_add_u32_dpp v106, v106, v106 row_shr:4 row_mask:0xf bank_mask:0xf
    s_nop 1
    v_add_u32_dpp v106, v106, v106 row_shr:8 row_mask:0xf bank_mask:0xf
    s_nop 1
    v_add_u32_dpp v106, v106, v106 row_bcast:15 row_mask:0xa bank_mask:0xf
    s_nop 1
    v_add_u32_dpp v106, v106, v106 row_bcast:31 row_mask:0xc bank_mask:0xf
    v_sub_u32 v102, v106, v107
    v_add_u32 v103, v102, v94
    v_add_u32 v104, v102, v104
    v_add_u32 v105, v102, v105
    ds_write_b128 v1, v[102:105] offset:1024
    s_waitcnt lgkmcnt(0)
L_p_6:
    s_barrier
    ds_read_b32 v8, v8 offset:1024
    ds_read_b32 v9, v9 offset:1024
    ds_read_b32 v10, v10 offset:1024
    ds_read_b32 v11, v11 offset:1024
    ds_read_b32 v12, v12 offset:1024
    ds_read_b32 v13, v13 offset:1024
    ds_read_b32 v14, v14 offset:1024
    ds_read_b32 v15, v15 offset:1024
    ds_read_b32 v16, v16 offset:1024
    ds_read_b32 v17, v17 offset:1024
    ds_read_b32 v18, v18 offset:1024
    ds_read_b32 v19, v19 offset:1024
    ds_read_b32 v20, v20 offset:1024
    s_cmp_lg_u32 s3, 0
    s_cbranch_scc1 L_os_8
    s_and_b32 s29, s2, 7
    s_mul_i32 s29, s29, 96
    s_lshr_b32 s36, s2, 3
    s_add_u32 s29, s29, s36
    s_lshl_b32 s29, s29, 2
    s_add_u32 s29, s29, 80216064
    v_lshl_or_b32 v94, v94, 16, v102
    v_lshl_or_b32 v95, v95, 16, v103
    v_lshl_or_b32 v96, v96, 16, v104
    v_lshl_or_b32 v97, v97, 16, v105
    buffer_store_dword v94, v93, s[24:27], s29 offen
    s_add_u32 s29, s29, 4224
    buffer_store_dword v95, v93, s[24:27], s29 offen
    s_add_u32 s29, s29, 4224
    buffer_store_dword v96, v93, s[24:27], s29 offen
    s_add_u32 s29, s29, 4224
    buffer_store_dword v97, v93, s[24:27], s29 offen
L_os_8:
    s_waitcnt lgkmcnt(0)
    v_add_u32 v80, v8, v80
    v_add_u32 v81, v9, v81
    v_add_u32 v82, v10, v82
    v_add_u32 v83, v11, v83
    ds_write_b32 v80, v22 offset:2176
    ds_write_b32 v81, v23 offset:2176
    ds_write_b32 v82, v24 offset:2176
    ds_write_b32 v83, v25 offset:2176
    v_lshrrev_b32 v8, 1, v80
    v_lshrrev_b32 v9, 1, v81
    v_lshrrev_b32 v10, 1, v82
    v_lshrrev_b32 v11, 1, v83
    ds_write_b16 v8, v36 offset:55424
    ds_write_b16_d16_hi v9, v36 offset:55424
    ds_write_b16 v10, v37 offset:55424
    ds_write_b16_d16_hi v11, v37 offset:55424
    s_mul_i32 s31, s34, 26624
    s_add_u32 s31, s31, 0
    s_lshl_b32 s30, s31, 1
    buffer_load_dwordx4 v[8:11], v1, s[12:15], s30 offen nt
    buffer_load_dwordx4 v[22:25], v1, s[16:19], s30 offen nt
    buffer_load_dwordx2 v[36:37], v3, s[20:23], s31 offen nt
    v_add_u32 v84, v12, v84
    v_add_u32 v85, v13, v85
    v_add_u32 v86, v14, v86
    v_add_u32 v87, v15, v87
    ds_write_b32 v84, v26 offset:2176
    ds_write_b32 v85, v27 offset:2176
    ds_write_b32 v86, v28 offset:2176
    ds_write_b32 v87, v29 offset:2176
    v_lshrrev_b32 v12, 1, v84
    v_lshrrev_b32 v13, 1, v85
    v_lshrrev_b32 v14, 1, v86
    v_lshrrev_b32 v15, 1, v87
    ds_write_b16 v12, v38 offset:55424
    ds_write_b16_d16_hi v13, v38 offset:55424
    ds_write_b16 v14, v39 offset:55424
    ds_write_b16_d16_hi v15, v39 offset:55424
    s_mul_i32 s31, s34, 26624
    s_add_u32 s31, s31, 8192
    s_lshl_b32 s30, s31, 1
    buffer_load_dwordx4 v[12:15], v1, s[12:15], s30 offen nt
    buffer_load_dwordx4 v[26:29], v1, s[16:19], s30 offen nt
    buffer_load_dwordx2 v[38:39], v3, s[20:23], s31 offen nt
    v_add_u32 v88, v16, v88
    v_add_u32 v89, v17, v89
    v_add_u32 v90, v18, v90
    v_add_u32 v91, v19, v91
    ds_write_b32 v88, v30 offset:2176
    ds_write_b32 v89, v31 offset:2176
    ds_write_b32 v90, v32 offset:2176
    ds_write_b32 v91, v33 offset:2176
    v_lshrrev_b32 v16, 1, v88
    v_lshrrev_b32 v17, 1, v89
    v_lshrrev_b32 v18, 1, v90
    v_lshrrev_b32 v19, 1, v91
    ds_write_b16 v16, v40 offset:55424
    ds_write_b16_d16_hi v17, v40 offset:55424
    ds_write_b16 v18, v41 offset:55424
    ds_write_b16_d16_hi v19, v41 offset:55424
    s_mul_i32 s31, s34, 26624
    s_add_u32 s31, s31, 16384
    s_lshl_b32 s30, s31, 1
    buffer_load_dwordx4 v[16:19], v1, s[12:15], s30 offen nt
    buffer_load_dwordx4 v[30:33], v1, s[16:19], s30 offen nt
    buffer_load_dwordx2 v[40:41], v3, s[20:23], s31 offen nt
    v_add_u32 v92, v20, v92
    ds_write_b32 v92, v34 offset:2176
    v_lshrrev_b32 v20, 1, v92
    ds_write_b16 v20, v42 offset:55424
    s_mul_i32 s31, s34, 26624
    s_add_u32 s31, s31, 24576
    s_lshl_b32 s30, s31, 1
    buffer_load_dword v20, v4, s[12:15], s30 offen nt
    buffer_load_dword v34, v4, s[16:19], s30 offen nt
    buffer_load_ushort v42, v5, s[20:23], s31 offen nt
L_se_7:
    s_waitcnt lgkmcnt(0)
    s_barrier
    ds_read_b128 v[94:97], v1 offset:2176
    ds_read_b128 v[98:101], v1 offset:18560
    ds_read_b128 v[102:105], v1 offset:34944
    ds_read_b128 v[106:109], v1 offset:51328
    s_cmp_ge_u32 s3, 14
    s_cbranch_scc1 L_cr_9
    ds_read_b128 v[110:113], v2 offset:2176
L_cr_9:
    s_waitcnt vmcnt(12)
    v_mul_hi_u32_u24 v80, s28, v44
    v_mul_hi_u32_u24 v81, s28, v45
    v_mul_hi_u32_u24 v82, s28, v46
    v_mul_hi_u32_u24 v83, s28, v47
    v_lshl_or_b32 v58, v44, 20, v58
    v_lshl_or_b32 v59, v45, 20, v59
    v_lshl_or_b32 v60, v46, 20, v60
    v_lshl_or_b32 v61, v47, 20, v61
    v_and_b32 v44, 0x3fc, v80
    v_and_b32 v45, 0x3fc, v81
    v_and_b32 v46, 0x3fc, v82
    v_and_b32 v47, 0x3fc, v83
    ds_add_rtn_u32 v80, v44, v6 offset:0
    ds_add_rtn_u32 v81, v45, v6 offset:0
    ds_add_rtn_u32 v82, v46, v6 offset:0
    ds_add_rtn_u32 v83, v47, v6 offset:0
    s_waitcnt lgkmcnt(4)
    s_mul_i32 s29, s32, 53248
    s_add_u32 s29, s29, 0
    buffer_store_dwordx4 v[94:97], v1, s[24:27], s29 offen sc0 sc1
    s_mul_i32 s29, s32, 53248
    s_add_u32 s29, s29, 16384
    buffer_store_dwordx4 v[98:101], v1, s[24:27], s29 offen sc0 sc1
    v_lshlrev_b32 v114, 16, v72
    v_lshlrev_b32 v116, 16, v73
    v_and_b32 v115, 0xffff0000, v72
    v_and_b32 v117, 0xffff0000, v73
    v_mul_f32 v114, v7, v114
    v_mul_f32 v116, v7, v116
    v_mul_f32 v115, v7, v115
    v_mul_f32 v117, v7, v117
    v_cvt_pk_bf16_f32 v72, v114, v115
    v_cvt_pk_bf16_f32 v73, v116, v117
    v_lshlrev_b32 v114, 16, v72
    v_lshlrev_b32 v116, 16, v73
    v_and_b32 v115, 0xffff0000, v72
    v_and_b32 v117, 0xffff0000, v73
    v_mul_f32 v114, 0.15915494, v114
    v_mul_f32 v116, 0.15915494, v116
    v_mul_f32 v115, 0.15915494, v115
    v_mul_f32 v117, 0.15915494, v117
    v_fract_f32 v114, v114
    v_fract_f32 v116, v116
    v_fract_f32 v115, v115
    v_fract_f32 v117, v117
    v_cos_f32 v114, v114
    v_cos_f32 v116, v116
    v_cos_f32 v115, v115
    v_cos_f32 v117, v117
    s_nop 0
    v_cvt_pk_bf16_f32 v72, v114, v115
    v_cvt_pk_bf16_f32 v73, v116, v117
    v_lshlrev_b32 v114, 16, v72
    v_lshlrev_b32 v116, 16, v73
    v_and_b32 v115, 0xffff0000, v72
    v_and_b32 v117, 0xffff0000, v73
    v_cvt_pk_f16_f32 v72, v114, v115
    v_cvt_pk_f16_f32 v73, v116, v117
    v_mul_hi_u32_u24 v84, s28, v48
    v_mul_hi_u32_u24 v85, s28, v49
    v_mul_hi_u32_u24 v86, s28, v50
    v_mul_hi_u32_u24 v87, s28, v51
    v_lshl_or_b32 v62, v48, 20, v62
    v_lshl_or_b32 v63, v49, 20, v63
    v_lshl_or_b32 v64, v50, 20, v64
    v_lshl_or_b32 v65, v51, 20, v65
    v_and_b32 v48, 0x3fc, v84
    v_and_b32 v49, 0x3fc, v85
    v_and_b32 v50, 0x3fc, v86
    v_and_b32 v51, 0x3fc, v87
    ds_add_rtn_u32 v84, v48, v6 offset:0
    ds_add_rtn_u32 v85, v49, v6 offset:0
    ds_add_rtn_u32 v86, v50, v6 offset:0
    ds_add_rtn_u32 v87, v51, v6 offset:0
    s_mul_i32 s29, s32, 53248
    s_add_u32 s29, s29, 32768
    buffer_store_dwordx4 v[102:105], v1, s[24:27], s29 offen sc0 sc1
    s_mul_i32 s29, s32, 53248
    s_add_u32 s29, s29, 49152
    s_mul_i32 s36, s32, 26624
    s_add_u32 s36, s36, 53473280
    s_cmp_lt_u32 s3, 4
    s_cselect_b32 s29, s29, s36
    buffer_store_dwordx4 v[106:109], v1, s[24:27], s29 offen sc0 sc1
    s_cmp_lg_u32 s3, 0
    s_cbranch_scc1 L_ci_12
    s_mov_b32 s47, 1
    s_atomic_add s47, s[50:51], 0 glc
L_ci_12:
    v_lshlrev_b32 v114, 16, v74
    v_lshlrev_b32 v116, 16, v75
    v_and_b32 v115, 0xffff0000, v74
    v_and_b32 v117, 0xffff0000, v75
    v_mul_f32 v114, v7, v114
    v_mul_f32 v116, v7, v116
    v_mul_f32 v115, v7, v115
    v_mul_f32 v117, v7, v117
    v_cvt_pk_bf16_f32 v74, v114, v115
    v_cvt_pk_bf16_f32 v75, v116, v117
    v_lshlrev_b32 v114, 16, v74
    v_lshlrev_b32 v116, 16, v75
    v_and_b32 v115, 0xffff0000, v74
    v_and_b32 v117, 0xffff0000, v75
    v_mul_f32 v114, 0.15915494, v114
    v_mul_f32 v116, 0.15915494, v116
    v_mul_f32 v115, 0.15915494, v115
    v_mul_f32 v117, 0.15915494, v117
    v_fract_f32 v114, v114
    v_fract_f32 v116, v116
    v_fract_f32 v115, v115
    v_fract_f32 v117, v117
    v_cos_f32 v114, v114
    v_cos_f32 v116, v116
    v_cos_f32 v115, v115
    v_cos_f32 v117, v117
    s_nop 0
    v_cvt_pk_bf16_f32 v74, v114, v115
    v_cvt_pk_bf16_f32 v75, v116, v117
    v_lshlrev_b32 v114, 16, v74
    v_lshlrev_b32 v116, 16, v75
    v_and_b32 v115, 0xffff0000, v74
    v_and_b32 v117, 0xffff0000, v75
    v_cvt_pk_f16_f32 v74, v114, v115
    v_cvt_pk_f16_f32 v75, v116, v117
    v_mul_hi_u32_u24 v88, s28, v52
    v_mul_hi_u32_u24 v89, s28, v53
    v_mul_hi_u32_u24 v90, s28, v54
    v_mul_hi_u32_u24 v91, s28, v55
    v_lshl_or_b32 v66, v52, 20, v66
    v_lshl_or_b32 v67, v53, 20, v67
    v_lshl_or_b32 v68, v54, 20, v68
    v_lshl_or_b32 v69, v55, 20, v69
    v_and_b32 v52, 0x3fc, v88
    v_and_b32 v53, 0x3fc, v89
    v_and_b32 v54, 0x3fc, v90
    v_and_b32 v55, 0x3fc, v91
    ds_add_rtn_u32 v88, v52, v6 offset:0
    ds_add_rtn_u32 v89, v53, v6 offset:0
    ds_add_rtn_u32 v90, v54, v6 offset:0
    ds_add_rtn_u32 v91, v55, v6 offset:0
    s_cmp_ge_u32 s3, 14
    s_cbranch_scc1 L_cs_14
    s_mul_i32 s29, s32, 26624
    s_add_u32 s29, s29, 53489664
    buffer_store_dwordx4 v[110:113], v1, s[24:27], s29 offen sc0 sc1
L_cs_14:
    v_lshlrev_b32 v114, 16, v76
    v_lshlrev_b32 v116, 16, v77
    v_and_b32 v115, 0xffff0000, v76
    v_and_b32 v117, 0xffff0000, v77
    v_mul_f32 v114, v7, v114
    v_mul_f32 v116, v7, v116
    v_mul_f32 v115, v7, v115
    v_mul_f32 v117, v7, v117
    v_cvt_pk_bf16_f32 v76, v114, v115
    v_cvt_pk_bf16_f32 v77, v116, v117
    v_lshlrev_b32 v114, 16, v76
    v_lshlrev_b32 v116, 16, v77
    v_and_b32 v115, 0xffff0000, v76
    v_and_b32 v117, 0xffff0000, v77
    v_mul_f32 v114, 0.15915494, v114
    v_mul_f32 v116, 0.15915494, v116
    v_mul_f32 v115, 0.15915494, v115
    v_mul_f32 v117, 0.15915494, v117
    v_fract_f32 v114, v114
    v_fract_f32 v116, v116
    v_fract_f32 v115, v115
    v_fract_f32 v117, v117
    v_cos_f32 v114, v114
    v_cos_f32 v116, v116
    v_cos_f32 v115, v115
    v_cos_f32 v117, v117
    s_nop 0
    v_cvt_pk_bf16_f32 v76, v114, v115
    v_cvt_pk_bf16_f32 v77, v116, v117
    v_lshlrev_b32 v114, 16, v76
    v_lshlrev_b32 v116, 16, v77
    v_and_b32 v115, 0xffff0000, v76
    v_and_b32 v117, 0xffff0000, v77
    v_cvt_pk_f16_f32 v76, v114, v115
    v_cvt_pk_f16_f32 v77, v116, v117
    v_mul_hi_u32_u24 v92, s28, v56
    v_lshl_or_b32 v70, v56, 20, v70
    v_and_b32 v56, 0x3fc, v92
    ds_add_rtn_u32 v92, v56, v6 offset:0
    v_lshlrev_b32 v114, 16, v78
    v_and_b32 v115, 0xffff0000, v78
    v_mul_f32 v114, v7, v114
    v_mul_f32 v115, v7, v115
    v_cvt_pk_bf16_f32 v78, v114, v115
    v_lshlrev_b32 v114, 16, v78
    v_and_b32 v115, 0xffff0000, v78
    v_mul_f32 v114, 0.15915494, v114
    v_mul_f32 v115, 0.15915494, v115
    v_fract_f32 v114, v114
    v_fract_f32 v115, v115
    v_cos_f32 v114, v114
    v_cos_f32 v115, v115
    s_nop 0
    v_cvt_pk_bf16_f32 v78, v114, v115
    v_lshlrev_b32 v114, 16, v78
    v_and_b32 v115, 0xffff0000, v78
    v_cvt_pk_f16_f32 v78, v114, v115
    s_waitcnt lgkmcnt(0)
    s_cmp_lg_u32 s3, 0
    s_cbranch_scc1 L_cp_15
    v_mov_b32 v21, s47
    ds_write_b32 v57, v21 offset:2052
    s_waitcnt lgkmcnt(0)
L_cp_15:
    s_barrier
    s_cmp_lg_u32 s3, 0
    s_cbranch_scc1 L_p_16
    ds_read_b128 v[94:97], v1 offset:0
    v_mov_b32 v98, 0
    v_mov_b32 v99, 0
    v_mov_b32 v100, 0
    v_mov_b32 v101, 0
    s_waitcnt lgkmcnt(0)
    ds_write_b128 v1, v[98:101] offset:0
    v_add_u32 v104, v94, v95
    v_add_u32 v105, v104, v96
    v_add_u32 v107, v105, v97
    v_mov_b32 v106, v107
    s_nop 1
    v_add_u32_dpp v106, v106, v106 row_shr:1 row_mask:0xf bank_mask:0xf
    s_nop 1
    v_add_u32_dpp v106, v106, v106 row_shr:2 row_mask:0xf bank_mask:0xf
    s_nop 1
    v_add_u32_dpp v106, v106, v106 row_shr:4 row_mask:0xf bank_mask:0xf
    s_nop 1
    v_add_u32_dpp v106, v106, v106 row_shr:8 row_mask:0xf bank_mask:0xf
    s_nop 1
    v_add_u32_dpp v106, v106, v106 row_bcast:15 row_mask:0xa bank_mask:0xf
    s_nop 1
    v_add_u32_dpp v106, v106, v106 row_bcast:31 row_mask:0xc bank_mask:0xf
    v_sub_u32 v102, v106, v107
    v_add_u32 v103, v102, v94
    v_add_u32 v104, v102, v104
    v_add_u32 v105, v102, v105
    ds_write_b128 v1, v[102:105] offset:1024
    s_waitcnt lgkmcnt(0)
L_p_16:
    s_barrier
    ds_read_b32 v21, v57 offset:2052
    ds_read_b32 v44, v44 offset:1024
    ds_read_b32 v45, v45 offset:1024
    ds_read_b32 v46, v46 offset:1024
    ds_read_b32 v47, v47 offset:1024
    ds_read_b32 v48, v48 offset:1024
    ds_read_b32 v49, v49 offset:1024
    ds_read_b32 v50, v50 offset:1024
    ds_read_b32 v51, v51 offset:1024
    ds_read_b32 v52, v52 offset:1024
    ds_read_b32 v53, v53 offset:1024
    ds_read_b32 v54, v54 offset:1024
    ds_read_b32 v55, v55 offset:1024
    ds_read_b32 v56, v56 offset:1024
    s_cmp_lg_u32 s3, 0
    s_cbranch_scc1 L_os_18
    s_and_b32 s29, s2, 7
    s_mul_i32 s29, s29, 96
    s_lshr_b32 s36, s2, 3
    s_add_u32 s29, s29, s36
    s_lshl_b32 s29, s29, 2
    s_add_u32 s29, s29, 80216192
    v_lshl_or_b32 v94, v94, 16, v102
    v_lshl_or_b32 v95, v95, 16, v103
    v_lshl_or_b32 v96, v96, 16, v104
    v_lshl_or_b32 v97, v97, 16, v105
    buffer_store_dword v94, v93, s[24:27], s29 offen
    s_add_u32 s29, s29, 4224
    buffer_store_dword v95, v93, s[24:27], s29 offen
    s_add_u32 s29, s29, 4224
    buffer_store_dword v96, v93, s[24:27], s29 offen
    s_add_u32 s29, s29, 4224
    buffer_store_dword v97, v93, s[24:27], s29 offen
L_os_18:
    s_waitcnt lgkmcnt(0)
    v_add_u32 v80, v44, v80
    v_add_u32 v81, v45, v81
    v_add_u32 v82, v46, v82
    v_add_u32 v83, v47, v83
    ds_write_b32 v80, v58 offset:2176
    ds_write_b32 v81, v59 offset:2176
    ds_write_b32 v82, v60 offset:2176
    ds_write_b32 v83, v61 offset:2176
    v_lshrrev_b32 v44, 1, v80
    v_lshrrev_b32 v45, 1, v81
    v_lshrrev_b32 v46, 1, v82
    v_lshrrev_b32 v47, 1, v83
    ds_write_b16 v44, v72 offset:55424
    ds_write_b16_d16_hi v45, v72 offset:55424
    ds_write_b16 v46, v73 offset:55424
    ds_write_b16_d16_hi v47, v73 offset:55424
    v_readfirstlane_b32 s49, v21
    s_mov_b32 s48, 1
    s_cmp_lt_u32 s49, 128
    s_addc_u32 s48, s48, 0
    s_cmp_lt_u32 s49, 245
    s_addc_u32 s48, s48, 0
    s_min_u32 s29, s49, 128
    s_min_u32 s36, s49, 245
    s_add_u32 s49, s49, s29
    s_add_u32 s49, s49, s36
    s_add_u32 s31, s49, 0
    s_cmp_gt_u32 s48, 0
    s_cselect_b32 s31, s31, 629
    s_lshl_b32 s31, s31, 13
    s_add_u32 s31, s31, 20447232
    s_lshl_b32 s30, s31, 1
    buffer_load_dwordx4 v[44:47], v1, s[12:15], s30 offen nt
    buffer_load_dwordx4 v[58:61], v1, s[16:19], s30 offen nt
    buffer_load_dwordx2 v[72:73], v3, s[20:23], s31 offen nt
    v_add_u32 v84, v48, v84
    v_add_u32 v85, v49, v85
    v_add_u32 v86, v50, v86
    v_add_u32 v87, v51, v87
    ds_write_b32 v84, v62 offset:2176
    ds_write_b32 v85, v63 offset:2176
    ds_write_b32 v86, v64 offset:2176
    ds_write_b32 v87, v65 offset:2176
    v_lshrrev_b32 v48, 1, v84
    v_lshrrev_b32 v49, 1, v85
    v_lshrrev_b32 v50, 1, v86
    v_lshrrev_b32 v51, 1, v87
    ds_write_b16 v48, v74 offset:55424
    ds_write_b16_d16_hi v49, v74 offset:55424
    ds_write_b16 v50, v75 offset:55424
    ds_write_b16_d16_hi v51, v75 offset:55424
    s_add_u32 s31, s49, 1
    s_cmp_gt_u32 s48, 1
    s_cselect_b32 s31, s31, 629
    s_lshl_b32 s31, s31, 13
    s_add_u32 s31, s31, 20447232
    s_lshl_b32 s30, s31, 1
    buffer_load_dwordx4 v[48:51], v1, s[12:15], s30 offen nt
    buffer_load_dwordx4 v[62:65], v1, s[16:19], s30 offen nt
    buffer_load_dwordx2 v[74:75], v3, s[20:23], s31 offen nt
    v_add_u32 v88, v52, v88
    v_add_u32 v89, v53, v89
    v_add_u32 v90, v54, v90
    v_add_u32 v91, v55, v91
    ds_write_b32 v88, v66 offset:2176
    ds_write_b32 v89, v67 offset:2176
    ds_write_b32 v90, v68 offset:2176
    ds_write_b32 v91, v69 offset:2176
    v_lshrrev_b32 v52, 1, v88
    v_lshrrev_b32 v53, 1, v89
    v_lshrrev_b32 v54, 1, v90
    v_lshrrev_b32 v55, 1, v91
    ds_write_b16 v52, v76 offset:55424
    ds_write_b16_d16_hi v53, v76 offset:55424
    ds_write_b16 v54, v77 offset:55424
    ds_write_b16_d16_hi v55, v77 offset:55424
    s_add_u32 s31, s49, 2
    s_cmp_gt_u32 s48, 2
    s_cselect_b32 s31, s31, 629
    s_lshl_b32 s31, s31, 13
    s_add_u32 s31, s31, 20447232
    s_lshl_b32 s30, s31, 1
    buffer_load_dwordx4 v[52:55], v1, s[12:15], s30 offen nt
    buffer_load_dwordx4 v[66:69], v1, s[16:19], s30 offen nt
    buffer_load_dwordx2 v[76:77], v3, s[20:23], s31 offen nt
    v_add_u32 v92, v56, v92
    ds_write_b32 v92, v70 offset:2176
    v_lshrrev_b32 v56, 1, v92
    ds_write_b16 v56, v78 offset:55424
L_se_17:
    s_waitcnt lgkmcnt(0)
    s_barrier
    ds_read_b128 v[94:97], v1 offset:2176
    ds_read_b128 v[98:101], v1 offset:18560
    ds_read_b128 v[102:105], v1 offset:34944
    ds_read_b128 v[106:109], v1 offset:51328
    s_cmp_ge_u32 s3, 14
    s_cbranch_scc1 L_cr_19
    ds_read_b128 v[110:113], v2 offset:2176
L_cr_19:
    s_waitcnt vmcnt(9)
    v_mul_hi_u32_u24 v80, s28, v8
    v_mul_hi_u32_u24 v81, s28, v9
    v_mul_hi_u32_u24 v82, s28, v10
    v_mul_hi_u32_u24 v83, s28, v11
    v_lshl_or_b32 v22, v8, 20, v22
    v_lshl_or_b32 v23, v9, 20, v23
    v_lshl_or_b32 v24, v10, 20, v24
    v_lshl_or_b32 v25, v11, 20, v25
    v_and_b32 v8, 0x3fc, v80
    v_and_b32 v9, 0x3fc, v81
    v_and_b32 v10, 0x3fc, v82
    v_and_b32 v11, 0x3fc, v83
    ds_add_rtn_u32 v80, v8, v6 offset:0
    ds_add_rtn_u32 v81, v9, v6 offset:0
    ds_add_rtn_u32 v82, v10, v6 offset:0
    ds_add_rtn_u32 v83, v11, v6 offset:0
    s_waitcnt lgkmcnt(4)
    s_mul_i32 s29, s33, 53248
    s_add_u32 s29, s29, 0
    buffer_store_dwordx4 v[94:97], v1, s[24:27], s29 offen sc0 sc1
    s_mul_i32 s29, s33, 53248
    s_add_u32 s29, s29, 16384
    buffer_store_dwordx4 v[98:101], v1, s[24:27], s29 offen sc0 sc1
    v_lshlrev_b32 v114, 16, v36
    v_lshlrev_b32 v116, 16, v37
    v_and_b32 v115, 0xffff0000, v36
    v_and_b32 v117, 0xffff0000, v37
    v_mul_f32 v114, v7, v114
    v_mul_f32 v116, v7, v116
    v_mul_f32 v115, v7, v115
    v_mul_f32 v117, v7, v117
    v_cvt_pk_bf16_f32 v36, v114, v115
    v_cvt_pk_bf16_f32 v37, v116, v117
    v_lshlrev_b32 v114, 16, v36
    v_lshlrev_b32 v116, 16, v37
    v_and_b32 v115, 0xffff0000, v36
    v_and_b32 v117, 0xffff0000, v37
    v_mul_f32 v114, 0.15915494, v114
    v_mul_f32 v116, 0.15915494, v116
    v_mul_f32 v115, 0.15915494, v115
    v_mul_f32 v117, 0.15915494, v117
    v_fract_f32 v114, v114
    v_fract_f32 v116, v116
    v_fract_f32 v115, v115
    v_fract_f32 v117, v117
    v_cos_f32 v114, v114
    v_cos_f32 v116, v116
    v_cos_f32 v115, v115
    v_cos_f32 v117, v117
    s_nop 0
    v_cvt_pk_bf16_f32 v36, v114, v115
    v_cvt_pk_bf16_f32 v37, v116, v117
    v_lshlrev_b32 v114, 16, v36
    v_lshlrev_b32 v116, 16, v37
    v_and_b32 v115, 0xffff0000, v36
    v_and_b32 v117, 0xffff0000, v37
    v_cvt_pk_f16_f32 v36, v114, v115
    v_cvt_pk_f16_f32 v37, v116, v117
    v_mul_hi_u32_u24 v84, s28, v12
    v_mul_hi_u32_u24 v85, s28, v13
    v_mul_hi_u32_u24 v86, s28, v14
    v_mul_hi_u32_u24 v87, s28, v15
    v_lshl_or_b32 v26, v12, 20, v26
    v_lshl_or_b32 v27, v13, 20, v27
    v_lshl_or_b32 v28, v14, 20, v28
    v_lshl_or_b32 v29, v15, 20, v29
    v_and_b32 v12, 0x3fc, v84
    v_and_b32 v13, 0x3fc, v85
    v_and_b32 v14, 0x3fc, v86
    v_and_b32 v15, 0x3fc, v87
    ds_add_rtn_u32 v84, v12, v6 offset:0
    ds_add_rtn_u32 v85, v13, v6 offset:0
    ds_add_rtn_u32 v86, v14, v6 offset:0
    ds_add_rtn_u32 v87, v15, v6 offset:0
    s_mul_i32 s29, s33, 53248
    s_add_u32 s29, s29, 32768
    buffer_store_dwordx4 v[102:105], v1, s[24:27], s29 offen sc0 sc1
    s_mul_i32 s29, s33, 53248
    s_add_u32 s29, s29, 49152
    s_mul_i32 s36, s33, 26624
    s_add_u32 s36, s36, 53473280
    s_cmp_lt_u32 s3, 4
    s_cselect_b32 s29, s29, s36
    buffer_store_dwordx4 v[106:109], v1, s[24:27], s29 offen sc0 sc1
    v_lshlrev_b32 v114, 16, v38
    v_lshlrev_b32 v116, 16, v39
    v_and_b32 v115, 0xffff0000, v38
    v_and_b32 v117, 0xffff0000, v39
    v_mul_f32 v114, v7, v114
    v_mul_f32 v116, v7, v116
    v_mul_f32 v115, v7, v115
    v_mul_f32 v117, v7, v117
    v_cvt_pk_bf16_f32 v38, v114, v115
    v_cvt_pk_bf16_f32 v39, v116, v117
    v_lshlrev_b32 v114, 16, v38
    v_lshlrev_b32 v116, 16, v39
    v_and_b32 v115, 0xffff0000, v38
    v_and_b32 v117, 0xffff0000, v39
    v_mul_f32 v114, 0.15915494, v114
    v_mul_f32 v116, 0.15915494, v116
    v_mul_f32 v115, 0.15915494, v115
    v_mul_f32 v117, 0.15915494, v117
    v_fract_f32 v114, v114
    v_fract_f32 v116, v116
    v_fract_f32 v115, v115
    v_fract_f32 v117, v117
    v_cos_f32 v114, v114
    v_cos_f32 v116, v116
    v_cos_f32 v115, v115
    v_cos_f32 v117, v117
    s_nop 0
    v_cvt_pk_bf16_f32 v38, v114, v115
    v_cvt_pk_bf16_f32 v39, v116, v117
    v_lshlrev_b32 v114, 16, v38
    v_lshlrev_b32 v116, 16, v39
    v_and_b32 v115, 0xffff0000, v38
    v_and_b32 v117, 0xffff0000, v39
    v_cvt_pk_f16_f32 v38, v114, v115
    v_cvt_pk_f16_f32 v39, v116, v117
    v_mul_hi_u32_u24 v88, s28, v16
    v_mul_hi_u32_u24 v89, s28, v17
    v_mul_hi_u32_u24 v90, s28, v18
    v_mul_hi_u32_u24 v91, s28, v19
    v_lshl_or_b32 v30, v16, 20, v30
    v_lshl_or_b32 v31, v17, 20, v31
    v_lshl_or_b32 v32, v18, 20, v32
    v_lshl_or_b32 v33, v19, 20, v33
    v_and_b32 v16, 0x3fc, v88
    v_and_b32 v17, 0x3fc, v89
    v_and_b32 v18, 0x3fc, v90
    v_and_b32 v19, 0x3fc, v91
    ds_add_rtn_u32 v88, v16, v6 offset:0
    ds_add_rtn_u32 v89, v17, v6 offset:0
    ds_add_rtn_u32 v90, v18, v6 offset:0
    ds_add_rtn_u32 v91, v19, v6 offset:0
    s_cmp_ge_u32 s3, 14
    s_cbranch_scc1 L_cs_23
    s_mul_i32 s29, s33, 26624
    s_add_u32 s29, s29, 53489664
    buffer_store_dwordx4 v[110:113], v1, s[24:27], s29 offen sc0 sc1
L_cs_23:
    v_lshlrev_b32 v114, 16, v40
    v_lshlrev_b32 v116, 16, v41
    v_and_b32 v115, 0xffff0000, v40
    v_and_b32 v117, 0xffff0000, v41
    v_mul_f32 v114, v7, v114
    v_mul_f32 v116, v7, v116
    v_mul_f32 v115, v7, v115
    v_mul_f32 v117, v7, v117
    v_cvt_pk_bf16_f32 v40, v114, v115
    v_cvt_pk_bf16_f32 v41, v116, v117
    v_lshlrev_b32 v114, 16, v40
    v_lshlrev_b32 v116, 16, v41
    v_and_b32 v115, 0xffff0000, v40
    v_and_b32 v117, 0xffff0000, v41
    v_mul_f32 v114, 0.15915494, v114
    v_mul_f32 v116, 0.15915494, v116
    v_mul_f32 v115, 0.15915494, v115
    v_mul_f32 v117, 0.15915494, v117
    v_fract_f32 v114, v114
    v_fract_f32 v116, v116
    v_fract_f32 v115, v115
    v_fract_f32 v117, v117
    v_cos_f32 v114, v114
    v_cos_f32 v116, v116
    v_cos_f32 v115, v115
    v_cos_f32 v117, v117
    s_nop 0
    v_cvt_pk_bf16_f32 v40, v114, v115
    v_cvt_pk_bf16_f32 v41, v116, v117
    v_lshlrev_b32 v114, 16, v40
    v_lshlrev_b32 v116, 16, v41
    v_and_b32 v115, 0xffff0000, v40
    v_and_b32 v117, 0xffff0000, v41
    v_cvt_pk_f16_f32 v40, v114, v115
    v_cvt_pk_f16_f32 v41, v116, v117
    v_mul_hi_u32_u24 v92, s28, v20
    v_lshl_or_b32 v34, v20, 20, v34
    v_and_b32 v20, 0x3fc, v92
    ds_add_rtn_u32 v92, v20, v6 offset:0
    v_lshlrev_b32 v114, 16, v42
    v_and_b32 v115, 0xffff0000, v42
    v_mul_f32 v114, v7, v114
    v_mul_f32 v115, v7, v115
    v_cvt_pk_bf16_f32 v42, v114, v115
    v_lshlrev_b32 v114, 16, v42
    v_and_b32 v115, 0xffff0000, v42
    v_mul_f32 v114, 0.15915494, v114
    v_mul_f32 v115, 0.15915494, v115
    v_fract_f32 v114, v114
    v_fract_f32 v115, v115
    v_cos_f32 v114, v114
    v_cos_f32 v115, v115
    s_nop 0
    v_cvt_pk_bf16_f32 v42, v114, v115
    v_lshlrev_b32 v114, 16, v42
    v_and_b32 v115, 0xffff0000, v42
    v_cvt_pk_f16_f32 v42, v114, v115
    s_waitcnt lgkmcnt(0)
    s_barrier
    s_cmp_lg_u32 s3, 0
    s_cbranch_scc1 L_p_24
    ds_read_b128 v[94:97], v1 offset:0
    v_mov_b32 v98, 0
    v_mov_b32 v99, 0
    v_mov_b32 v100, 0
    v_mov_b32 v101, 0
    s_waitcnt lgkmcnt(0)
    ds_write_b128 v1, v[98:101] offset:0
    v_add_u32 v104, v94, v95
    v_add_u32 v105, v104, v96
    v_add_u32 v107, v105, v97
    v_mov_b32 v106, v107
    s_nop 1
    v_add_u32_dpp v106, v106, v106 row_shr:1 row_mask:0xf bank_mask:0xf
    s_nop 1
    v_add_u32_dpp v106, v106, v106 row_shr:2 row_mask:0xf bank_mask:0xf
    s_nop 1
    v_add_u32_dpp v106, v106, v106 row_shr:4 row_mask:0xf bank_mask:0xf
    s_nop 1
    v_add_u32_dpp v106, v106, v106 row_shr:8 row_mask:0xf bank_mask:0xf
    s_nop 1
    v_add_u32_dpp v106, v106, v106 row_bcast:15 row_mask:0xa bank_mask:0xf
    s_nop 1
    v_add_u32_dpp v106, v106, v106 row_bcast:31 row_mask:0xc bank_mask:0xf
    v_sub_u32 v102, v106, v107
    v_add_u32 v103, v102, v94
    v_add_u32 v104, v102, v104
    v_add_u32 v105, v102, v105
    ds_write_b128 v1, v[102:105] offset:1024
    s_waitcnt lgkmcnt(0)
L_p_24:
    s_barrier
    ds_read_b32 v8, v8 offset:1024
    ds_read_b32 v9, v9 offset:1024
    ds_read_b32 v10, v10 offset:1024
    ds_read_b32 v11, v11 offset:1024
    ds_read_b32 v12, v12 offset:1024
    ds_read_b32 v13, v13 offset:1024
    ds_read_b32 v14, v14 offset:1024
    ds_read_b32 v15, v15 offset:1024
    ds_read_b32 v16, v16 offset:1024
    ds_read_b32 v17, v17 offset:1024
    ds_read_b32 v18, v18 offset:1024
    ds_read_b32 v19, v19 offset:1024
    ds_read_b32 v20, v20 offset:1024
    s_cmp_lg_u32 s3, 0
    s_cbranch_scc1 L_os_26
    s_and_b32 s29, s2, 7
    s_mul_i32 s29, s29, 96
    s_lshr_b32 s36, s2, 3
    s_add_u32 s29, s29, s36
    s_lshl_b32 s29, s29, 2
    s_add_u32 s29, s29, 80216320
    v_lshl_or_b32 v94, v94, 16, v102
    v_lshl_or_b32 v95, v95, 16, v103
    v_lshl_or_b32 v96, v96, 16, v104
    v_lshl_or_b32 v97, v97, 16, v105
    buffer_store_dword v94, v93, s[24:27], s29 offen
    s_add_u32 s29, s29, 4224
    buffer_store_dword v95, v93, s[24:27], s29 offen
    s_add_u32 s29, s29, 4224
    buffer_store_dword v96, v93, s[24:27], s29 offen
    s_add_u32 s29, s29, 4224
    buffer_store_dword v97, v93, s[24:27], s29 offen
L_os_26:
    s_waitcnt lgkmcnt(0)
    v_add_u32 v80, v8, v80
    v_add_u32 v81, v9, v81
    v_add_u32 v82, v10, v82
    v_add_u32 v83, v11, v83
    ds_write_b32 v80, v22 offset:2176
    ds_write_b32 v81, v23 offset:2176
    ds_write_b32 v82, v24 offset:2176
    ds_write_b32 v83, v25 offset:2176
    v_lshrrev_b32 v8, 1, v80
    v_lshrrev_b32 v9, 1, v81
    v_lshrrev_b32 v10, 1, v82
    v_lshrrev_b32 v11, 1, v83
    ds_write_b16 v8, v36 offset:55424
    ds_write_b16_d16_hi v9, v36 offset:55424
    ds_write_b16 v10, v37 offset:55424
    ds_write_b16_d16_hi v11, v37 offset:55424
    v_add_u32 v84, v12, v84
    v_add_u32 v85, v13, v85
    v_add_u32 v86, v14, v86
    v_add_u32 v87, v15, v87
    ds_write_b32 v84, v26 offset:2176
    ds_write_b32 v85, v27 offset:2176
    ds_write_b32 v86, v28 offset:2176
    ds_write_b32 v87, v29 offset:2176
    v_lshrrev_b32 v12, 1, v84
    v_lshrrev_b32 v13, 1, v85
    v_lshrrev_b32 v14, 1, v86
    v_lshrrev_b32 v15, 1, v87
    ds_write_b16 v12, v38 offset:55424
    ds_write_b16_d16_hi v13, v38 offset:55424
    ds_write_b16 v14, v39 offset:55424
    ds_write_b16_d16_hi v15, v39 offset:55424
    v_add_u32 v88, v16, v88
    v_add_u32 v89, v17, v89
    v_add_u32 v90, v18, v90
    v_add_u32 v91, v19, v91
    ds_write_b32 v88, v30 offset:2176
    ds_write_b32 v89, v31 offset:2176
    ds_write_b32 v90, v32 offset:2176
    ds_write_b32 v91, v33 offset:2176
    v_lshrrev_b32 v16, 1, v88
    v_lshrrev_b32 v17, 1, v89
    v_lshrrev_b32 v18, 1, v90
    v_lshrrev_b32 v19, 1, v91
    ds_write_b16 v16, v40 offset:55424
    ds_write_b16_d16_hi v17, v40 offset:55424
    ds_write_b16 v18, v41 offset:55424
    ds_write_b16_d16_hi v19, v41 offset:55424
    v_add_u32 v92, v20, v92
    ds_write_b32 v92, v34 offset:2176
    v_lshrrev_b32 v20, 1, v92
    ds_write_b16 v20, v42 offset:55424
    s_mul_i32 s36, s2, 3125
    s_and_b32 s29, s36, -2
    s_lshl_b32 s29, s29, 3
    v_mov_b32 v114, 0x40000000
    v_cmp_gt_u32 vcc, 539, v0
    buffer_load_dwordx4 v[8:11], v1, s[40:43], s29 offen
    s_add_u32 s29, s29, 16384
    v_cndmask_b32 v114, v114, v1, vcc
    buffer_load_dwordx4 v[12:15], v114, s[40:43], s29 offen
L_se_25:
    s_waitcnt lgkmcnt(0)
    s_barrier
    ds_read_b128 v[94:97], v1 offset:2176
    ds_read_b128 v[98:101], v1 offset:18560
    ds_read_b128 v[102:105], v1 offset:34944
    ds_read_b128 v[106:109], v1 offset:51328
    s_cmp_ge_u32 s3, 14
    s_cbranch_scc1 L_cr_27
    ds_read_b128 v[110:113], v2 offset:2176
L_cr_27:
    s_waitcnt vmcnt(2)
    s_cmp_le_u32 s48, 0
    s_cbranch_scc1 L_hg_28
    v_mul_hi_u32_u24 v80, s28, v44
    v_mul_hi_u32_u24 v81, s28, v45
    v_mul_hi_u32_u24 v82, s28, v46
    v_mul_hi_u32_u24 v83, s28, v47
    v_lshl_or_b32 v58, v44, 20, v58
    v_lshl_or_b32 v59, v45, 20, v59
    v_lshl_or_b32 v60, v46, 20, v60
    v_lshl_or_b32 v61, v47, 20, v61
    v_and_b32 v44, 0x3fc, v80
    v_and_b32 v45, 0x3fc, v81
    v_and_b32 v46, 0x3fc, v82
    v_and_b32 v47, 0x3fc, v83
    ds_add_rtn_u32 v80, v44, v6 offset:0
    ds_add_rtn_u32 v81, v45, v6 offset:0
    ds_add_rtn_u32 v82, v46, v6 offset:0
    ds_add_rtn_u32 v83, v47, v6 offset:0
    v_lshlrev_b32 v114, 16, v72
    v_lshlrev_b32 v116, 16, v73
    v_and_b32 v115, 0xffff0000, v72
    v_and_b32 v117, 0xffff0000, v73
    v_mul_f32 v114, v7, v114
    v_mul_f32 v116, v7, v116
    v_mul_f32 v115, v7, v115
    v_mul_f32 v117, v7, v117
    v_cvt_pk_bf16_f32 v72, v114, v115
    v_cvt_pk_bf16_f32 v73, v116, v117
    v_lshlrev_b32 v114, 16, v72
    v_lshlrev_b32 v116, 16, v73
    v_and_b32 v115, 0xffff0000, v72
    v_and_b32 v117, 0xffff0000, v73
    v_mul_f32 v114, 0.15915494, v114
    v_mul_f32 v116, 0.15915494, v116
    v_mul_f32 v115, 0.15915494, v115
    v_mul_f32 v117, 0.15915494, v117
    v_fract_f32 v114, v114
    v_fract_f32 v116, v116
    v_fract_f32 v115, v115
    v_fract_f32 v117, v117
    v_cos_f32 v114, v114
    v_cos_f32 v116, v116
    v_cos_f32 v115, v115
    v_cos_f32 v117, v117
    s_nop 0
    v_cvt_pk_bf16_f32 v72, v114, v115
    v_cvt_pk_bf16_f32 v73, v116, v117
    v_lshlrev_b32 v114, 16, v72
    v_lshlrev_b32 v116, 16, v73
    v_and_b32 v115, 0xffff0000, v72
    v_and_b32 v117, 0xffff0000, v73
    v_cvt_pk_f16_f32 v72, v114, v115
    v_cvt_pk_f16_f32 v73, v116, v117
L_hg_28:
    s_waitcnt lgkmcnt(0)
    s_mul_i32 s29, s34, 53248
    s_add_u32 s29, s29, 0
    buffer_store_dwordx4 v[94:97], v1, s[24:27], s29 offen sc0 sc1
    s_mul_i32 s29, s34, 53248
    s_add_u32 s29, s29, 16384
    buffer_store_dwordx4 v[98:101], v1, s[24:27], s29 offen sc0 sc1
    s_cmp_le_u32 s48, 1
    s_cbranch_scc1 L_hg_29
    v_mul_hi_u32_u24 v84, s28, v48
    v_mul_hi_u32_u24 v85, s28, v49
    v_mul_hi_u32_u24 v86, s28, v50
    v_mul_hi_u32_u24 v87, s28, v51
    v_lshl_or_b32 v62, v48, 20, v62
    v_lshl_or_b32 v63, v49, 20, v63
    v_lshl_or_b32 v64, v50, 20, v64
    v_lshl_or_b32 v65, v51, 20, v65
    v_and_b32 v48, 0x3fc, v84
    v_and_b32 v49, 0x3fc, v85
    v_and_b32 v50, 0x3fc, v86
    v_and_b32 v51, 0x3fc, v87
    ds_add_rtn_u32 v84, v48, v6 offset:0
    ds_add_rtn_u32 v85, v49, v6 offset:0
    ds_add_rtn_u32 v86, v50, v6 offset:0
    ds_add_rtn_u32 v87, v51, v6 offset:0
    v_lshlrev_b32 v114, 16, v74
    v_lshlrev_b32 v116, 16, v75
    v_and_b32 v115, 0xffff0000, v74
    v_and_b32 v117, 0xffff0000, v75
    v_mul_f32 v114, v7, v114
    v_mul_f32 v116, v7, v116
    v_mul_f32 v115, v7, v115
    v_mul_f32 v117, v7, v117
    v_cvt_pk_bf16_f32 v74, v114, v115
    v_cvt_pk_bf16_f32 v75, v116, v117
    v_lshlrev_b32 v114, 16, v74
    v_lshlrev_b32 v116, 16, v75
    v_and_b32 v115, 0xffff0000, v74
    v_and_b32 v117, 0xffff0000, v75
    v_mul_f32 v114, 0.15915494, v114
    v_mul_f32 v116, 0.15915494, v116
    v_mul_f32 v115, 0.15915494, v115
    v_mul_f32 v117, 0.15915494, v117
    v_fract_f32 v114, v114
    v_fract_f32 v116, v116
    v_fract_f32 v115, v115
    v_fract_f32 v117, v117
    v_cos_f32 v114, v114
    v_cos_f32 v116, v116
    v_cos_f32 v115, v115
    v_cos_f32 v117, v117
    s_nop 0
    v_cvt_pk_bf16_f32 v74, v114, v115
    v_cvt_pk_bf16_f32 v75, v116, v117
    v_lshlrev_b32 v114, 16, v74
    v_lshlrev_b32 v116, 16, v75
    v_and_b32 v115, 0xffff0000, v74
    v_and_b32 v117, 0xffff0000, v75
    v_cvt_pk_f16_f32 v74, v114, v115
    v_cvt_pk_f16_f32 v75, v116, v117
L_hg_29:
    s_mul_i32 s29, s34, 53248
    s_add_u32 s29, s29, 32768
    buffer_store_dwordx4 v[102:105], v1, s[24:27], s29 offen sc0 sc1
    s_mul_i32 s29, s34, 53248
    s_add_u32 s29, s29, 49152
    s_mul_i32 s36, s34, 26624
    s_add_u32 s36, s36, 53473280
    s_cmp_lt_u32 s3, 4
    s_cselect_b32 s29, s29, s36
    buffer_store_dwordx4 v[106:109], v1, s[24:27], s29 offen sc0 sc1
    s_cmp_ge_u32 s3, 14
    s_cbranch_scc1 L_cs_30
    s_mul_i32 s29, s34, 26624
    s_add_u32 s29, s29, 53489664
    buffer_store_dwordx4 v[110:113], v1, s[24:27], s29 offen sc0 sc1
L_cs_30:
    s_cmp_le_u32 s48, 2
    s_cbranch_scc1 L_hg_31
    v_mul_hi_u32_u24 v88, s28, v52
    v_mul_hi_u32_u24 v89, s28, v53
    v_mul_hi_u32_u24 v90, s28, v54
    v_mul_hi_u32_u24 v91, s28, v55
    v_lshl_or_b32 v66, v52, 20, v66
    v_lshl_or_b32 v67, v53, 20, v67
    v_lshl_or_b32 v68, v54, 20, v68
    v_lshl_or_b32 v69, v55, 20, v69
    v_and_b32 v52, 0x3fc, v88
    v_and_b32 v53, 0x3fc, v89
    v_and_b32 v54, 0x3fc, v90
    v_and_b32 v55, 0x3fc, v91
    ds_add_rtn_u32 v88, v52, v6 offset:0
    ds_add_rtn_u32 v89, v53, v6 offset:0
    ds_add_rtn_u32 v90, v54, v6 offset:0
    ds_add_rtn_u32 v91, v55, v6 offset:0
    v_lshlrev_b32 v114, 16, v76
    v_lshlrev_b32 v116, 16, v77
    v_and_b32 v115, 0xffff0000, v76
    v_and_b32 v117, 0xffff0000, v77
    v_mul_f32 v114, v7, v114
    v_mul_f32 v116, v7, v116
    v_mul_f32 v115, v7, v115
    v_mul_f32 v117, v7, v117
    v_cvt_pk_bf16_f32 v76, v114, v115
    v_cvt_pk_bf16_f32 v77, v116, v117
    v_lshlrev_b32 v114, 16, v76
    v_lshlrev_b32 v116, 16, v77
    v_and_b32 v115, 0xffff0000, v76
    v_and_b32 v117, 0xffff0000, v77
    v_mul_f32 v114, 0.15915494, v114
    v_mul_f32 v116, 0.15915494, v116
    v_mul_f32 v115, 0.15915494, v115
    v_mul_f32 v117, 0.15915494, v117
    v_fract_f32 v114, v114
    v_fract_f32 v116, v116
    v_fract_f32 v115, v115
    v_fract_f32 v117, v117
    v_cos_f32 v114, v114
    v_cos_f32 v116, v116
    v_cos_f32 v115, v115
    v_cos_f32 v117, v117
    s_nop 0
    v_cvt_pk_bf16_f32 v76, v114, v115
    v_cvt_pk_bf16_f32 v77, v116, v117
    v_lshlrev_b32 v114, 16, v76
    v_lshlrev_b32 v116, 16, v77
    v_and_b32 v115, 0xffff0000, v76
    v_and_b32 v117, 0xffff0000, v77
    v_cvt_pk_f16_f32 v76, v114, v115
    v_cvt_pk_f16_f32 v77, v116, v117
L_hg_31:
    s_waitcnt lgkmcnt(0)
    s_barrier
    s_cmp_lg_u32 s3, 0
    s_cbranch_scc1 L_p_32
    ds_read_b128 v[94:97], v1 offset:0
    v_mov_b32 v98, 0
    v_mov_b32 v99, 0
    v_mov_b32 v100, 0
    v_mov_b32 v101, 0
    s_waitcnt lgkmcnt(0)
    ds_write_b128 v1, v[98:101] offset:0
    v_add_u32 v104, v94, v95
    v_add_u32 v105, v104, v96
    v_add_u32 v107, v105, v97
    v_mov_b32 v106, v107
    s_nop 1
    v_add_u32_dpp v106, v106, v106 row_shr:1 row_mask:0xf bank_mask:0xf
    s_nop 1
    v_add_u32_dpp v106, v106, v106 row_shr:2 row_mask:0xf bank_mask:0xf
    s_nop 1
    v_add_u32_dpp v106, v106, v106 row_shr:4 row_mask:0xf bank_mask:0xf
    s_nop 1
    v_add_u32_dpp v106, v106, v106 row_shr:8 row_mask:0xf bank_mask:0xf
    s_nop 1
    v_add_u32_dpp v106, v106, v106 row_bcast:15 row_mask:0xa bank_mask:0xf
    s_nop 1
    v_add_u32_dpp v106, v106, v106 row_bcast:31 row_mask:0xc bank_mask:0xf
    v_sub_u32 v102, v106, v107
    v_add_u32 v103, v102, v94
    v_add_u32 v104, v102, v104
    v_add_u32 v105, v102, v105
    ds_write_b128 v1, v[102:105] offset:1024
    s_waitcnt lgkmcnt(0)
L_p_32:
    s_barrier
    s_cmp_le_u32 s48, 0
    s_cbranch_scc1 L_sr_34
    ds_read_b32 v44, v44 offset:1024
    ds_read_b32 v45, v45 offset:1024
    ds_read_b32 v46, v46 offset:1024
    ds_read_b32 v47, v47 offset:1024
    s_cmp_le_u32 s48, 1
    s_cbranch_scc1 L_sr_34
    ds_read_b32 v48, v48 offset:1024
    ds_read_b32 v49, v49 offset:1024
    ds_read_b32 v50, v50 offset:1024
    ds_read_b32 v51, v51 offset:1024
    s_cmp_le_u32 s48, 2
    s_cbranch_scc1 L_sr_34
    ds_read_b32 v52, v52 offset:1024
    ds_read_b32 v53, v53 offset:1024
    ds_read_b32 v54, v54 offset:1024
    ds_read_b32 v55, v55 offset:1024
L_sr_34:
    s_cmp_lg_u32 s3, 0
    s_cbranch_scc1 L_os_35
    s_and_b32 s29, s2, 7
    s_mul_i32 s29, s29, 32
    s_lshr_b32 s36, s2, 3
    s_add_u32 s29, s29, s36
    s_lshl_b32 s29, s29, 2
    s_add_u32 s29, s29, 80219136
    v_lshl_or_b32 v94, v94, 16, v102
    v_lshl_or_b32 v95, v95, 16, v103
    v_lshl_or_b32 v96, v96, 16, v104
    v_lshl_or_b32 v97, v97, 16, v105
    buffer_store_dword v94, v93, s[24:27], s29 offen
    s_add_u32 s29, s29, 4224
    buffer_store_dword v95, v93, s[24:27], s29 offen
    s_add_u32 s29, s29, 4224
    buffer_store_dword v96, v93, s[24:27], s29 offen
    s_add_u32 s29, s29, 4224
    buffer_store_dword v97, v93, s[24:27], s29 offen
L_os_35:
    s_waitcnt lgkmcnt(0)
    s_cmp_le_u32 s48, 0
    s_cbranch_scc1 L_se_33
    v_add_u32 v80, v44, v80
    v_add_u32 v81, v45, v81
    v_add_u32 v82, v46, v82
    v_add_u32 v83, v47, v83
    ds_write_b32 v80, v58 offset:2176
    ds_write_b32 v81, v59 offset:2176
    ds_write_b32 v82, v60 offset:2176
    ds_write_b32 v83, v61 offset:2176
    v_lshrrev_b32 v44, 1, v80
    v_lshrrev_b32 v45, 1, v81
    v_lshrrev_b32 v46, 1, v82
    v_lshrrev_b32 v47, 1, v83
    ds_write_b16 v44, v72 offset:55424
    ds_write_b16_d16_hi v45, v72 offset:55424
    ds_write_b16 v46, v73 offset:55424
    ds_write_b16_d16_hi v47, v73 offset:55424
    s_cmp_le_u32 s48, 1
    s_cbranch_scc1 L_se_33
    v_add_u32 v84, v48, v84
    v_add_u32 v85, v49, v85
    v_add_u32 v86, v50, v86
    v_add_u32 v87, v51, v87
    ds_write_b32 v84, v62 offset:2176
    ds_write_b32 v85, v63 offset:2176
    ds_write_b32 v86, v64 offset:2176
    ds_write_b32 v87, v65 offset:2176
    v_lshrrev_b32 v48, 1, v84
    v_lshrrev_b32 v49, 1, v85
    v_lshrrev_b32 v50, 1, v86
    v_lshrrev_b32 v51, 1, v87
    ds_write_b16 v48, v74 offset:55424
    ds_write_b16_d16_hi v49, v74 offset:55424
    ds_write_b16 v50, v75 offset:55424
    ds_write_b16_d16_hi v51, v75 offset:55424
    s_cmp_le_u32 s48, 2
    s_cbranch_scc1 L_se_33
    v_add_u32 v88, v52, v88
    v_add_u32 v89, v53, v89
    v_add_u32 v90, v54, v90
    v_add_u32 v91, v55, v91
    ds_write_b32 v88, v66 offset:2176
    ds_write_b32 v89, v67 offset:2176
    ds_write_b32 v90, v68 offset:2176
    ds_write_b32 v91, v69 offset:2176
    v_lshrrev_b32 v52, 1, v88
    v_lshrrev_b32 v53, 1, v89
    v_lshrrev_b32 v54, 1, v90
    v_lshrrev_b32 v55, 1, v91
    ds_write_b16 v52, v76 offset:55424
    ds_write_b16_d16_hi v53, v76 offset:55424
    ds_write_b16 v54, v77 offset:55424
    ds_write_b16_d16_hi v55, v77 offset:55424
L_se_33:
    s_waitcnt lgkmcnt(0)
    s_barrier
    s_lshl_b32 s30, s48, 3
    s_min_u32 s31, s30, 16
    s_sub_i32 s30, s30, 16
    s_cmp_gt_u32 s48, 0
    s_cbranch_scc0 L_fr_36
    ds_read_b128 v[94:97], v1 offset:2176
L_fr_36:
    s_cmp_gt_u32 s48, 1
    s_cbranch_scc0 L_fr_37
    ds_read_b128 v[98:101], v1 offset:18560
L_fr_37:
    s_cmp_gt_u32 s48, 2
    s_cbranch_scc0 L_fr_38
    ds_read_b128 v[102:105], v1 offset:34944
L_fr_38:
    s_cmp_lt_u32 s3, s31
    s_cbranch_scc0 L_fr_39
    ds_read_b128 v[106:109], v1 offset:55424
L_fr_39:
    s_cmp_lt_i32 s3, s30
    s_cbranch_scc0 L_fr_40
    ds_read_b128 v[110:113], v2 offset:6272
L_fr_40:
    s_waitcnt lgkmcnt(0)
    s_cmp_gt_u32 s48, 0
    s_cselect_b64 exec, -1, 0
    s_lshl_b32 s29, s35, 2
    s_add_u32 s29, s29, 0
    buffer_store_dwordx4 v[94:97], v1, s[24:27], s29 offen sc0 sc1
    s_cmp_gt_u32 s48, 1
    s_cselect_b64 exec, -1, 0
    s_lshl_b32 s29, s35, 2
    s_add_u32 s29, s29, 16384
    buffer_store_dwordx4 v[98:101], v1, s[24:27], s29 offen sc0 sc1
    s_cmp_gt_u32 s48, 2
    s_cselect_b64 exec, -1, 0
    s_lshl_b32 s29, s35, 2
    s_add_u32 s29, s29, 32768
    buffer_store_dwordx4 v[102:105], v1, s[24:27], s29 offen sc0 sc1
    s_cmp_lt_u32 s3, s31
    s_cselect_b64 exec, -1, 0
    s_lshl_b32 s29, s35, 1
    s_add_u32 s29, s29, 53477376
    buffer_store_dwordx4 v[106:109], v1, s[24:27], s29 offen sc0 sc1
    s_cmp_lt_i32 s3, s30
    s_cselect_b64 exec, -1, 0
    s_lshl_b32 s29, s35, 1
    s_add_u32 s29, s29, 53493760
    buffer_store_dwordx4 v[110:113], v1, s[24:27], s29 offen sc0 sc1
    s_mov_b64 exec, -1
    s_waitcnt vmcnt(5)
    v_and_b32 v8, 0x7fff7fff, v8
    v_and_b32 v9, 0x7fff7fff, v9
    v_and_b32 v10, 0x7fff7fff, v10
    v_and_b32 v11, 0x7fff7fff, v11
    v_and_b32 v12, 0x7fff7fff, v12
    v_and_b32 v13, 0x7fff7fff, v13
    v_and_b32 v14, 0x7fff7fff, v14
    v_and_b32 v15, 0x7fff7fff, v15
    v_pk_max_u16 v8, v8, v9
    v_pk_max_u16 v10, v10, v11
    v_pk_max_u16 v12, v12, v13
    v_pk_max_u16 v14, v14, v15
    v_pk_max_u16 v8, v8, v10
    v_pk_max_u16 v12, v12, v14
    v_pk_max_u16 v8, v8, v12
    v_lshrrev_b32 v114, 16, v8
    v_and_b32 v8, 0xffff, v8
    v_max_u32 v114, v114, v8
    v_mov_b32 v115, 0
    s_nop 1
    v_max_u32_dpp v114, v114, v114 row_shr:1 row_mask:0xf bank_mask:0xf
    s_nop 1
    v_max_u32_dpp v114, v114, v114 row_shr:2 row_mask:0xf bank_mask:0xf
    s_nop 1
    v_max_u32_dpp v114, v114, v114 row_shr:4 row_mask:0xf bank_mask:0xf
    s_nop 1
    v_max_u32_dpp v114, v114, v114 row_shr:8 row_mask:0xf bank_mask:0xf
    s_nop 1
    v_max_u32_dpp v114, v114, v114 row_bcast:15 row_mask:0xa bank_mask:0xf
    s_nop 1
    v_max_u32_dpp v114, v114, v114 row_bcast:31 row_mask:0xc bank_mask:0xf
    s_lshl_b64 exec, 1, 63
    ds_max_u32 v115, v114 offset:2048
    s_waitcnt lgkmcnt(0)
    s_barrier
    s_cmp_lg_u32 s3, 0
    s_cbranch_scc1 L_k1_nomax
    ds_read_b32 v114, v115 offset:2048
    s_lshl_b32 s29, s2, 2
    s_add_u32 s29, s29, 81298432
    s_waitcnt lgkmcnt(0)
    buffer_store_dword v114, v115, s[24:27], s29 offen
L_k1_nomax:
L_k1_end:
    s_endpgm
.globl gather_part_kernel
.p2align 8
.type gather_part_kernel,@function
gather_part_kernel:
    s_cmp_ge_u32 s2, 256
    s_cbranch_scc1 L_k2_end
    s_load_dwordx2 s[6:7], s[0:1], 104
    s_load_dwordx2 s[32:33], s[0:1], 0
    v_lshrrev_b32 v6, 6, v0
    v_and_b32 v1, 63, v0
    v_readfirstlane_b32 s3, v6
    s_and_b32 s4, s2, 7
    s_lshl_b32 s4, s4, 5
    s_lshr_b32 s25, s2, 3
    s_add_u32 s4, s4, s25
    v_lshlrev_b32 v2, 4, v0
    v_lshlrev_b32 v5, 1, v0
    s_mul_i32 s26, s3, 48
    v_add_u32 v7, s26, v1
    v_lshl_add_u32 v9, v1, 4, s3
    v_cmp_gt_u32 vcc, 48, v1
    v_lshlrev_b32 v15, 4, v1
    s_nop 0
    v_cndmask_b32 v7, v9, v7, vcc
    v_lshlrev_b32 v14, 2, v7
    v_mov_b32 v10, 0
    v_mov_b32 v6, 8
    s_mul_i32 s25, s4, 4224
    s_add_u32 s25, s25, 80216064
    s_mov_b32 s26, 81298432
    s_waitcnt lgkmcnt(0)
    s_mov_b32 s8, s6
    s_and_b32 s9, s7, 0xffff
    s_mov_b32 s10, 268435456
    s_mov_b32 s11, 0x20000
    buffer_load_dword v8, v14, s[8:11], s25 offen
    buffer_load_dwordx4 v[88:91], v15, s[8:11], s26 offen
    s_mov_b32 s12, s32
    s_and_b32 s13, s33, 0xffff
    s_mov_b32 s14, 6400000
    s_mov_b32 s15, 0x20000
    s_mul_i32 s26, s4, 3125
    s_and_b32 s25, s26, -2
    s_lshl_b32 s25, s25, 3
    v_mov_b32 v13, 0x40000000
    v_cmp_gt_u32 vcc, 539, v0
    buffer_load_dwordx4 v[16:19], v2, s[12:15], s25 offen
    s_add_u32 s25, s25, 16384
    v_cndmask_b32 v13, v13, v2, vcc
    buffer_load_dwordx4 v[20:23], v13, s[12:15], s25 offen
    v_lshlrev_b32 v14, 2, v0
    ds_write_b32 v14, v10
    s_and_b32 s26, s26, -2
    v_add_u32 v3, 36864, v2
    v_add_u32 v4, 102400, v2
    v_mul_u32_u24 v11, 262656, v1
    s_mov_b32 s16, 1275072512
    s_mov_b32 s17, 5497560
    s_mov_b32 s31, 53477376
    s_mov_b32 s18, 0
    s_mov_b32 s19, 0
    v_add_u32 v24, s26, v5
    v_and_b32 v24, 0xfff, v24
    v_lshlrev_b32 v24, 3, v24
    v_xor_b32 v25, 0x4000, v24
    v_and_b32 v12, 31, v7
    v_lshrrev_b32 v13, 5, v7
    v_mul_u32_u24 v14, 43, v13
    v_lshrrev_b32 v14, 7, v14
    v_mad_i32_i24 v15, v14, -3, v13
    v_lshl_add_u32 v14, v12, 3, v14
    v_lshl_add_u32 v14, v15, 8, v14
    v_mul_u32_u24 v14, 13312, v14
    v_subrev_u32 v13, 24, v13
    v_lshl_add_u32 v12, v12, 3, v13
    v_cmp_gt_u32 vcc, 48, v1
    v_mul_u32_u24 v12, 12288, v12
    v_add_u32 v12, 10223616, v12
    v_cndmask_b32 v7, v12, v14, vcc
    v_mov_b32 v28, 0
    v_mov_b32 v29, 0
    v_mov_b32 v30, 0
    v_mov_b32 v31, 0
    v_mov_b32 v32, 0
    v_mov_b32 v33, 0
    v_mov_b32 v34, 0
    v_mov_b32 v35, 0
    v_mov_b32 v36, 0
    v_mov_b32 v37, 0
    v_mov_b32 v38, 0
    v_mov_b32 v39, 0
    v_mov_b32 v40, 0
    v_mov_b32 v41, 0
    v_mov_b32 v42, 0
    v_mov_b32 v43, 0
    v_mov_b32 v44, 0
    v_mov_b32 v45, 0
    v_mov_b32 v46, 0
    v_mov_b32 v47, 0
    v_mov_b32 v48, 0
    v_mov_b32 v49, 0
    v_mov_b32 v50, 0
    v_mov_b32 v51, 0
    v_mov_b32 v52, 0
    v_mov_b32 v53, 0
    v_mov_b32 v54, 0
    v_mov_b32 v55, 0
    v_mov_b32 v56, 0
    v_mov_b32 v57, 0
    v_mov_b32 v58, 0
    v_mov_b32 v59, 0
    v_mov_b32 v60, 0
    v_mov_b32 v61, 0
    v_mov_b32 v62, 0
    v_mov_b32 v63, 0
    v_mov_b32 v64, 0
    v_mov_b32 v65, 0
    v_mov_b32 v66, 0
    v_mov_b32 v67, 0
    v_mov_b32 v68, 0
    v_mov_b32 v69, 0
    v_mov_b32 v70, 0
    v_mov_b32 v71, 0
    v_mov_b32 v72, 0
    v_mov_b32 v73, 0
    v_mov_b32 v74, 0
    v_mov_b32 v75, 0
    v_mov_b32 v76, 0
    v_mov_b32 v77, 0
    v_mov_b32 v78, 0
    v_mov_b32 v79, 0
    v_mov_b32 v80, 0
    v_mov_b32 v81, 0
    v_mov_b32 v82, 0
    v_mov_b32 v83, 0
    v_mov_b32 v84, 0
    v_mov_b32 v85, 0
    v_mov_b32 v86, 0
    v_mov_b32 v87, 0
    s_waitcnt vmcnt(3)
    v_bfe_u32 v12, v8, 2, 14
    v_lshrrev_b32 v8, 18, v8
    v_add_u32 v7, v7, v12
    v_add_u32 v13, 62, v8
    v_mul_u32_u24 v13, 16645, v13
    v_lshrrev_b32 v13, 20, v13
    v_min_u32 v14, 63, v8
    v_cmp_lt_u32 s[20:21], 0, v8
    v_lshl_or_b32 v9, v7, 6, v14
    s_nop 1
    v_add_u32_dpp v13, v13, v13 row_shr:1 row_mask:0xf bank_mask:0xf
    s_nop 1
    v_add_u32_dpp v13, v13, v13 row_shr:2 row_mask:0xf bank_mask:0xf
    s_nop 1
    v_add_u32_dpp v13, v13, v13 row_shr:4 row_mask:0xf bank_mask:0xf
    s_nop 1
    v_add_u32_dpp v13, v13, v13 row_shr:8 row_mask:0xf bank_mask:0xf
    s_nop 1
    v_add_u32_dpp v13, v13, v13 row_bcast:15 row_mask:0xa bank_mask:0xf
    s_nop 1
    v_add_u32_dpp v13, v13, v13 row_bcast:31 row_mask:0xc bank_mask:0xf
    s_nop 0
    v_readlane_b32 s25, v13, 63
    s_nop 3
    s_add_u32 s22, s25, 4
    s_mul_i32 s22, s22, 52429
    s_lshr_b32 s22, s22, 18
    s_add_u32 s23, s25, 14
    s_mul_i32 s23, s23, 34953
    s_lshr_b32 s23, s23, 19
    s_cmp_eq_u64 s[20:21], 0
    s_cbranch_scc1 L_pr_42
L_pb_41:
    s_ff1_i32_b64 s27, s[20:21]
    s_bitset0_b64 s[20:21], s27
    v_readlane_b32 s32, v9, s27
    s_lshr_b32 s25, s32, 6
    s_bfm_b64 exec, s32, 0
    v_add_lshl_u32 v28, s25, v1, 2
    v_lshrrev_b32 v29, 1, v28
L_pi_44:
    buffer_load_dword v28, v28, s[8:11], 0 offen
    buffer_load_ushort v29, v29, s[8:11], s31 offen
    s_cmp_eq_u64 s[20:21], 0
    s_cbranch_scc1 L_pr_46
L_pb_45:
    s_ff1_i32_b64 s27, s[20:21]
    s_bitset0_b64 s[20:21], s27
    v_readlane_b32 s33, v9, s27
    s_lshr_b32 s25, s33, 6
    s_bfm_b64 exec, s33, 0
    v_add_lshl_u32 v30, s25, v1, 2
    v_lshrrev_b32 v31, 1, v30
L_pi_48:
    buffer_load_dword v30, v30, s[8:11], 0 offen
    buffer_load_ushort v31, v31, s[8:11], s31 offen
    s_cmp_eq_u64 s[20:21], 0
    s_cbranch_scc1 L_pr_50
L_pb_49:
    s_ff1_i32_b64 s27, s[20:21]
    s_bitset0_b64 s[20:21], s27
    v_readlane_b32 s34, v9, s27
    s_lshr_b32 s25, s34, 6
    s_bfm_b64 exec, s34, 0
    v_add_lshl_u32 v32, s25, v1, 2
    v_lshrrev_b32 v33, 1, v32
L_pi_52:
    buffer_load_dword v32, v32, s[8:11], 0 offen
    buffer_load_ushort v33, v33, s[8:11], s31 offen
    s_cmp_eq_u64 s[20:21], 0
    s_cbranch_scc1 L_pr_54
L_pb_53:
    s_ff1_i32_b64 s27, s[20:21]
    s_bitset0_b64 s[20:21], s27
    v_readlane_b32 s35, v9, s27
    s_lshr_b32 s25, s35, 6
    s_bfm_b64 exec, s35, 0
    v_add_lshl_u32 v34, s25, v1, 2
    v_lshrrev_b32 v35, 1, v34
L_pi_56:
    buffer_load_dword v34, v34, s[8:11], 0 offen
    buffer_load_ushort v35, v35, s[8:11], s31 offen
    s_cmp_eq_u64 s[20:21], 0
    s_cbranch_scc1 L_pr_58
L_pb_57:
    s_ff1_i32_b64 s27, s[20:21]
    s_bitset0_b64 s[20:21], s27
    v_readlane_b32 s36, v9, s27
    s_lshr_b32 s25, s36, 6
    s_bfm_b64 exec, s36, 0
    v_add_lshl_u32 v36, s25, v1, 2
    v_lshrrev_b32 v37, 1, v36
L_pi_60:
    buffer_load_dword v36, v36, s[8:11], 0 offen
    buffer_load_ushort v37, v37, s[8:11], s31 offen
    s_cmp_eq_u64 s[20:21], 0
    s_cbranch_scc1 L_pr_62
L_pb_61:
    s_ff1_i32_b64 s27, s[20:21]
    s_bitset0_b64 s[20:21], s27
    v_readlane_b32 s37, v9, s27
    s_lshr_b32 s25, s37, 6
    s_bfm_b64 exec, s37, 0
    v_add_lshl_u32 v38, s25, v1, 2
    v_lshrrev_b32 v39, 1, v38
L_pi_64:
    buffer_load_dword v38, v38, s[8:11], 0 offen
    buffer_load_ushort v39, v39, s[8:11], s31 offen
    s_cmp_eq_u64 s[20:21], 0
    s_cbranch_scc1 L_pr_66
L_pb_65:
    s_ff1_i32_b64 s27, s[20:21]
    s_bitset0_b64 s[20:21], s27
    v_readlane_b32 s38, v9, s27
    s_lshr_b32 s25, s38, 6
    s_bfm_b64 exec, s38, 0
    v_add_lshl_u32 v40, s25, v1, 2
    v_lshrrev_b32 v41, 1, v40
L_pi_68:
    buffer_load_dword v40, v40, s[8:11], 0 offen
    buffer_load_ushort v41, v41, s[8:11], s31 offen
    s_cmp_eq_u64 s[20:21], 0
    s_cbranch_scc1 L_pr_70
L_pb_69:
    s_ff1_i32_b64 s27, s[20:21]
    s_bitset0_b64 s[20:21], s27
    v_readlane_b32 s39, v9, s27
    s_lshr_b32 s25, s39, 6
    s_bfm_b64 exec, s39, 0
    v_add_lshl_u32 v42, s25, v1, 2
    v_lshrrev_b32 v43, 1, v42
L_pi_72:
    buffer_load_dword v42, v42, s[8:11], 0 offen
    buffer_load_ushort v43, v43, s[8:11], s31 offen
    s_cmp_eq_u64 s[20:21], 0
    s_cbranch_scc1 L_pr_74
L_pb_73:
    s_ff1_i32_b64 s27, s[20:21]
    s_bitset0_b64 s[20:21], s27
    v_readlane_b32 s40, v9, s27
    s_lshr_b32 s25, s40, 6
    s_bfm_b64 exec, s40, 0
    v_add_lshl_u32 v44, s25, v1, 2
    v_lshrrev_b32 v45, 1, v44
L_pi_76:
    buffer_load_dword v44, v44, s[8:11], 0 offen
    buffer_load_ushort v45, v45, s[8:11], s31 offen
    s_cmp_eq_u64 s[20:21], 0
    s_cbranch_scc1 L_pr_78
L_pb_77:
    s_ff1_i32_b64 s27, s[20:21]
    s_bitset0_b64 s[20:21], s27
    v_readlane_b32 s41, v9, s27
    s_lshr_b32 s25, s41, 6
    s_bfm_b64 exec, s41, 0
    v_add_lshl_u32 v46, s25, v1, 2
    v_lshrrev_b32 v47, 1, v46
L_pi_80:
    buffer_load_dword v46, v46, s[8:11], 0 offen
    buffer_load_ushort v47, v47, s[8:11], s31 offen
    s_cmp_eq_u64 s[20:21], 0
    s_cbranch_scc1 L_pr_82
L_pb_81:
    s_ff1_i32_b64 s27, s[20:21]
    s_bitset0_b64 s[20:21], s27
    v_readlane_b32 s42, v9, s27
    s_lshr_b32 s25, s42, 6
    s_bfm_b64 exec, s42, 0
    v_add_lshl_u32 v48, s25, v1, 2
    v_lshrrev_b32 v49, 1, v48
L_pi_84:
    buffer_load_dword v48, v48, s[8:11], 0 offen
    buffer_load_ushort v49, v49, s[8:11], s31 offen
    s_cmp_eq_u64 s[20:21], 0
    s_cbranch_scc1 L_pr_86
L_pb_85:
    s_ff1_i32_b64 s27, s[20:21]
    s_bitset0_b64 s[20:21], s27
    v_readlane_b32 s43, v9, s27
    s_lshr_b32 s25, s43, 6
    s_bfm_b64 exec, s43, 0
    v_add_lshl_u32 v50, s25, v1, 2
    v_lshrrev_b32 v51, 1, v50
L_pi_88:
    buffer_load_dword v50, v50, s[8:11], 0 offen
    buffer_load_ushort v51, v51, s[8:11], s31 offen
    s_cmp_le_u32 s22, 12
    s_cbranch_scc1 L_pe_91
    s_cmp_eq_u64 s[20:21], 0
    s_cbranch_scc1 L_pr_90
L_pb_89:
    s_ff1_i32_b64 s27, s[20:21]
    s_bitset0_b64 s[20:21], s27
    v_readlane_b32 s44, v9, s27
    s_lshr_b32 s25, s44, 6
    s_bfm_b64 exec, s44, 0
    v_add_lshl_u32 v52, s25, v1, 2
    v_lshrrev_b32 v53, 1, v52
L_pi_92:
    buffer_load_dword v52, v52, s[8:11], 0 offen
    buffer_load_ushort v53, v53, s[8:11], s31 offen
    s_cmp_le_u32 s22, 13
    s_cbranch_scc1 L_pe_95
    s_cmp_eq_u64 s[20:21], 0
    s_cbranch_scc1 L_pr_94
L_pb_93:
    s_ff1_i32_b64 s27, s[20:21]
    s_bitset0_b64 s[20:21], s27
    v_readlane_b32 s45, v9, s27
    s_lshr_b32 s25, s45, 6
    s_bfm_b64 exec, s45, 0
    v_add_lshl_u32 v54, s25, v1, 2
    v_lshrrev_b32 v55, 1, v54
L_pi_96:
    buffer_load_dword v54, v54, s[8:11], 0 offen
    buffer_load_ushort v55, v55, s[8:11], s31 offen
    s_cmp_le_u32 s22, 14
    s_cbranch_scc1 L_pe_99
    s_cmp_eq_u64 s[20:21], 0
    s_cbranch_scc1 L_pr_98
L_pb_97:
    s_ff1_i32_b64 s27, s[20:21]
    s_bitset0_b64 s[20:21], s27
    v_readlane_b32 s46, v9, s27
    s_lshr_b32 s25, s46, 6
    s_bfm_b64 exec, s46, 0
    v_add_lshl_u32 v56, s25, v1, 2
    v_lshrrev_b32 v57, 1, v56
L_pi_100:
    buffer_load_dword v56, v56, s[8:11], 0 offen
    buffer_load_ushort v57, v57, s[8:11], s31 offen
    s_mov_b64 exec, -1
    s_nop 1
    v_add_u32_dpp v12, v12, v12 row_shr:1 row_mask:0xf bank_mask:0xf
    s_nop 1
    v_add_u32_dpp v12, v12, v12 row_shr:2 row_mask:0xf bank_mask:0xf
    s_nop 1
    v_add_u32_dpp v12, v12, v12 row_shr:4 row_mask:0xf bank_mask:0xf
    s_nop 1
    v_add_u32_dpp v12, v12, v12 row_shr:8 row_mask:0xf bank_mask:0xf
    s_nop 1
    v_add_u32_dpp v12, v12, v12 row_bcast:15 row_mask:0xa bank_mask:0xf
    s_nop 1
    v_add_u32_dpp v12, v12, v12 row_bcast:31 row_mask:0xc bank_mask:0xf
    v_mov_b32 v13, s23
    s_waitcnt lgkmcnt(0)
    s_barrier
    s_lshl_b64 exec, 1, 63
    ds_max_u32 v10, v13 offset:2048
    ds_add_u32 v10, v12 offset:2052
    s_mov_b64 exec, -1
    s_waitcnt vmcnt(30)
    v_max3_u32 v88, v88, v89, v90
    v_max_u32 v88, v88, v91
    s_nop 1
    v_max_u32_dpp v88, v88, v88 row_shr:1 row_mask:0xf bank_mask:0xf
    s_nop 1
    v_max_u32_dpp v88, v88, v88 row_shr:2 row_mask:0xf bank_mask:0xf
    s_nop 1
    v_max_u32_dpp v88, v88, v88 row_shr:4 row_mask:0xf bank_mask:0xf
    s_nop 1
    v_max_u32_dpp v88, v88, v88 row_shr:8 row_mask:0xf bank_mask:0xf
    s_nop 1
    v_max_u32_dpp v88, v88, v88 row_bcast:15 row_mask:0xa bank_mask:0xf
    s_nop 1
    v_max_u32_dpp v88, v88, v88 row_bcast:31 row_mask:0xc bank_mask:0xf
    s_nop 0
    v_readlane_b32 s25, v88, 63
    s_nop 3
    s_max_u32 s25, s25, 2176
    s_lshl_b32 s25, s25, 16
    v_rcp_f32 v12, s25
    s_nop 0
    v_mul_f32 v12, 0x467f0000, v12
    v_lshlrev_b32 v14, 16, v16
    v_and_b32 v15, 0xffff0000, v16
    v_mul_f32 v14, v12, v14
    v_mul_f32 v15, v12, v15
    v_cvt_pk_f16_f32 v16, v14, v15
    v_lshlrev_b32 v14, 16, v17
    v_and_b32 v15, 0xffff0000, v17
    v_mul_f32 v14, v12, v14
    v_mul_f32 v15, v12, v15
    v_cvt_pk_f16_f32 v17, v14, v15
    v_lshlrev_b32 v14, 16, v18
    v_and_b32 v15, 0xffff0000, v18
    v_mul_f32 v14, v12, v14
    v_mul_f32 v15, v12, v15
    v_cvt_pk_f16_f32 v18, v14, v15
    v_lshlrev_b32 v14, 16, v19
    v_and_b32 v15, 0xffff0000, v19
    v_mul_f32 v14, v12, v14
    v_mul_f32 v15, v12, v15
    v_cvt_pk_f16_f32 v19, v14, v15
    v_lshlrev_b32 v14, 16, v20
    v_and_b32 v15, 0xffff0000, v20
    v_mul_f32 v14, v12, v14
    v_mul_f32 v15, v12, v15
    v_cvt_pk_f16_f32 v20, v14, v15
    v_lshlrev_b32 v14, 16, v21
    v_and_b32 v15, 0xffff0000, v21
    v_mul_f32 v14, v12, v14
    v_mul_f32 v15, v12, v15
    v_cvt_pk_f16_f32 v21, v14, v15
    v_lshlrev_b32 v14, 16, v22
    v_and_b32 v15, 0xffff0000, v22
    v_mul_f32 v14, v12, v14
    v_mul_f32 v15, v12, v15
    v_cvt_pk_f16_f32 v22, v14, v15
    v_lshlrev_b32 v14, 16, v23
    v_and_b32 v15, 0xffff0000, v23
    v_mul_f32 v14, v12, v14
    v_mul_f32 v15, v12, v15
    v_cvt_pk_f16_f32 v23, v14, v15
    ds_write_b128 v24, v[16:19] offset:4096
    ds_write_b128 v25, v[20:23] offset:4096
    s_waitcnt lgkmcnt(0)
    s_barrier
    ds_read_b64 v[12:13], v10 offset:2048
    s_waitcnt lgkmcnt(0)
    v_readfirstlane_b32 s23, v12
    v_readfirstlane_b32 s28, v13
    s_nop 3
    s_max_u32 s23, s23, 5
    s_mul_i32 s25, s4, 14592
    s_add_u32 s28, s28, s25
    s_add_u32 s28, s28, 15
    s_and_b32 s28, s28, -16
    s_mov_b32 s24, 0
    s_mov_b32 s29, 0
    s_mov_b32 s64, 98174976
    s_waitcnt vmcnt(20)
    s_bfm_b64 exec, s32, 0
    v_lshrrev_b32 v88, 17, v28
    v_and_b32 v88, 0x7ff8, v88
    ds_read_b64 v[88:89], v88 offset:4096
    s_bfm_b64 exec, s33, 0
    v_lshrrev_b32 v90, 17, v30
    v_and_b32 v90, 0x7ff8, v90
    ds_read_b64 v[90:91], v90 offset:4096
    s_bfm_b64 exec, s34, 0
    v_lshrrev_b32 v92, 17, v32
    v_and_b32 v92, 0x7ff8, v92
    ds_read_b64 v[92:93], v92 offset:4096
    s_bfm_b64 exec, s35, 0
    v_lshrrev_b32 v94, 17, v34
    v_and_b32 v94, 0x7ff8, v94
    ds_read_b64 v[94:95], v94 offset:4096
    s_bfm_b64 exec, s36, 0
    v_lshrrev_b32 v96, 17, v36
    v_and_b32 v96, 0x7ff8, v96
    ds_read_b64 v[96:97], v96 offset:4096
    s_cmp_eq_u64 s[20:21], 0
    s_cbranch_scc1 L_pr_102
L_pb_101:
    s_ff1_i32_b64 s27, s[20:21]
    s_bitset0_b64 s[20:21], s27
    v_readlane_b32 s48, v9, s27
    s_lshr_b32 s25, s48, 6
    s_bfm_b64 exec, s48, 0
    v_add_lshl_u32 v58, s25, v1, 2
    v_lshrrev_b32 v59, 1, v58
L_pi_104:
    buffer_load_dword v58, v58, s[8:11], 0 offen
    buffer_load_ushort v59, v59, s[8:11], s31 offen
    s_cmp_eq_u64 s[20:21], 0
    s_cbranch_scc1 L_pr_106
L_pb_105:
    s_ff1_i32_b64 s27, s[20:21]
    s_bitset0_b64 s[20:21], s27
    v_readlane_b32 s49, v9, s27
    s_lshr_b32 s25, s49, 6
    s_bfm_b64 exec, s49, 0
    v_add_lshl_u32 v60, s25, v1, 2
    v_lshrrev_b32 v61, 1, v60
L_pi_108:
    buffer_load_dword v60, v60, s[8:11], 0 offen
    buffer_load_ushort v61, v61, s[8:11], s31 offen
    s_cmp_eq_u64 s[20:21], 0
    s_cbranch_scc1 L_pr_110
L_pb_109:
    s_ff1_i32_b64 s27, s[20:21]
    s_bitset0_b64 s[20:21], s27
    v_readlane_b32 s50, v9, s27
    s_lshr_b32 s25, s50, 6
    s_bfm_b64 exec, s50, 0
    v_add_lshl_u32 v62, s25, v1, 2
    v_lshrrev_b32 v63, 1, v62
L_pi_112:
    buffer_load_dword v62, v62, s[8:11], 0 offen
    buffer_load_ushort v63, v63, s[8:11], s31 offen
    s_cmp_eq_u64 s[20:21], 0
    s_cbranch_scc1 L_pr_114
L_pb_113:
    s_ff1_i32_b64 s27, s[20:21]
    s_bitset0_b64 s[20:21], s27
    v_readlane_b32 s51, v9, s27
    s_lshr_b32 s25, s51, 6
    s_bfm_b64 exec, s51, 0
    v_add_lshl_u32 v64, s25, v1, 2
    v_lshrrev_b32 v65, 1, v64
L_pi_116:
    buffer_load_dword v64, v64, s[8:11], 0 offen
    buffer_load_ushort v65, v65, s[8:11], s31 offen
    s_cmp_eq_u64 s[20:21], 0
    s_cbranch_scc1 L_pr_118
L_pb_117:
    s_ff1_i32_b64 s27, s[20:21]
    s_bitset0_b64 s[20:21], s27
    v_readlane_b32 s52, v9, s27
    s_lshr_b32 s25, s52, 6
    s_bfm_b64 exec, s52, 0
    v_add_lshl_u32 v66, s25, v1, 2
    v_lshrrev_b32 v67, 1, v66
L_pi_120:
    buffer_load_dword v66, v66, s[8:11], 0 offen
    buffer_load_ushort v67, v67, s[8:11], s31 offen
    s_waitcnt vmcnt(20)
    s_bfm_b64 exec, s37, 0
    v_lshrrev_b32 v98, 17, v38
    v_and_b32 v98, 0x7ff8, v98
    ds_read_b64 v[98:99], v98 offset:4096
    s_bfm_b64 exec, s38, 0
    v_lshrrev_b32 v100, 17, v40
    v_and_b32 v100, 0x7ff8, v100
    ds_read_b64 v[100:101], v100 offset:4096
    s_bfm_b64 exec, s39, 0
    v_lshrrev_b32 v102, 17, v42
    v_and_b32 v102, 0x7ff8, v102
    ds_read_b64 v[102:103], v102 offset:4096
    s_bfm_b64 exec, s40, 0
    v_lshrrev_b32 v104, 17, v44
    v_and_b32 v104, 0x7ff8, v104
    ds_read_b64 v[104:105], v104 offset:4096
    s_bfm_b64 exec, s41, 0
    v_lshrrev_b32 v106, 17, v46
    v_and_b32 v106, 0x7ff8, v106
    ds_read_b64 v[106:107], v106 offset:4096
    s_cmp_eq_u64 s[20:21], 0
    s_cbranch_scc1 L_pr_122
L_pb_121:
    s_ff1_i32_b64 s27, s[20:21]
    s_bitset0_b64 s[20:21], s27
    v_readlane_b32 s53, v9, s27
    s_lshr_b32 s25, s53, 6
    s_bfm_b64 exec, s53, 0
    v_add_lshl_u32 v68, s25, v1, 2
    v_lshrrev_b32 v69, 1, v68
L_pi_124:
    buffer_load_dword v68, v68, s[8:11], 0 offen
    buffer_load_ushort v69, v69, s[8:11], s31 offen
    s_cmp_eq_u64 s[20:21], 0
    s_cbranch_scc1 L_pr_126
L_pb_125:
    s_ff1_i32_b64 s27, s[20:21]
    s_bitset0_b64 s[20:21], s27
    v_readlane_b32 s54, v9, s27
    s_lshr_b32 s25, s54, 6
    s_bfm_b64 exec, s54, 0
    v_add_lshl_u32 v70, s25, v1, 2
    v_lshrrev_b32 v71, 1, v70
L_pi_128:
    buffer_load_dword v70, v70, s[8:11], 0 offen
    buffer_load_ushort v71, v71, s[8:11], s31 offen
    s_cmp_eq_u64 s[20:21], 0
    s_cbranch_scc1 L_pr_130
L_pb_129:
    s_ff1_i32_b64 s27, s[20:21]
    s_bitset0_b64 s[20:21], s27
    v_readlane_b32 s55, v9, s27
    s_lshr_b32 s25, s55, 6
    s_bfm_b64 exec, s55, 0
    v_add_lshl_u32 v72, s25, v1, 2
    v_lshrrev_b32 v73, 1, v72
L_pi_132:
    buffer_load_dword v72, v72, s[8:11], 0 offen
    buffer_load_ushort v73, v73, s[8:11], s31 offen
    s_cmp_eq_u64 s[20:21], 0
    s_cbranch_scc1 L_pr_134
L_pb_133:
    s_ff1_i32_b64 s27, s[20:21]
    s_bitset0_b64 s[20:21], s27
    v_readlane_b32 s56, v9, s27
    s_lshr_b32 s25, s56, 6
    s_bfm_b64 exec, s56, 0
    v_add_lshl_u32 v74, s25, v1, 2
    v_lshrrev_b32 v75, 1, v74
L_pi_136:
    buffer_load_dword v74, v74, s[8:11], 0 offen
    buffer_load_ushort v75, v75, s[8:11], s31 offen
    s_cmp_eq_u64 s[20:21], 0
    s_cbranch_scc1 L_pr_138
L_pb_137:
    s_ff1_i32_b64 s27, s[20:21]
    s_bitset0_b64 s[20:21], s27
    v_readlane_b32 s57, v9, s27
    s_lshr_b32 s25, s57, 6
    s_bfm_b64 exec, s57, 0
    v_add_lshl_u32 v76, s25, v1, 2
    v_lshrrev_b32 v77, 1, v76
L_pi_140:
    buffer_load_dword v76, v76, s[8:11], 0 offen
    buffer_load_ushort v77, v77, s[8:11], s31 offen
    s_waitcnt lgkmcnt(5)
    s_bfm_b64 exec, s32, 0
    v_fma_mix_f32 v12, v88, v29, s16 op_sel_hi:[1,1,0]
    v_fma_mix_f32 v13, v88, v29, s16 op_sel:[1,0,0] op_sel_hi:[1,1,0]
    v_fma_mix_f32 v14, v89, v29, s16 op_sel_hi:[1,1,0]
    v_fma_mix_f32 v15, v89, v29, s16 op_sel:[1,0,0] op_sel_hi:[1,1,0]
    v_and_b32 v29, 0xfffff, v28
    v_lshl_add_u32 v88, v13, 13, v12
    v_mul_hi_u32_u24 v29, s17, v29
    v_lshl_add_u32 v89, v15, 13, v14
    v_lshrrev_b32 v12, 6, v28
    v_lshl_add_u32 v88, v28, 26, v88
    v_and_b32 v28, 0x3fc, v29
    v_lshl_add_u32 v89, v12, 26, v89
    ds_add_rtn_u32 v29, v28, v6 offset:0
    s_bfm_b64 exec, s33, 0
    v_fma_mix_f32 v12, v90, v31, s16 op_sel_hi:[1,1,0]
    v_fma_mix_f32 v13, v90, v31, s16 op_sel:[1,0,0] op_sel_hi:[1,1,0]
    v_fma_mix_f32 v14, v91, v31, s16 op_sel_hi:[1,1,0]
    v_fma_mix_f32 v15, v91, v31, s16 op_sel:[1,0,0] op_sel_hi:[1,1,0]
    v_and_b32 v31, 0xfffff, v30
    v_lshl_add_u32 v90, v13, 13, v12
    v_mul_hi_u32_u24 v31, s17, v31
    v_lshl_add_u32 v91, v15, 13, v14
    v_lshrrev_b32 v12, 6, v30
    v_lshl_add_u32 v90, v30, 26, v90
    v_and_b32 v30, 0x3fc, v31
    v_lshl_add_u32 v91, v12, 26, v91
    ds_add_rtn_u32 v31, v30, v6 offset:0
    s_bfm_b64 exec, s34, 0
    v_fma_mix_f32 v12, v92, v33, s16 op_sel_hi:[1,1,0]
    v_fma_mix_f32 v13, v92, v33, s16 op_sel:[1,0,0] op_sel_hi:[1,1,0]
    v_fma_mix_f32 v14, v93, v33, s16 op_sel_hi:[1,1,0]
    v_fma_mix_f32 v15, v93, v33, s16 op_sel:[1,0,0] op_sel_hi:[1,1,0]
    v_and_b32 v33, 0xfffff, v32
    v_lshl_add_u32 v92, v13, 13, v12
    v_mul_hi_u32_u24 v33, s17, v33
    v_lshl_add_u32 v93, v15, 13, v14
    v_lshrrev_b32 v12, 6, v32
    v_lshl_add_u32 v92, v32, 26, v92
    v_and_b32 v32, 0x3fc, v33
    v_lshl_add_u32 v93, v12, 26, v93
    ds_add_rtn_u32 v33, v32, v6 offset:0
    s_bfm_b64 exec, s35, 0
    v_fma_mix_f32 v12, v94, v35, s16 op_sel_hi:[1,1,0]
    v_fma_mix_f32 v13, v94, v35, s16 op_sel:[1,0,0] op_sel_hi:[1,1,0]
    v_fma_mix_f32 v14, v95, v35, s16 op_sel_hi:[1,1,0]
    v_fma_mix_f32 v15, v95, v35, s16 op_sel:[1,0,0] op_sel_hi:[1,1,0]
    v_and_b32 v35, 0xfffff, v34
    v_lshl_add_u32 v94, v13, 13, v12
    v_mul_hi_u32_u24 v35, s17, v35
    v_lshl_add_u32 v95, v15, 13, v14
    v_lshrrev_b32 v12, 6, v34
    v_lshl_add_u32 v94, v34, 26, v94
    v_and_b32 v34, 0x3fc, v35
    v_lshl_add_u32 v95, v12, 26, v95
    ds_add_rtn_u32 v35, v34, v6 offset:0
    s_bfm_b64 exec, s36, 0
    v_fma_mix_f32 v12, v96, v37, s16 op_sel_hi:[1,1,0]
    v_fma_mix_f32 v13, v96, v37, s16 op_sel:[1,0,0] op_sel_hi:[1,1,0]
    v_fma_mix_f32 v14, v97, v37, s16 op_sel_hi:[1,1,0]
    v_fma_mix_f32 v15, v97, v37, s16 op_sel:[1,0,0] op_sel_hi:[1,1,0]
    v_and_b32 v37, 0xfffff, v36
    v_lshl_add_u32 v96, v13, 13, v12
    v_mul_hi_u32_u24 v37, s17, v37
    v_lshl_add_u32 v97, v15, 13, v14
    v_lshrrev_b32 v12, 6, v36
    v_lshl_add_u32 v96, v36, 26, v96
    v_and_b32 v36, 0x3fc, v37
    v_lshl_add_u32 v97, v12, 26, v97
    ds_add_rtn_u32 v37, v36, v6 offset:0
    s_waitcnt vmcnt(20)
    s_bfm_b64 exec, s42, 0
    v_lshrrev_b32 v108, 17, v48
    v_and_b32 v108, 0x7ff8, v108
    ds_read_b64 v[108:109], v108 offset:4096
    s_bfm_b64 exec, s43, 0
    v_lshrrev_b32 v110, 17, v50
    v_and_b32 v110, 0x7ff8, v110
    ds_read_b64 v[110:111], v110 offset:4096
    s_bfm_b64 exec, s44, 0
    v_lshrrev_b32 v112, 17, v52
    v_and_b32 v112, 0x7ff8, v112
    ds_read_b64 v[112:113], v112 offset:4096
    s_bfm_b64 exec, s45, 0
    v_lshrrev_b32 v114, 17, v54
    v_and_b32 v114, 0x7ff8, v114
    ds_read_b64 v[114:115], v114 offset:4096
    s_bfm_b64 exec, s46, 0
    v_lshrrev_b32 v116, 17, v56
    v_and_b32 v116, 0x7ff8, v116
    ds_read_b64 v[116:117], v116 offset:4096
    s_cmp_eq_u64 s[20:21], 0
    s_cbranch_scc1 L_pr_142
L_pb_141:
    s_ff1_i32_b64 s27, s[20:21]
    s_bitset0_b64 s[20:21], s27
    v_readlane_b32 s58, v9, s27
    s_lshr_b32 s25, s58, 6
    s_bfm_b64 exec, s58, 0
    v_add_lshl_u32 v78, s25, v1, 2
    v_lshrrev_b32 v79, 1, v78
L_pi_144:
    buffer_load_dword v78, v78, s[8:11], 0 offen
    buffer_load_ushort v79, v79, s[8:11], s31 offen
    s_cmp_eq_u64 s[20:21], 0
    s_cbranch_scc1 L_pr_146
L_pb_145:
    s_ff1_i32_b64 s27, s[20:21]
    s_bitset0_b64 s[20:21], s27
    v_readlane_b32 s59, v9, s27
    s_lshr_b32 s25, s59, 6
    s_bfm_b64 exec, s59, 0
    v_add_lshl_u32 v80, s25, v1, 2
    v_lshrrev_b32 v81, 1, v80
L_pi_148:
    buffer_load_dword v80, v80, s[8:11], 0 offen
    buffer_load_ushort v81, v81, s[8:11], s31 offen
    s_cmp_le_u32 s22, 12
    s_cbranch_scc1 L_pe_151
    s_cmp_eq_u64 s[20:21], 0
    s_cbranch_scc1 L_pr_150
L_pb_149:
    s_ff1_i32_b64 s27, s[20:21]
    s_bitset0_b64 s[20:21], s27
    v_readlane_b32 s60, v9, s27
    s_lshr_b32 s25, s60, 6
    s_bfm_b64 exec, s60, 0
    v_add_lshl_u32 v82, s25, v1, 2
    v_lshrrev_b32 v83, 1, v82
L_pi_152:
    buffer_load_dword v82, v82, s[8:11], 0 offen
    buffer_load_ushort v83, v83, s[8:11], s31 offen
    s_cmp_le_u32 s22, 13
    s_cbranch_scc1 L_pe_155
    s_cmp_eq_u64 s[20:21], 0
    s_cbranch_scc1 L_pr_154
L_pb_153:
    s_ff1_i32_b64 s27, s[20:21]
    s_bitset0_b64 s[20:21], s27
    v_readlane_b32 s61, v9, s27
    s_lshr_b32 s25, s61, 6
    s_bfm_b64 exec, s61, 0
    v_add_lshl_u32 v84, s25, v1, 2
    v_lshrrev_b32 v85, 1, v84
L_pi_156:
    buffer_load_dword v84, v84, s[8:11], 0 offen
    buffer_load_ushort v85, v85, s[8:11], s31 offen
    s_cmp_le_u32 s22, 14
    s_cbranch_scc1 L_pe_159
    s_cmp_eq_u64 s[20:21], 0
    s_cbranch_scc1 L_pr_158
L_pb_157:
    s_ff1_i32_b64 s27, s[20:21]
    s_bitset0_b64 s[20:21], s27
    v_readlane_b32 s62, v9, s27
    s_lshr_b32 s25, s62, 6
    s_bfm_b64 exec, s62, 0
    v_add_lshl_u32 v86, s25, v1, 2
    v_lshrrev_b32 v87, 1, v86
L_pi_160:
    buffer_load_dword v86, v86, s[8:11], 0 offen
    buffer_load_ushort v87, v87, s[8:11], s31 offen
    s_waitcnt lgkmcnt(5)
    s_bfm_b64 exec, s37, 0
    v_fma_mix_f32 v12, v98, v39, s16 op_sel_hi:[1,1,0]
    v_fma_mix_f32 v13, v98, v39, s16 op_sel:[1,0,0] op_sel_hi:[1,1,0]
    v_fma_mix_f32 v14, v99, v39, s16 op_sel_hi:[1,1,0]
    v_fma_mix_f32 v15, v99, v39, s16 op_sel:[1,0,0] op_sel_hi:[1,1,0]
    v_and_b32 v39, 0xfffff, v38
    v_lshl_add_u32 v98, v13, 13, v12
    v_mul_hi_u32_u24 v39, s17, v39
    v_lshl_add_u32 v99, v15, 13, v14
    v_lshrrev_b32 v12, 6, v38
    v_lshl_add_u32 v98, v38, 26, v98
    v_and_b32 v38, 0x3fc, v39
    v_lshl_add_u32 v99, v12, 26, v99
    ds_add_rtn_u32 v39, v38, v6 offset:0
    s_bfm_b64 exec, s38, 0
    v_fma_mix_f32 v12, v100, v41, s16 op_sel_hi:[1,1,0]
    v_fma_mix_f32 v13, v100, v41, s16 op_sel:[1,0,0] op_sel_hi:[1,1,0]
    v_fma_mix_f32 v14, v101, v41, s16 op_sel_hi:[1,1,0]
    v_fma_mix_f32 v15, v101, v41, s16 op_sel:[1,0,0] op_sel_hi:[1,1,0]
    v_and_b32 v41, 0xfffff, v40
    v_lshl_add_u32 v100, v13, 13, v12
    v_mul_hi_u32_u24 v41, s17, v41
    v_lshl_add_u32 v101, v15, 13, v14
    v_lshrrev_b32 v12, 6, v40
    v_lshl_add_u32 v100, v40, 26, v100
    v_and_b32 v40, 0x3fc, v41
    v_lshl_add_u32 v101, v12, 26, v101
    ds_add_rtn_u32 v41, v40, v6 offset:0
    s_bfm_b64 exec, s39, 0
    v_fma_mix_f32 v12, v102, v43, s16 op_sel_hi:[1,1,0]
    v_fma_mix_f32 v13, v102, v43, s16 op_sel:[1,0,0] op_sel_hi:[1,1,0]
    v_fma_mix_f32 v14, v103, v43, s16 op_sel_hi:[1,1,0]
    v_fma_mix_f32 v15, v103, v43, s16 op_sel:[1,0,0] op_sel_hi:[1,1,0]
    v_and_b32 v43, 0xfffff, v42
    v_lshl_add_u32 v102, v13, 13, v12
    v_mul_hi_u32_u24 v43, s17, v43
    v_lshl_add_u32 v103, v15, 13, v14
    v_lshrrev_b32 v12, 6, v42
    v_lshl_add_u32 v102, v42, 26, v102
    v_and_b32 v42, 0x3fc, v43
    v_lshl_add_u32 v103, v12, 26, v103
    ds_add_rtn_u32 v43, v42, v6 offset:0
    s_bfm_b64 exec, s40, 0
    v_fma_mix_f32 v12, v104, v45, s16 op_sel_hi:[1,1,0]
    v_fma_mix_f32 v13, v104, v45, s16 op_sel:[1,0,0] op_sel_hi:[1,1,0]
    v_fma_mix_f32 v14, v105, v45, s16 op_sel_hi:[1,1,0]
    v_fma_mix_f32 v15, v105, v45, s16 op_sel:[1,0,0] op_sel_hi:[1,1,0]
    v_and_b32 v45, 0xfffff, v44
    v_lshl_add_u32 v104, v13, 13, v12
    v_mul_hi_u32_u24 v45, s17, v45
    v_lshl_add_u32 v105, v15, 13, v14
    v_lshrrev_b32 v12, 6, v44
    v_lshl_add_u32 v104, v44, 26, v104
    v_and_b32 v44, 0x3fc, v45
    v_lshl_add_u32 v105, v12, 26, v105
    ds_add_rtn_u32 v45, v44, v6 offset:0
    s_bfm_b64 exec, s41, 0
    v_fma_mix_f32 v12, v106, v47, s16 op_sel_hi:[1,1,0]
    v_fma_mix_f32 v13, v106, v47, s16 op_sel:[1,0,0] op_sel_hi:[1,1,0]
    v_fma_mix_f32 v14, v107, v47, s16 op_sel_hi:[1,1,0]
    v_fma_mix_f32 v15, v107, v47, s16 op_sel:[1,0,0] op_sel_hi:[1,1,0]
    v_and_b32 v47, 0xfffff, v46
    v_lshl_add_u32 v106, v13, 13, v12
    v_mul_hi_u32_u24 v47, s17, v47
    v_lshl_add_u32 v107, v15, 13, v14
    v_lshrrev_b32 v12, 6, v46
    v_lshl_add_u32 v106, v46, 26, v106
    v_and_b32 v46, 0x3fc, v47
    v_lshl_add_u32 v107, v12, 26, v107
    ds_add_rtn_u32 v47, v46, v6 offset:0
    s_waitcnt lgkmcnt(5)
    s_bfm_b64 exec, s42, 0
    v_fma_mix_f32 v12, v108, v49, s16 op_sel_hi:[1,1,0]
    v_fma_mix_f32 v13, v108, v49, s16 op_sel:[1,0,0] op_sel_hi:[1,1,0]
    v_fma_mix_f32 v14, v109, v49, s16 op_sel_hi:[1,1,0]
    v_fma_mix_f32 v15, v109, v49, s16 op_sel:[1,0,0] op_sel_hi:[1,1,0]
    v_and_b32 v49, 0xfffff, v48
    v_lshl_add_u32 v108, v13, 13, v12
    v_mul_hi_u32_u24 v49, s17, v49
    v_lshl_add_u32 v109, v15, 13, v14
    v_lshrrev_b32 v12, 6, v48
    v_lshl_add_u32 v108, v48, 26, v108
    v_and_b32 v48, 0x3fc, v49
    v_lshl_add_u32 v109, v12, 26, v109
    ds_add_rtn_u32 v49, v48, v6 offset:0
    s_bfm_b64 exec, s43, 0
    v_fma_mix_f32 v12, v110, v51, s16 op_sel_hi:[1,1,0]
    v_fma_mix_f32 v13, v110, v51, s16 op_sel:[1,0,0] op_sel_hi:[1,1,0]
    v_fma_mix_f32 v14, v111, v51, s16 op_sel_hi:[1,1,0]
    v_fma_mix_f32 v15, v111, v51, s16 op_sel:[1,0,0] op_sel_hi:[1,1,0]
    v_and_b32 v51, 0xfffff, v50
    v_lshl_add_u32 v110, v13, 13, v12
    v_mul_hi_u32_u24 v51, s17, v51
    v_lshl_add_u32 v111, v15, 13, v14
    v_lshrrev_b32 v12, 6, v50
    v_lshl_add_u32 v110, v50, 26, v110
    v_and_b32 v50, 0x3fc, v51
    v_lshl_add_u32 v111, v12, 26, v111
    ds_add_rtn_u32 v51, v50, v6 offset:0
    s_bfm_b64 exec, s44, 0
    v_fma_mix_f32 v12, v112, v53, s16 op_sel_hi:[1,1,0]
    v_fma_mix_f32 v13, v112, v53, s16 op_sel:[1,0,0] op_sel_hi:[1,1,0]
    v_fma_mix_f32 v14, v113, v53, s16 op_sel_hi:[1,1,0]
    v_fma_mix_f32 v15, v113, v53, s16 op_sel:[1,0,0] op_sel_hi:[1,1,0]
    v_and_b32 v53, 0xfffff, v52
    v_lshl_add_u32 v112, v13, 13, v12
    v_mul_hi_u32_u24 v53, s17, v53
    v_lshl_add_u32 v113, v15, 13, v14
    v_lshrrev_b32 v12, 6, v52
    v_lshl_add_u32 v112, v52, 26, v112
    v_and_b32 v52, 0x3fc, v53
    v_lshl_add_u32 v113, v12, 26, v113
    ds_add_rtn_u32 v53, v52, v6 offset:0
    s_bfm_b64 exec, s45, 0
    v_fma_mix_f32 v12, v114, v55, s16 op_sel_hi:[1,1,0]
    v_fma_mix_f32 v13, v114, v55, s16 op_sel:[1,0,0] op_sel_hi:[1,1,0]
    v_fma_mix_f32 v14, v115, v55, s16 op_sel_hi:[1,1,0]
    v_fma_mix_f32 v15, v115, v55, s16 op_sel:[1,0,0] op_sel_hi:[1,1,0]
    v_and_b32 v55, 0xfffff, v54
    v_lshl_add_u32 v114, v13, 13, v12
    v_mul_hi_u32_u24 v55, s17, v55
    v_lshl_add_u32 v115, v15, 13, v14
    v_lshrrev_b32 v12, 6, v54
    v_lshl_add_u32 v114, v54, 26, v114
    v_and_b32 v54, 0x3fc, v55
    v_lshl_add_u32 v115, v12, 26, v115
    ds_add_rtn_u32 v55, v54, v6 offset:0
    s_bfm_b64 exec, s46, 0
    v_fma_mix_f32 v12, v116, v57, s16 op_sel_hi:[1,1,0]
    v_fma_mix_f32 v13, v116, v57, s16 op_sel:[1,0,0] op_sel_hi:[1,1,0]
    v_fma_mix_f32 v14, v117, v57, s16 op_sel_hi:[1,1,0]
    v_fma_mix_f32 v15, v117, v57, s16 op_sel:[1,0,0] op_sel_hi:[1,1,0]
    v_and_b32 v57, 0xfffff, v56
    v_lshl_add_u32 v116, v13, 13, v12
    v_mul_hi_u32_u24 v57, s17, v57
    v_lshl_add_u32 v117, v15, 13, v14
    v_lshrrev_b32 v12, 6, v56
    v_lshl_add_u32 v116, v56, 26, v116
    v_and_b32 v56, 0x3fc, v57
    v_lshl_add_u32 v117, v12, 26, v117
    ds_add_rtn_u32 v57, v56, v6 offset:0
    s_mov_b64 exec, -1
    s_waitcnt lgkmcnt(0)
    s_barrier
    s_branch L_k2_afterh
L_k2_loop:
    s_setprio 3
    s_mov_b64 exec, -1
    s_sub_i32 s25, s29, 0
    v_cmp_gt_i32 s[66:67], s25, v5
    s_sub_i32 s25, s29, 2048
    v_cmp_gt_i32 s[68:69], s25, v5
    s_sub_i32 s25, s29, 4096
    v_cmp_gt_i32 s[70:71], s25, v5
    s_mov_b64 exec, s[66:67]
    ds_read_b128 v[16:19], v3 offset:0
    s_mov_b64 exec, s[68:69]
    ds_read_b128 v[20:23], v3 offset:16384
    s_mov_b64 exec, s[70:71]
    ds_read_b128 v[24:27], v3 offset:32768
    s_cmp_lg_u32 s19, 0
    s_cbranch_scc1 L_hw0_162
    s_waitcnt vmcnt(30)
L_hw1_163:
    s_bfm_b64 exec, s32, 0
    v_lshrrev_b32 v88, 17, v28
    v_and_b32 v88, 0x7ff8, v88
    ds_read_b64 v[88:89], v88 offset:4096
    s_bfm_b64 exec, s33, 0
    v_lshrrev_b32 v90, 17, v30
    v_and_b32 v90, 0x7ff8, v90
    ds_read_b64 v[90:91], v90 offset:4096
    s_bfm_b64 exec, s34, 0
    v_lshrrev_b32 v92, 17, v32
    v_and_b32 v92, 0x7ff8, v92
    ds_read_b64 v[92:93], v92 offset:4096
    s_bfm_b64 exec, s35, 0
    v_lshrrev_b32 v94, 17, v34
    v_and_b32 v94, 0x7ff8, v94
    ds_read_b64 v[94:95], v94 offset:4096
    s_bfm_b64 exec, s36, 0
    v_lshrrev_b32 v96, 17, v36
    v_and_b32 v96, 0x7ff8, v96
    ds_read_b64 v[96:97], v96 offset:4096
    s_cmp_eq_u32 s37, 0
    s_cbranch_scc1 L_hs_164
    s_bfm_b64 exec, s37, 0
    v_lshrrev_b32 v98, 17, v38
    v_and_b32 v98, 0x7ff8, v98
    ds_read_b64 v[98:99], v98 offset:4096
    s_bfm_b64 exec, s38, 0
    v_lshrrev_b32 v100, 17, v40
    v_and_b32 v100, 0x7ff8, v100
    ds_read_b64 v[100:101], v100 offset:4096
    s_bfm_b64 exec, s39, 0
    v_lshrrev_b32 v102, 17, v42
    v_and_b32 v102, 0x7ff8, v102
    ds_read_b64 v[102:103], v102 offset:4096
    s_bfm_b64 exec, s40, 0
    v_lshrrev_b32 v104, 17, v44
    v_and_b32 v104, 0x7ff8, v104
    ds_read_b64 v[104:105], v104 offset:4096
    s_bfm_b64 exec, s41, 0
    v_lshrrev_b32 v106, 17, v46
    v_and_b32 v106, 0x7ff8, v106
    ds_read_b64 v[106:107], v106 offset:4096
    s_waitcnt lgkmcnt(5)
    s_mov_b64 exec, s[66:67]
    s_cbranch_execz L_cs_165
    s_add_u32 s25, s64, 0
    buffer_store_dwordx4 v[16:19], v2, s[8:11], s25 offen sc0 sc1
L_cs_165:
    s_mov_b64 exec, s[68:69]
    s_cbranch_execz L_cs_166
    s_add_u32 s25, s64, 16384
    buffer_store_dwordx4 v[20:23], v2, s[8:11], s25 offen sc0 sc1
L_cs_166:
    s_mov_b64 exec, s[70:71]
    s_cbranch_execz L_cs_167
    s_add_u32 s25, s64, 32768
    buffer_store_dwordx4 v[24:27], v2, s[8:11], s25 offen sc0 sc1
L_cs_167:
    s_mov_b64 exec, -1
    s_sub_i32 s25, s29, 6144
    v_cmp_gt_i32 s[66:67], s25, v5
    s_sub_i32 s25, s29, 8192
    v_cmp_gt_i32 s[68:69], s25, v5
    s_sub_i32 s25, s29, 10240
    v_cmp_gt_i32 s[70:71], s25, v5
    s_mov_b64 exec, s[66:67]
    ds_read_b128 v[16:19], v3 offset:49152
    s_mov_b64 exec, s[68:69]
    ds_read_b128 v[20:23], v4 offset:0
    s_mov_b64 exec, s[70:71]
    ds_read_b128 v[24:27], v4 offset:16384
    s_bfm_b64 exec, s32, 0
    v_fma_mix_f32 v12, v88, v29, s16 op_sel_hi:[1,1,0]
    v_fma_mix_f32 v13, v88, v29, s16 op_sel:[1,0,0] op_sel_hi:[1,1,0]
    v_fma_mix_f32 v14, v89, v29, s16 op_sel_hi:[1,1,0]
    v_fma_mix_f32 v15, v89, v29, s16 op_sel:[1,0,0] op_sel_hi:[1,1,0]
    v_and_b32 v29, 0xfffff, v28
    v_lshl_add_u32 v88, v13, 13, v12
    v_mul_hi_u32_u24 v29, s17, v29
    v_lshl_add_u32 v89, v15, 13, v14
    v_lshrrev_b32 v12, 6, v28
    v_lshl_add_u32 v88, v28, 26, v88
    v_and_b32 v28, 0x3fc, v29
    v_lshl_add_u32 v89, v12, 26, v89
    ds_add_rtn_u32 v29, v28, v6 offset:0
    s_bfm_b64 exec, s33, 0
    v_fma_mix_f32 v12, v90, v31, s16 op_sel_hi:[1,1,0]
    v_fma_mix_f32 v13, v90, v31, s16 op_sel:[1,0,0] op_sel_hi:[1,1,0]
    v_fma_mix_f32 v14, v91, v31, s16 op_sel_hi:[1,1,0]
    v_fma_mix_f32 v15, v91, v31, s16 op_sel:[1,0,0] op_sel_hi:[1,1,0]
    v_and_b32 v31, 0xfffff, v30
    v_lshl_add_u32 v90, v13, 13, v12
    v_mul_hi_u32_u24 v31, s17, v31
    v_lshl_add_u32 v91, v15, 13, v14
    v_lshrrev_b32 v12, 6, v30
    v_lshl_add_u32 v90, v30, 26, v90
    v_and_b32 v30, 0x3fc, v31
    v_lshl_add_u32 v91, v12, 26, v91
    ds_add_rtn_u32 v31, v30, v6 offset:0
    s_bfm_b64 exec, s34, 0
    v_fma_mix_f32 v12, v92, v33, s16 op_sel_hi:[1,1,0]
    v_fma_mix_f32 v13, v92, v33, s16 op_sel:[1,0,0] op_sel_hi:[1,1,0]
    v_fma_mix_f32 v14, v93, v33, s16 op_sel_hi:[1,1,0]
    v_fma_mix_f32 v15, v93, v33, s16 op_sel:[1,0,0] op_sel_hi:[1,1,0]
    v_and_b32 v33, 0xfffff, v32
    v_lshl_add_u32 v92, v13, 13, v12
    v_mul_hi_u32_u24 v33, s17, v33
    v_lshl_add_u32 v93, v15, 13, v14
    v_lshrrev_b32 v12, 6, v32
    v_lshl_add_u32 v92, v32, 26, v92
    v_and_b32 v32, 0x3fc, v33
    v_lshl_add_u32 v93, v12, 26, v93
    ds_add_rtn_u32 v33, v32, v6 offset:0
    s_bfm_b64 exec, s35, 0
    v_fma_mix_f32 v12, v94, v35, s16 op_sel_hi:[1,1,0]
    v_fma_mix_f32 v13, v94, v35, s16 op_sel:[1,0,0] op_sel_hi:[1,1,0]
    v_fma_mix_f32 v14, v95, v35, s16 op_sel_hi:[1,1,0]
    v_fma_mix_f32 v15, v95, v35, s16 op_sel:[1,0,0] op_sel_hi:[1,1,0]
    v_and_b32 v35, 0xfffff, v34
    v_lshl_add_u32 v94, v13, 13, v12
    v_mul_hi_u32_u24 v35, s17, v35
    v_lshl_add_u32 v95, v15, 13, v14
    v_lshrrev_b32 v12, 6, v34
    v_lshl_add_u32 v94, v34, 26, v94
    v_and_b32 v34, 0x3fc, v35
    v_lshl_add_u32 v95, v12, 26, v95
    ds_add_rtn_u32 v35, v34, v6 offset:0
    s_bfm_b64 exec, s36, 0
    v_fma_mix_f32 v12, v96, v37, s16 op_sel_hi:[1,1,0]
    v_fma_mix_f32 v13, v96, v37, s16 op_sel:[1,0,0] op_sel_hi:[1,1,0]
    v_fma_mix_f32 v14, v97, v37, s16 op_sel_hi:[1,1,0]
    v_fma_mix_f32 v15, v97, v37, s16 op_sel:[1,0,0] op_sel_hi:[1,1,0]
    v_and_b32 v37, 0xfffff, v36
    v_lshl_add_u32 v96, v13, 13, v12
    v_mul_hi_u32_u24 v37, s17, v37
    v_lshl_add_u32 v97, v15, 13, v14
    v_lshrrev_b32 v12, 6, v36
    v_lshl_add_u32 v96, v36, 26, v96
    v_and_b32 v36, 0x3fc, v37
    v_lshl_add_u32 v97, v12, 26, v97
    ds_add_rtn_u32 v37, v36, v6 offset:0
    s_setprio 2
    s_bfm_b64 exec, s42, 0
    v_lshrrev_b32 v108, 17, v48
    v_and_b32 v108, 0x7ff8, v108
    ds_read_b64 v[108:109], v108 offset:4096
    s_bfm_b64 exec, s43, 0
    v_lshrrev_b32 v110, 17, v50
    v_and_b32 v110, 0x7ff8, v110
    ds_read_b64 v[110:111], v110 offset:4096
    s_bfm_b64 exec, s44, 0
    v_lshrrev_b32 v112, 17, v52
    v_and_b32 v112, 0x7ff8, v112
    ds_read_b64 v[112:113], v112 offset:4096
    s_bfm_b64 exec, s45, 0
    v_lshrrev_b32 v114, 17, v54
    v_and_b32 v114, 0x7ff8, v114
    ds_read_b64 v[114:115], v114 offset:4096
    s_waitcnt lgkmcnt(9)
    s_mov_b64 exec, s[66:67]
    s_cbranch_execz L_cs_168
    s_add_u32 s25, s64, 49152
    buffer_store_dwordx4 v[16:19], v2, s[8:11], s25 offen sc0 sc1
L_cs_168:
    s_mov_b64 exec, s[68:69]
    s_cbranch_execz L_cs_169
    s_add_u32 s25, s64, 65536
    buffer_store_dwordx4 v[20:23], v2, s[8:11], s25 offen sc0 sc1
L_cs_169:
    s_mov_b64 exec, s[70:71]
    s_cbranch_execz L_cs_170
    s_add_u32 s25, s64, 81920
    buffer_store_dwordx4 v[24:27], v2, s[8:11], s25 offen sc0 sc1
L_cs_170:
    s_mov_b64 exec, -1
    s_sub_i32 s25, s29, 12288
    v_cmp_gt_i32 s[66:67], s25, v5
    s_sub_i32 s25, s29, 14336
    v_cmp_gt_i32 s[68:69], s25, v5
    s_mov_b64 exec, s[66:67]
    ds_read_b128 v[16:19], v4 offset:32768
    s_mov_b64 exec, s[68:69]
    ds_read_b128 v[20:23], v4 offset:49152
    s_bfm_b64 exec, s37, 0
    v_fma_mix_f32 v12, v98, v39, s16 op_sel_hi:[1,1,0]
    v_fma_mix_f32 v13, v98, v39, s16 op_sel:[1,0,0] op_sel_hi:[1,1,0]
    v_fma_mix_f32 v14, v99, v39, s16 op_sel_hi:[1,1,0]
    v_fma_mix_f32 v15, v99, v39, s16 op_sel:[1,0,0] op_sel_hi:[1,1,0]
    v_and_b32 v39, 0xfffff, v38
    v_lshl_add_u32 v98, v13, 13, v12
    v_mul_hi_u32_u24 v39, s17, v39
    v_lshl_add_u32 v99, v15, 13, v14
    v_lshrrev_b32 v12, 6, v38
    v_lshl_add_u32 v98, v38, 26, v98
    v_and_b32 v38, 0x3fc, v39
    v_lshl_add_u32 v99, v12, 26, v99
    ds_add_rtn_u32 v39, v38, v6 offset:0
    s_bfm_b64 exec, s38, 0
    v_fma_mix_f32 v12, v100, v41, s16 op_sel_hi:[1,1,0]
    v_fma_mix_f32 v13, v100, v41, s16 op_sel:[1,0,0] op_sel_hi:[1,1,0]
    v_fma_mix_f32 v14, v101, v41, s16 op_sel_hi:[1,1,0]
    v_fma_mix_f32 v15, v101, v41, s16 op_sel:[1,0,0] op_sel_hi:[1,1,0]
    v_and_b32 v41, 0xfffff, v40
    v_lshl_add_u32 v100, v13, 13, v12
    v_mul_hi_u32_u24 v41, s17, v41
    v_lshl_add_u32 v101, v15, 13, v14
    v_lshrrev_b32 v12, 6, v40
    v_lshl_add_u32 v100, v40, 26, v100
    v_and_b32 v40, 0x3fc, v41
    v_lshl_add_u32 v101, v12, 26, v101
    ds_add_rtn_u32 v41, v40, v6 offset:0
    s_bfm_b64 exec, s39, 0
    v_fma_mix_f32 v12, v102, v43, s16 op_sel_hi:[1,1,0]
    v_fma_mix_f32 v13, v102, v43, s16 op_sel:[1,0,0] op_sel_hi:[1,1,0]
    v_fma_mix_f32 v14, v103, v43, s16 op_sel_hi:[1,1,0]
    v_fma_mix_f32 v15, v103, v43, s16 op_sel:[1,0,0] op_sel_hi:[1,1,0]
    v_and_b32 v43, 0xfffff, v42
    v_lshl_add_u32 v102, v13, 13, v12
    v_mul_hi_u32_u24 v43, s17, v43
    v_lshl_add_u32 v103, v15, 13, v14
    v_lshrrev_b32 v12, 6, v42
    v_lshl_add_u32 v102, v42, 26, v102
    v_and_b32 v42, 0x3fc, v43
    v_lshl_add_u32 v103, v12, 26, v103
    ds_add_rtn_u32 v43, v42, v6 offset:0
    s_bfm_b64 exec, s40, 0
    v_fma_mix_f32 v12, v104, v45, s16 op_sel_hi:[1,1,0]
    v_fma_mix_f32 v13, v104, v45, s16 op_sel:[1,0,0] op_sel_hi:[1,1,0]
    v_fma_mix_f32 v14, v105, v45, s16 op_sel_hi:[1,1,0]
    v_fma_mix_f32 v15, v105, v45, s16 op_sel:[1,0,0] op_sel_hi:[1,1,0]
    v_and_b32 v45, 0xfffff, v44
    v_lshl_add_u32 v104, v13, 13, v12
    v_mul_hi_u32_u24 v45, s17, v45
    v_lshl_add_u32 v105, v15, 13, v14
    v_lshrrev_b32 v12, 6, v44
    v_lshl_add_u32 v104, v44, 26, v104
    v_and_b32 v44, 0x3fc, v45
    v_lshl_add_u32 v105, v12, 26, v105
    ds_add_rtn_u32 v45, v44, v6 offset:0
    s_bfm_b64 exec, s41, 0
    v_fma_mix_f32 v12, v106, v47, s16 op_sel_hi:[1,1,0]
    v_fma_mix_f32 v13, v106, v47, s16 op_sel:[1,0,0] op_sel_hi:[1,1,0]
    v_fma_mix_f32 v14, v107, v47, s16 op_sel_hi:[1,1,0]
    v_fma_mix_f32 v15, v107, v47, s16 op_sel:[1,0,0] op_sel_hi:[1,1,0]
    v_and_b32 v47, 0xfffff, v46
    v_lshl_add_u32 v106, v13, 13, v12
    v_mul_hi_u32_u24 v47, s17, v47
    v_lshl_add_u32 v107, v15, 13, v14
    v_lshrrev_b32 v12, 6, v46
    v_lshl_add_u32 v106, v46, 26, v106
    v_and_b32 v46, 0x3fc, v47
    v_lshl_add_u32 v107, v12, 26, v107
    ds_add_rtn_u32 v47, v46, v6 offset:0
    s_setprio 1
    s_waitcnt lgkmcnt(5)
    s_mov_b64 exec, s[66:67]
    s_cbranch_execz L_cs_171
    s_add_u32 s25, s64, 98304
    buffer_store_dwordx4 v[16:19], v2, s[8:11], s25 offen sc0 sc1
L_cs_171:
    s_mov_b64 exec, s[68:69]
    s_cbranch_execz L_cs_172
    s_add_u32 s25, s64, 114688
    buffer_store_dwordx4 v[20:23], v2, s[8:11], s25 offen sc0 sc1
L_cs_172:
    s_bfm_b64 exec, s42, 0
    v_fma_mix_f32 v12, v108, v49, s16 op_sel_hi:[1,1,0]
    v_fma_mix_f32 v13, v108, v49, s16 op_sel:[1,0,0] op_sel_hi:[1,1,0]
    v_fma_mix_f32 v14, v109, v49, s16 op_sel_hi:[1,1,0]
    v_fma_mix_f32 v15, v109, v49, s16 op_sel:[1,0,0] op_sel_hi:[1,1,0]
    v_and_b32 v49, 0xfffff, v48
    v_lshl_add_u32 v108, v13, 13, v12
    v_mul_hi_u32_u24 v49, s17, v49
    v_lshl_add_u32 v109, v15, 13, v14
    v_lshrrev_b32 v12, 6, v48
    v_lshl_add_u32 v108, v48, 26, v108
    v_and_b32 v48, 0x3fc, v49
    v_lshl_add_u32 v109, v12, 26, v109
    ds_add_rtn_u32 v49, v48, v6 offset:0
    s_bfm_b64 exec, s43, 0
    v_fma_mix_f32 v12, v110, v51, s16 op_sel_hi:[1,1,0]
    v_fma_mix_f32 v13, v110, v51, s16 op_sel:[1,0,0] op_sel_hi:[1,1,0]
    v_fma_mix_f32 v14, v111, v51, s16 op_sel_hi:[1,1,0]
    v_fma_mix_f32 v15, v111, v51, s16 op_sel:[1,0,0] op_sel_hi:[1,1,0]
    v_and_b32 v51, 0xfffff, v50
    v_lshl_add_u32 v110, v13, 13, v12
    v_mul_hi_u32_u24 v51, s17, v51
    v_lshl_add_u32 v111, v15, 13, v14
    v_lshrrev_b32 v12, 6, v50
    v_lshl_add_u32 v110, v50, 26, v110
    v_and_b32 v50, 0x3fc, v51
    v_lshl_add_u32 v111, v12, 26, v111
    ds_add_rtn_u32 v51, v50, v6 offset:0
    s_bfm_b64 exec, s44, 0
    v_fma_mix_f32 v12, v112, v53, s16 op_sel_hi:[1,1,0]
    v_fma_mix_f32 v13, v112, v53, s16 op_sel:[1,0,0] op_sel_hi:[1,1,0]
    v_fma_mix_f32 v14, v113, v53, s16 op_sel_hi:[1,1,0]
    v_fma_mix_f32 v15, v113, v53, s16 op_sel:[1,0,0] op_sel_hi:[1,1,0]
    v_and_b32 v53, 0xfffff, v52
    v_lshl_add_u32 v112, v13, 13, v12
    v_mul_hi_u32_u24 v53, s17, v53
    v_lshl_add_u32 v113, v15, 13, v14
    v_lshrrev_b32 v12, 6, v52
    v_lshl_add_u32 v112, v52, 26, v112
    v_and_b32 v52, 0x3fc, v53
    v_lshl_add_u32 v113, v12, 26, v113
    ds_add_rtn_u32 v53, v52, v6 offset:0
    s_bfm_b64 exec, s45, 0
    v_fma_mix_f32 v12, v114, v55, s16 op_sel_hi:[1,1,0]
    v_fma_mix_f32 v13, v114, v55, s16 op_sel:[1,0,0] op_sel_hi:[1,1,0]
    v_fma_mix_f32 v14, v115, v55, s16 op_sel_hi:[1,1,0]
    v_fma_mix_f32 v15, v115, v55, s16 op_sel:[1,0,0] op_sel_hi:[1,1,0]
    v_and_b32 v55, 0xfffff, v54
    v_lshl_add_u32 v114, v13, 13, v12
    v_mul_hi_u32_u24 v55, s17, v55
    v_lshl_add_u32 v115, v15, 13, v14
    v_lshrrev_b32 v12, 6, v54
    v_lshl_add_u32 v114, v54, 26, v114
    v_and_b32 v54, 0x3fc, v55
    v_lshl_add_u32 v115, v12, 26, v115
    ds_add_rtn_u32 v55, v54, v6 offset:0
    s_cmp_eq_u32 s46, 0
    s_cbranch_scc1 L_h3_161
    s_bfm_b64 exec, s46, 0
    v_lshrrev_b32 v116, 17, v56
    v_and_b32 v116, 0x7ff8, v116
    ds_read_b64 v[116:117], v116 offset:4096
    s_waitcnt lgkmcnt(0)
    s_bfm_b64 exec, s46, 0
    v_fma_mix_f32 v12, v116, v57, s16 op_sel_hi:[1,1,0]
    v_fma_mix_f32 v13, v116, v57, s16 op_sel:[1,0,0] op_sel_hi:[1,1,0]
    v_fma_mix_f32 v14, v117, v57, s16 op_sel_hi:[1,1,0]
    v_fma_mix_f32 v15, v117, v57, s16 op_sel:[1,0,0] op_sel_hi:[1,1,0]
    v_and_b32 v57, 0xfffff, v56
    v_lshl_add_u32 v116, v13, 13, v12
    v_mul_hi_u32_u24 v57, s17, v57
    v_lshl_add_u32 v117, v15, 13, v14
    v_lshrrev_b32 v12, 6, v56
    v_lshl_add_u32 v116, v56, 26, v116
    v_and_b32 v56, 0x3fc, v57
    v_lshl_add_u32 v117, v12, 26, v117
    ds_add_rtn_u32 v57, v56, v6 offset:0
L_h3_161:
    s_mov_b64 exec, -1
    s_waitcnt lgkmcnt(0)
    s_barrier
L_k2_afterh:
    s_cmp_lg_u32 s3, 0
    s_cbranch_scc1 L_p_181
    ds_read_b128 v[16:19], v2 offset:0
    v_mov_b32 v20, 0
    v_mov_b32 v21, 0
    v_mov_b32 v22, 0
    v_mov_b32 v23, 0
    s_waitcnt lgkmcnt(0)
    ds_write_b128 v2, v[20:23] offset:0
    v_add_u32 v26, v16, v17
    v_add_u32 v27, v26, v18
    v_add_u32 v13, v27, v19
    v_mov_b32 v12, v13
    s_nop 1
    v_add_u32_dpp v12, v12, v12 row_shr:1 row_mask:0xf bank_mask:0xf
    s_nop 1
    v_add_u32_dpp v12, v12, v12 row_shr:2 row_mask:0xf bank_mask:0xf
    s_nop 1
    v_add_u32_dpp v12, v12, v12 row_shr:4 row_mask:0xf bank_mask:0xf
    s_nop 1
    v_add_u32_dpp v12, v12, v12 row_shr:8 row_mask:0xf bank_mask:0xf
    s_nop 1
    v_add_u32_dpp v12, v12, v12 row_bcast:15 row_mask:0xa bank_mask:0xf
    s_nop 1
    v_add_u32_dpp v12, v12, v12 row_bcast:31 row_mask:0xc bank_mask:0xf
    v_sub_u32 v24, v12, v13
    v_add_u32 v25, v24, v16
    v_add_u32 v26, v24, v26
    v_add_u32 v27, v24, v27
    ds_write_b128 v2, v[24:27] offset:1024
    s_lshl_b64 exec, 1, 63
    ds_write_b32 v10, v12 offset:2064
    s_mov_b64 exec, -1
    s_waitcnt lgkmcnt(0)
L_p_181:
    s_barrier
    ds_read_b32 v12, v10 offset:2064
    s_bfm_b64 exec, s32, 0
    ds_read_b32 v28, v28 offset:1024
    s_bfm_b64 exec, s33, 0
    ds_read_b32 v30, v30 offset:1024
    s_bfm_b64 exec, s34, 0
    ds_read_b32 v32, v32 offset:1024
    s_bfm_b64 exec, s35, 0
    ds_read_b32 v34, v34 offset:1024
    s_bfm_b64 exec, s36, 0
    ds_read_b32 v36, v36 offset:1024
    s_cmp_eq_u32 s37, 0
    s_cbranch_scc1 L_sa_182
    s_bfm_b64 exec, s37, 0
    ds_read_b32 v38, v38 offset:1024
    s_bfm_b64 exec, s38, 0
    ds_read_b32 v40, v40 offset:1024
    s_bfm_b64 exec, s39, 0
    ds_read_b32 v42, v42 offset:1024
    s_bfm_b64 exec, s40, 0
    ds_read_b32 v44, v44 offset:1024
    s_bfm_b64 exec, s41, 0
    ds_read_b32 v46, v46 offset:1024
    s_bfm_b64 exec, s42, 0
    ds_read_b32 v48, v48 offset:1024
    s_bfm_b64 exec, s43, 0
    ds_read_b32 v50, v50 offset:1024
    s_bfm_b64 exec, s44, 0
    ds_read_b32 v52, v52 offset:1024
    s_bfm_b64 exec, s45, 0
    ds_read_b32 v54, v54 offset:1024
    s_cmp_eq_u32 s46, 0
    s_cbranch_scc1 L_sa_182
    s_bfm_b64 exec, s46, 0
    ds_read_b32 v56, v56 offset:1024
L_sa_182:
    s_cmp_lg_u32 s3, 0
    s_cbranch_scc1 L_os_185
    s_mov_b64 exec, -1
    s_lshl_b32 s65, s24, 8
    s_add_u32 s65, s65, s4
    s_cmp_ge_u32 s24, 5
    s_cbranch_scc1 L_ovf_186
L_ovfback_187:
    s_lshl_b32 s65, s65, 2
    s_add_u32 s25, s65, 81364992
    v_lshrrev_b32 v24, 3, v24
    v_lshrrev_b32 v25, 3, v25
    v_lshrrev_b32 v26, 3, v26
    v_lshrrev_b32 v27, 3, v27
    v_lshl_or_b32 v16, v16, 13, v24
    v_lshl_or_b32 v17, v17, 13, v25
    v_lshl_or_b32 v18, v18, 13, v26
    v_lshl_or_b32 v19, v19, 13, v27
    buffer_store_dword v16, v11, s[8:11], s25 offen
    s_add_u32 s25, s25, 65664
    buffer_store_dword v17, v11, s[8:11], s25 offen
    s_add_u32 s25, s25, 65664
    buffer_store_dword v18, v11, s[8:11], s25 offen
    s_add_u32 s25, s25, 65664
    buffer_store_dword v19, v11, s[8:11], s25 offen
    v_mov_b32 v20, s28
    s_add_u32 s25, s65, 81299456
    s_mov_b64 exec, 1
    buffer_store_dword v20, v10, s[8:11], s25 offen
L_os_185:
    s_mov_b64 exec, -1
    s_mov_b32 s19, s18
    s_lshl_b32 s64, s28, 3
    s_add_u32 s64, s64, 98174976
    s_cmp_lg_u32 s18, 0
    s_waitcnt lgkmcnt(0)
    v_readfirstlane_b32 s29, v12
    s_cbranch_scc1 L_sn_183
    s_setprio 3
    s_bfm_b64 exec, s32, 0
    v_add_u32 v28, v28, v29
    ds_write_b64 v28, v[88:89] offset:36864
    s_cmp_eq_u64 s[20:21], 0
    s_cbranch_scc1 L_pr_189
L_pb_188:
    s_ff1_i32_b64 s27, s[20:21]
    s_bitset0_b64 s[20:21], s27
    v_readlane_b32 s32, v9, s27
    s_lshr_b32 s25, s32, 6
    s_bfm_b64 exec, s32, 0
    v_add_lshl_u32 v28, s25, v1, 2
    v_lshrrev_b32 v29, 1, v28
L_pi_191:
    buffer_load_dword v28, v28, s[8:11], 0 offen
    buffer_load_ushort v29, v29, s[8:11], s31 offen
    s_bfm_b64 exec, s33, 0
    v_add_u32 v30, v30, v31
    ds_write_b64 v30, v[90:91] offset:36864
    s_cmp_eq_u64 s[20:21], 0
    s_cbranch_scc1 L_pr_193
L_pb_192:
    s_ff1_i32_b64 s27, s[20:21]
    s_bitset0_b64 s[20:21], s27
    v_readlane_b32 s33, v9, s27
    s_lshr_b32 s25, s33, 6
    s_bfm_b64 exec, s33, 0
    v_add_lshl_u32 v30, s25, v1, 2
    v_lshrrev_b32 v31, 1, v30
L_pi_195:
    buffer_load_dword v30, v30, s[8:11], 0 offen
    buffer_load_ushort v31, v31, s[8:11], s31 offen
    s_bfm_b64 exec, s34, 0
    v_add_u32 v32, v32, v33
    ds_write_b64 v32, v[92:93] offset:36864
    s_cmp_eq_u64 s[20:21], 0
    s_cbranch_scc1 L_pr_197
L_pb_196:
    s_ff1_i32_b64 s27, s[20:21]
    s_bitset0_b64 s[20:21], s27
    v_readlane_b32 s34, v9, s27
    s_lshr_b32 s25, s34, 6
    s_bfm_b64 exec, s34, 0
    v_add_lshl_u32 v32, s25, v1, 2
    v_lshrrev_b32 v33, 1, v32
L_pi_199:
    buffer_load_dword v32, v32, s[8:11], 0 offen
    buffer_load_ushort v33, v33, s[8:11], s31 offen
    s_bfm_b64 exec, s35, 0
    v_add_u32 v34, v34, v35
    ds_write_b64 v34, v[94:95] offset:36864
    s_cmp_eq_u64 s[20:21], 0
    s_cbranch_scc1 L_pr_201
L_pb_200:
    s_ff1_i32_b64 s27, s[20:21]
    s_bitset0_b64 s[20:21], s27
    v_readlane_b32 s35, v9, s27
    s_lshr_b32 s25, s35, 6
    s_bfm_b64 exec, s35, 0
    v_add_lshl_u32 v34, s25, v1, 2
    v_lshrrev_b32 v35, 1, v34
L_pi_203:
    buffer_load_dword v34, v34, s[8:11], 0 offen
    buffer_load_ushort v35, v35, s[8:11], s31 offen
    s_setprio 2
    s_bfm_b64 exec, s36, 0
    v_add_u32 v36, v36, v37
    ds_write_b64 v36, v[96:97] offset:36864
    s_cmp_eq_u64 s[20:21], 0
    s_cbranch_scc1 L_pr_205
L_pb_204:
    s_ff1_i32_b64 s27, s[20:21]
    s_bitset0_b64 s[20:21], s27
    v_readlane_b32 s36, v9, s27
    s_lshr_b32 s25, s36, 6
    s_bfm_b64 exec, s36, 0
    v_add_lshl_u32 v36, s25, v1, 2
    v_lshrrev_b32 v37, 1, v36
L_pi_207:
    buffer_load_dword v36, v36, s[8:11], 0 offen
    buffer_load_ushort v37, v37, s[8:11], s31 offen
    s_bfm_b64 exec, s37, 0
    v_add_u32 v38, v38, v39
    ds_write_b64 v38, v[98:99] offset:36864
    s_cmp_eq_u64 s[20:21], 0
    s_cbranch_scc1 L_pr_209
L_pb_208:
    s_ff1_i32_b64 s27, s[20:21]
    s_bitset0_b64 s[20:21], s27
    v_readlane_b32 s37, v9, s27
    s_lshr_b32 s25, s37, 6
    s_bfm_b64 exec, s37, 0
    v_add_lshl_u32 v38, s25, v1, 2
    v_lshrrev_b32 v39, 1, v38
L_pi_211:
    buffer_load_dword v38, v38, s[8:11], 0 offen
    buffer_load_ushort v39, v39, s[8:11], s31 offen
    s_bfm_b64 exec, s38, 0
    v_add_u32 v40, v40, v41
    ds_write_b64 v40, v[100:101] offset:36864
    s_cmp_eq_u64 s[20:21], 0
    s_cbranch_scc1 L_pr_213
L_pb_212:
    s_ff1_i32_b64 s27, s[20:21]
    s_bitset0_b64 s[20:21], s27
    v_readlane_b32 s38, v9, s27
    s_lshr_b32 s25, s38, 6
    s_bfm_b64 exec, s38, 0
    v_add_lshl_u32 v40, s25, v1, 2
    v_lshrrev_b32 v41, 1, v40
L_pi_215:
    buffer_load_dword v40, v40, s[8:11], 0 offen
    buffer_load_ushort v41, v41, s[8:11], s31 offen
    s_bfm_b64 exec, s39, 0
    v_add_u32 v42, v42, v43
    ds_write_b64 v42, v[102:103] offset:36864
    s_cmp_eq_u64 s[20:21], 0
    s_cbranch_scc1 L_pr_217
L_pb_216:
    s_ff1_i32_b64 s27, s[20:21]
    s_bitset0_b64 s[20:21], s27
    v_readlane_b32 s39, v9, s27
    s_lshr_b32 s25, s39, 6
    s_bfm_b64 exec, s39, 0
    v_add_lshl_u32 v42, s25, v1, 2
    v_lshrrev_b32 v43, 1, v42
L_pi_219:
    buffer_load_dword v42, v42, s[8:11], 0 offen
    buffer_load_ushort v43, v43, s[8:11], s31 offen
    s_setprio 1
    s_bfm_b64 exec, s40, 0
    v_add_u32 v44, v44, v45
    ds_write_b64 v44, v[104:105] offset:36864
    s_cmp_eq_u64 s[20:21], 0
    s_cbranch_scc1 L_pr_221
L_pb_220:
    s_ff1_i32_b64 s27, s[20:21]
    s_bitset0_b64 s[20:21], s27
    v_readlane_b32 s40, v9, s27
    s_lshr_b32 s25, s40, 6
    s_bfm_b64 exec, s40, 0
    v_add_lshl_u32 v44, s25, v1, 2
    v_lshrrev_b32 v45, 1, v44
L_pi_223:
    buffer_load_dword v44, v44, s[8:11], 0 offen
    buffer_load_ushort v45, v45, s[8:11], s31 offen
    s_bfm_b64 exec, s41, 0
    v_add_u32 v46, v46, v47
    ds_write_b64 v46, v[106:107] offset:36864
    s_cmp_eq_u64 s[20:21], 0
    s_cbranch_scc1 L_pr_225
L_pb_224:
    s_ff1_i32_b64 s27, s[20:21]
    s_bitset0_b64 s[20:21], s27
    v_readlane_b32 s41, v9, s27
    s_lshr_b32 s25, s41, 6
    s_bfm_b64 exec, s41, 0
    v_add_lshl_u32 v46, s25, v1, 2
    v_lshrrev_b32 v47, 1, v46
L_pi_227:
    buffer_load_dword v46, v46, s[8:11], 0 offen
    buffer_load_ushort v47, v47, s[8:11], s31 offen
    s_bfm_b64 exec, s42, 0
    v_add_u32 v48, v48, v49
    ds_write_b64 v48, v[108:109] offset:36864
    s_cmp_eq_u64 s[20:21], 0
    s_cbranch_scc1 L_pr_229
L_pb_228:
    s_ff1_i32_b64 s27, s[20:21]
    s_bitset0_b64 s[20:21], s27
    v_readlane_b32 s42, v9, s27
    s_lshr_b32 s25, s42, 6
    s_bfm_b64 exec, s42, 0
    v_add_lshl_u32 v48, s25, v1, 2
    v_lshrrev_b32 v49, 1, v48
L_pi_231:
    buffer_load_dword v48, v48, s[8:11], 0 offen
    buffer_load_ushort v49, v49, s[8:11], s31 offen
    s_setprio 0
    s_bfm_b64 exec, s43, 0
    v_add_u32 v50, v50, v51
    ds_write_b64 v50, v[110:111] offset:36864
    s_cmp_eq_u64 s[20:21], 0
    s_cbranch_scc1 L_pr_233
L_pb_232:
    s_ff1_i32_b64 s27, s[20:21]
    s_bitset0_b64 s[20:21], s27
    v_readlane_b32 s43, v9, s27
    s_lshr_b32 s25, s43, 6
    s_bfm_b64 exec, s43, 0
    v_add_lshl_u32 v50, s25, v1, 2
    v_lshrrev_b32 v51, 1, v50
L_pi_235:
    buffer_load_dword v50, v50, s[8:11], 0 offen
    buffer_load_ushort v51, v51, s[8:11], s31 offen
    s_bfm_b64 exec, s44, 0
    v_add_u32 v52, v52, v53
    ds_write_b64 v52, v[112:113] offset:36864
    s_cmp_le_u32 s22, 12
    s_cbranch_scc1 L_pe_238
    s_cmp_eq_u64 s[20:21], 0
    s_cbranch_scc1 L_pr_237
L_pb_236:
    s_ff1_i32_b64 s27, s[20:21]
    s_bitset0_b64 s[20:21], s27
    v_readlane_b32 s44, v9, s27
    s_lshr_b32 s25, s44, 6
    s_bfm_b64 exec, s44, 0
    v_add_lshl_u32 v52, s25, v1, 2
    v_lshrrev_b32 v53, 1, v52
L_pi_239:
    buffer_load_dword v52, v52, s[8:11], 0 offen
    buffer_load_ushort v53, v53, s[8:11], s31 offen
    s_bfm_b64 exec, s45, 0
    v_add_u32 v54, v54, v55
    ds_write_b64 v54, v[114:115] offset:36864
    s_cmp_le_u32 s22, 13
    s_cbranch_scc1 L_pe_242
    s_cmp_eq_u64 s[20:21], 0
    s_cbranch_scc1 L_pr_241
L_pb_240:
    s_ff1_i32_b64 s27, s[20:21]
    s_bitset0_b64 s[20:21], s27
    v_readlane_b32 s45, v9, s27
    s_lshr_b32 s25, s45, 6
    s_bfm_b64 exec, s45, 0
    v_add_lshl_u32 v54, s25, v1, 2
    v_lshrrev_b32 v55, 1, v54
L_pi_243:
    buffer_load_dword v54, v54, s[8:11], 0 offen
    buffer_load_ushort v55, v55, s[8:11], s31 offen
    s_bfm_b64 exec, s46, 0
    v_add_u32 v56, v56, v57
    ds_write_b64 v56, v[116:117] offset:36864
    s_cmp_le_u32 s22, 14
    s_cbranch_scc1 L_pe_246
    s_cmp_eq_u64 s[20:21], 0
    s_cbranch_scc1 L_pr_245
L_pb_244:
    s_ff1_i32_b64 s27, s[20:21]
    s_bitset0_b64 s[20:21], s27
    v_readlane_b32 s46, v9, s27
    s_lshr_b32 s25, s46, 6
    s_bfm_b64 exec, s46, 0
    v_add_lshl_u32 v56, s25, v1, 2
    v_lshrrev_b32 v57, 1, v56
L_pi_247:
    buffer_load_dword v56, v56, s[8:11], 0 offen
    buffer_load_ushort v57, v57, s[8:11], s31 offen
L_sf_184:
    s_lshr_b32 s29, s29, 3
    s_add_u32 s29, s29, 15
    s_and_b32 s29, s29, -16
    s_add_u32 s28, s28, s29
    s_waitcnt lgkmcnt(0)
    s_barrier
    s_add_u32 s24, s24, 1
    s_cmp_ge_u32 s24, s23
    s_cbranch_scc1 L_k2_final
    s_setprio 3
    s_mov_b64 exec, -1
    s_sub_i32 s25, s29, 0
    v_cmp_gt_i32 s[66:67], s25, v5
    s_sub_i32 s25, s29, 2048
    v_cmp_gt_i32 s[68:69], s25, v5
    s_sub_i32 s25, s29, 4096
    v_cmp_gt_i32 s[70:71], s25, v5
    s_mov_b64 exec, s[66:67]
    ds_read_b128 v[16:19], v3 offset:0
    s_mov_b64 exec, s[68:69]
    ds_read_b128 v[20:23], v3 offset:16384
    s_mov_b64 exec, s[70:71]
    ds_read_b128 v[24:27], v3 offset:32768
    s_cmp_lg_u32 s19, 0
    s_cbranch_scc1 L_hw0_249
    s_waitcnt vmcnt(30)
L_hw1_250:
    s_bfm_b64 exec, s48, 0
    v_lshrrev_b32 v88, 17, v58
    v_and_b32 v88, 0x7ff8, v88
    ds_read_b64 v[88:89], v88 offset:4096
    s_bfm_b64 exec, s49, 0
    v_lshrrev_b32 v90, 17, v60
    v_and_b32 v90, 0x7ff8, v90
    ds_read_b64 v[90:91], v90 offset:4096
    s_bfm_b64 exec, s50, 0
    v_lshrrev_b32 v92, 17, v62
    v_and_b32 v92, 0x7ff8, v92
    ds_read_b64 v[92:93], v92 offset:4096
    s_bfm_b64 exec, s51, 0
    v_lshrrev_b32 v94, 17, v64
    v_and_b32 v94, 0x7ff8, v94
    ds_read_b64 v[94:95], v94 offset:4096
    s_bfm_b64 exec, s52, 0
    v_lshrrev_b32 v96, 17, v66
    v_and_b32 v96, 0x7ff8, v96
    ds_read_b64 v[96:97], v96 offset:4096
    s_cmp_eq_u32 s53, 0
    s_cbranch_scc1 L_hs_251
    s_bfm_b64 exec, s53, 0
    v_lshrrev_b32 v98, 17, v68
    v_and_b32 v98, 0x7ff8, v98
    ds_read_b64 v[98:99], v98 offset:4096
    s_bfm_b64 exec, s54, 0
    v_lshrrev_b32 v100, 17, v70
    v_and_b32 v100, 0x7ff8, v100
    ds_read_b64 v[100:101], v100 offset:4096
    s_bfm_b64 exec, s55, 0
    v_lshrrev_b32 v102, 17, v72
    v_and_b32 v102, 0x7ff8, v102
    ds_read_b64 v[102:103], v102 offset:4096
    s_bfm_b64 exec, s56, 0
    v_lshrrev_b32 v104, 17, v74
    v_and_b32 v104, 0x7ff8, v104
    ds_read_b64 v[104:105], v104 offset:4096
    s_bfm_b64 exec, s57, 0
    v_lshrrev_b32 v106, 17, v76
    v_and_b32 v106, 0x7ff8, v106
    ds_read_b64 v[106:107], v106 offset:4096
    s_waitcnt lgkmcnt(5)
    s_mov_b64 exec, s[66:67]
    s_cbranch_execz L_cs_252
    s_add_u32 s25, s64, 0
    buffer_store_dwordx4 v[16:19], v2, s[8:11], s25 offen sc0 sc1
L_cs_252:
    s_mov_b64 exec, s[68:69]
    s_cbranch_execz L_cs_253
    s_add_u32 s25, s64, 16384
    buffer_store_dwordx4 v[20:23], v2, s[8:11], s25 offen sc0 sc1
L_cs_253:
    s_mov_b64 exec, s[70:71]
    s_cbranch_execz L_cs_254
    s_add_u32 s25, s64, 32768
    buffer_store_dwordx4 v[24:27], v2, s[8:11], s25 offen sc0 sc1
L_cs_254:
    s_mov_b64 exec, -1
    s_sub_i32 s25, s29, 6144
    v_cmp_gt_i32 s[66:67], s25, v5
    s_sub_i32 s25, s29, 8192
    v_cmp_gt_i32 s[68:69], s25, v5
    s_sub_i32 s25, s29, 10240
    v_cmp_gt_i32 s[70:71], s25, v5
    s_mov_b64 exec, s[66:67]
    ds_read_b128 v[16:19], v3 offset:49152
    s_mov_b64 exec, s[68:69]
    ds_read_b128 v[20:23], v4 offset:0
    s_mov_b64 exec, s[70:71]
    ds_read_b128 v[24:27], v4 offset:16384
    s_bfm_b64 exec, s48, 0
    v_fma_mix_f32 v12, v88, v59, s16 op_sel_hi:[1,1,0]
    v_fma_mix_f32 v13, v88, v59, s16 op_sel:[1,0,0] op_sel_hi:[1,1,0]
    v_fma_mix_f32 v14, v89, v59, s16 op_sel_hi:[1,1,0]
    v_fma_mix_f32 v15, v89, v59, s16 op_sel:[1,0,0] op_sel_hi:[1,1,0]
    v_and_b32 v59, 0xfffff, v58
    v_lshl_add_u32 v88, v13, 13, v12
    v_mul_hi_u32_u24 v59, s17, v59
    v_lshl_add_u32 v89, v15, 13, v14
    v_lshrrev_b32 v12, 6, v58
    v_lshl_add_u32 v88, v58, 26, v88
    v_and_b32 v58, 0x3fc, v59
    v_lshl_add_u32 v89, v12, 26, v89
    ds_add_rtn_u32 v59, v58, v6 offset:0
    s_bfm_b64 exec, s49, 0
    v_fma_mix_f32 v12, v90, v61, s16 op_sel_hi:[1,1,0]
    v_fma_mix_f32 v13, v90, v61, s16 op_sel:[1,0,0] op_sel_hi:[1,1,0]
    v_fma_mix_f32 v14, v91, v61, s16 op_sel_hi:[1,1,0]
    v_fma_mix_f32 v15, v91, v61, s16 op_sel:[1,0,0] op_sel_hi:[1,1,0]
    v_and_b32 v61, 0xfffff, v60
    v_lshl_add_u32 v90, v13, 13, v12
    v_mul_hi_u32_u24 v61, s17, v61
    v_lshl_add_u32 v91, v15, 13, v14
    v_lshrrev_b32 v12, 6, v60
    v_lshl_add_u32 v90, v60, 26, v90
    v_and_b32 v60, 0x3fc, v61
    v_lshl_add_u32 v91, v12, 26, v91
    ds_add_rtn_u32 v61, v60, v6 offset:0
    s_bfm_b64 exec, s50, 0
    v_fma_mix_f32 v12, v92, v63, s16 op_sel_hi:[1,1,0]
    v_fma_mix_f32 v13, v92, v63, s16 op_sel:[1,0,0] op_sel_hi:[1,1,0]
    v_fma_mix_f32 v14, v93, v63, s16 op_sel_hi:[1,1,0]
    v_fma_mix_f32 v15, v93, v63, s16 op_sel:[1,0,0] op_sel_hi:[1,1,0]
    v_and_b32 v63, 0xfffff, v62
    v_lshl_add_u32 v92, v13, 13, v12
    v_mul_hi_u32_u24 v63, s17, v63
    v_lshl_add_u32 v93, v15, 13, v14
    v_lshrrev_b32 v12, 6, v62
    v_lshl_add_u32 v92, v62, 26, v92
    v_and_b32 v62, 0x3fc, v63
    v_lshl_add_u32 v93, v12, 26, v93
    ds_add_rtn_u32 v63, v62, v6 offset:0
    s_bfm_b64 exec, s51, 0
    v_fma_mix_f32 v12, v94, v65, s16 op_sel_hi:[1,1,0]
    v_fma_mix_f32 v13, v94, v65, s16 op_sel:[1,0,0] op_sel_hi:[1,1,0]
    v_fma_mix_f32 v14, v95, v65, s16 op_sel_hi:[1,1,0]
    v_fma_mix_f32 v15, v95, v65, s16 op_sel:[1,0,0] op_sel_hi:[1,1,0]
    v_and_b32 v65, 0xfffff, v64
    v_lshl_add_u32 v94, v13, 13, v12
    v_mul_hi_u32_u24 v65, s17, v65
    v_lshl_add_u32 v95, v15, 13, v14
    v_lshrrev_b32 v12, 6, v64
    v_lshl_add_u32 v94, v64, 26, v94
    v_and_b32 v64, 0x3fc, v65
    v_lshl_add_u32 v95, v12, 26, v95
    ds_add_rtn_u32 v65, v64, v6 offset:0
    s_bfm_b64 exec, s52, 0
    v_fma_mix_f32 v12, v96, v67, s16 op_sel_hi:[1,1,0]
    v_fma_mix_f32 v13, v96, v67, s16 op_sel:[1,0,0] op_sel_hi:[1,1,0]
    v_fma_mix_f32 v14, v97, v67, s16 op_sel_hi:[1,1,0]
    v_fma_mix_f32 v15, v97, v67, s16 op_sel:[1,0,0] op_sel_hi:[1,1,0]
    v_and_b32 v67, 0xfffff, v66
    v_lshl_add_u32 v96, v13, 13, v12
    v_mul_hi_u32_u24 v67, s17, v67
    v_lshl_add_u32 v97, v15, 13, v14
    v_lshrrev_b32 v12, 6, v66
    v_lshl_add_u32 v96, v66, 26, v96
    v_and_b32 v66, 0x3fc, v67
    v_lshl_add_u32 v97, v12, 26, v97
    ds_add_rtn_u32 v67, v66, v6 offset:0
    s_setprio 2
    s_bfm_b64 exec, s58, 0
    v_lshrrev_b32 v108, 17, v78
    v_and_b32 v108, 0x7ff8, v108
    ds_read_b64 v[108:109], v108 offset:4096
    s_bfm_b64 exec, s59, 0
    v_lshrrev_b32 v110, 17, v80
    v_and_b32 v110, 0x7ff8, v110
    ds_read_b64 v[110:111], v110 offset:4096
    s_bfm_b64 exec, s60, 0
    v_lshrrev_b32 v112, 17, v82
    v_and_b32 v112, 0x7ff8, v112
    ds_read_b64 v[112:113], v112 offset:4096
    s_bfm_b64 exec, s61, 0
    v_lshrrev_b32 v114, 17, v84
    v_and_b32 v114, 0x7ff8, v114
    ds_read_b64 v[114:115], v114 offset:4096
    s_waitcnt lgkmcnt(9)
    s_mov_b64 exec, s[66:67]
    s_cbranch_execz L_cs_255
    s_add_u32 s25, s64, 49152
    buffer_store_dwordx4 v[16:19], v2, s[8:11], s25 offen sc0 sc1
L_cs_255:
    s_mov_b64 exec, s[68:69]
    s_cbranch_execz L_cs_256
    s_add_u32 s25, s64, 65536
    buffer_store_dwordx4 v[20:23], v2, s[8:11], s25 offen sc0 sc1
L_cs_256:
    s_mov_b64 exec, s[70:71]
    s_cbranch_execz L_cs_257
    s_add_u32 s25, s64, 81920
    buffer_store_dwordx4 v[24:27], v2, s[8:11], s25 offen sc0 sc1
L_cs_257:
    s_mov_b64 exec, -1
    s_sub_i32 s25, s29, 12288
    v_cmp_gt_i32 s[66:67], s25, v5
    s_sub_i32 s25, s29, 14336
    v_cmp_gt_i32 s[68:69], s25, v5
    s_mov_b64 exec, s[66:67]
    ds_read_b128 v[16:19], v4 offset:32768
    s_mov_b64 exec, s[68:69]
    ds_read_b128 v[20:23], v4 offset:49152
    s_bfm_b64 exec, s53, 0
    v_fma_mix_f32 v12, v98, v69, s16 op_sel_hi:[1,1,0]
    v_fma_mix_f32 v13, v98, v69, s16 op_sel:[1,0,0] op_sel_hi:[1,1,0]
    v_fma_mix_f32 v14, v99, v69, s16 op_sel_hi:[1,1,0]
    v_fma_mix_f32 v15, v99, v69, s16 op_sel:[1,0,0] op_sel_hi:[1,1,0]
    v_and_b32 v69, 0xfffff, v68
    v_lshl_add_u32 v98, v13, 13, v12
    v_mul_hi_u32_u24 v69, s17, v69
    v_lshl_add_u32 v99, v15, 13, v14
    v_lshrrev_b32 v12, 6, v68
    v_lshl_add_u32 v98, v68, 26, v98
    v_and_b32 v68, 0x3fc, v69
    v_lshl_add_u32 v99, v12, 26, v99
    ds_add_rtn_u32 v69, v68, v6 offset:0
    s_bfm_b64 exec, s54, 0
    v_fma_mix_f32 v12, v100, v71, s16 op_sel_hi:[1,1,0]
    v_fma_mix_f32 v13, v100, v71, s16 op_sel:[1,0,0] op_sel_hi:[1,1,0]
    v_fma_mix_f32 v14, v101, v71, s16 op_sel_hi:[1,1,0]
    v_fma_mix_f32 v15, v101, v71, s16 op_sel:[1,0,0] op_sel_hi:[1,1,0]
    v_and_b32 v71, 0xfffff, v70
    v_lshl_add_u32 v100, v13, 13, v12
    v_mul_hi_u32_u24 v71, s17, v71
    v_lshl_add_u32 v101, v15, 13, v14
    v_lshrrev_b32 v12, 6, v70
    v_lshl_add_u32 v100, v70, 26, v100
    v_and_b32 v70, 0x3fc, v71
    v_lshl_add_u32 v101, v12, 26, v101
    ds_add_rtn_u32 v71, v70, v6 offset:0
    s_bfm_b64 exec, s55, 0
    v_fma_mix_f32 v12, v102, v73, s16 op_sel_hi:[1,1,0]
    v_fma_mix_f32 v13, v102, v73, s16 op_sel:[1,0,0] op_sel_hi:[1,1,0]
    v_fma_mix_f32 v14, v103, v73, s16 op_sel_hi:[1,1,0]
    v_fma_mix_f32 v15, v103, v73, s16 op_sel:[1,0,0] op_sel_hi:[1,1,0]
    v_and_b32 v73, 0xfffff, v72
    v_lshl_add_u32 v102, v13, 13, v12
    v_mul_hi_u32_u24 v73, s17, v73
    v_lshl_add_u32 v103, v15, 13, v14
    v_lshrrev_b32 v12, 6, v72
    v_lshl_add_u32 v102, v72, 26, v102
    v_and_b32 v72, 0x3fc, v73
    v_lshl_add_u32 v103, v12, 26, v103
    ds_add_rtn_u32 v73, v72, v6 offset:0
    s_bfm_b64 exec, s56, 0
    v_fma_mix_f32 v12, v104, v75, s16 op_sel_hi:[1,1,0]
    v_fma_mix_f32 v13, v104, v75, s16 op_sel:[1,0,0] op_sel_hi:[1,1,0]
    v_fma_mix_f32 v14, v105, v75, s16 op_sel_hi:[1,1,0]
    v_fma_mix_f32 v15, v105, v75, s16 op_sel:[1,0,0] op_sel_hi:[1,1,0]
    v_and_b32 v75, 0xfffff, v74
    v_lshl_add_u32 v104, v13, 13, v12
    v_mul_hi_u32_u24 v75, s17, v75
    v_lshl_add_u32 v105, v15, 13, v14
    v_lshrrev_b32 v12, 6, v74
    v_lshl_add_u32 v104, v74, 26, v104
    v_and_b32 v74, 0x3fc, v75
    v_lshl_add_u32 v105, v12, 26, v105
    ds_add_rtn_u32 v75, v74, v6 offset:0
    s_bfm_b64 exec, s57, 0
    v_fma_mix_f32 v12, v106, v77, s16 op_sel_hi:[1,1,0]
    v_fma_mix_f32 v13, v106, v77, s16 op_sel:[1,0,0] op_sel_hi:[1,1,0]
    v_fma_mix_f32 v14, v107, v77, s16 op_sel_hi:[1,1,0]
    v_fma_mix_f32 v15, v107, v77, s16 op_sel:[1,0,0] op_sel_hi:[1,1,0]
    v_and_b32 v77, 0xfffff, v76
    v_lshl_add_u32 v106, v13, 13, v12
    v_mul_hi_u32_u24 v77, s17, v77
    v_lshl_add_u32 v107, v15, 13, v14
    v_lshrrev_b32 v12, 6, v76
    v_lshl_add_u32 v106, v76, 26, v106
    v_and_b32 v76, 0x3fc, v77
    v_lshl_add_u32 v107, v12, 26, v107
    ds_add_rtn_u32 v77, v76, v6 offset:0
    s_setprio 1
    s_waitcnt lgkmcnt(5)
    s_mov_b64 exec, s[66:67]
    s_cbranch_execz L_cs_258
    s_add_u32 s25, s64, 98304
    buffer_store_dwordx4 v[16:19], v2, s[8:11], s25 offen sc0 sc1
L_cs_258:
    s_mov_b64 exec, s[68:69]
    s_cbranch_execz L_cs_259
    s_add_u32 s25, s64, 114688
    buffer_store_dwordx4 v[20:23], v2, s[8:11], s25 offen sc0 sc1
L_cs_259:
    s_bfm_b64 exec, s58, 0
    v_fma_mix_f32 v12, v108, v79, s16 op_sel_hi:[1,1,0]
    v_fma_mix_f32 v13, v108, v79, s16 op_sel:[1,0,0] op_sel_hi:[1,1,0]
    v_fma_mix_f32 v14, v109, v79, s16 op_sel_hi:[1,1,0]
    v_fma_mix_f32 v15, v109, v79, s16 op_sel:[1,0,0] op_sel_hi:[1,1,0]
    v_and_b32 v79, 0xfffff, v78
    v_lshl_add_u32 v108, v13, 13, v12
    v_mul_hi_u32_u24 v79, s17, v79
    v_lshl_add_u32 v109, v15, 13, v14
    v_lshrrev_b32 v12, 6, v78
    v_lshl_add_u32 v108, v78, 26, v108
    v_and_b32 v78, 0x3fc, v79
    v_lshl_add_u32 v109, v12, 26, v109
    ds_add_rtn_u32 v79, v78, v6 offset:0
    s_bfm_b64 exec, s59, 0
    v_fma_mix_f32 v12, v110, v81, s16 op_sel_hi:[1,1,0]
    v_fma_mix_f32 v13, v110, v81, s16 op_sel:[1,0,0] op_sel_hi:[1,1,0]
    v_fma_mix_f32 v14, v111, v81, s16 op_sel_hi:[1,1,0]
    v_fma_mix_f32 v15, v111, v81, s16 op_sel:[1,0,0] op_sel_hi:[1,1,0]
    v_and_b32 v81, 0xfffff, v80
    v_lshl_add_u32 v110, v13, 13, v12
    v_mul_hi_u32_u24 v81, s17, v81
    v_lshl_add_u32 v111, v15, 13, v14
    v_lshrrev_b32 v12, 6, v80
    v_lshl_add_u32 v110, v80, 26, v110
    v_and_b32 v80, 0x3fc, v81
    v_lshl_add_u32 v111, v12, 26, v111
    ds_add_rtn_u32 v81, v80, v6 offset:0
    s_bfm_b64 exec, s60, 0
    v_fma_mix_f32 v12, v112, v83, s16 op_sel_hi:[1,1,0]
    v_fma_mix_f32 v13, v112, v83, s16 op_sel:[1,0,0] op_sel_hi:[1,1,0]
    v_fma_mix_f32 v14, v113, v83, s16 op_sel_hi:[1,1,0]
    v_fma_mix_f32 v15, v113, v83, s16 op_sel:[1,0,0] op_sel_hi:[1,1,0]
    v_and_b32 v83, 0xfffff, v82
    v_lshl_add_u32 v112, v13, 13, v12
    v_mul_hi_u32_u24 v83, s17, v83
    v_lshl_add_u32 v113, v15, 13, v14
    v_lshrrev_b32 v12, 6, v82
    v_lshl_add_u32 v112, v82, 26, v112
    v_and_b32 v82, 0x3fc, v83
    v_lshl_add_u32 v113, v12, 26, v113
    ds_add_rtn_u32 v83, v82, v6 offset:0
    s_bfm_b64 exec, s61, 0
    v_fma_mix_f32 v12, v114, v85, s16 op_sel_hi:[1,1,0]
    v_fma_mix_f32 v13, v114, v85, s16 op_sel:[1,0,0] op_sel_hi:[1,1,0]
    v_fma_mix_f32 v14, v115, v85, s16 op_sel_hi:[1,1,0]
    v_fma_mix_f32 v15, v115, v85, s16 op_sel:[1,0,0] op_sel_hi:[1,1,0]
    v_and_b32 v85, 0xfffff, v84
    v_lshl_add_u32 v114, v13, 13, v12
    v_mul_hi_u32_u24 v85, s17, v85
    v_lshl_add_u32 v115, v15, 13, v14
    v_lshrrev_b32 v12, 6, v84
    v_lshl_add_u32 v114, v84, 26, v114
    v_and_b32 v84, 0x3fc, v85
    v_lshl_add_u32 v115, v12, 26, v115
    ds_add_rtn_u32 v85, v84, v6 offset:0
    s_cmp_eq_u32 s62, 0
    s_cbranch_scc1 L_h3_248
    s_bfm_b64 exec, s62, 0
    v_lshrrev_b32 v116, 17, v86
    v_and_b32 v116, 0x7ff8, v116
    ds_read_b64 v[116:117], v116 offset:4096
    s_waitcnt lgkmcnt(0)
    s_bfm_b64 exec, s62, 0
    v_fma_mix_f32 v12, v116, v87, s16 op_sel_hi:[1,1,0]
    v_fma_mix_f32 v13, v116, v87, s16 op_sel:[1,0,0] op_sel_hi:[1,1,0]
    v_fma_mix_f32 v14, v117, v87, s16 op_sel_hi:[1,1,0]
    v_fma_mix_f32 v15, v117, v87, s16 op_sel:[1,0,0] op_sel_hi:[1,1,0]
    v_and_b32 v87, 0xfffff, v86
    v_lshl_add_u32 v116, v13, 13, v12
    v_mul_hi_u32_u24 v87, s17, v87
    v_lshl_add_u32 v117, v15, 13, v14
    v_lshrrev_b32 v12, 6, v86
    v_lshl_add_u32 v116, v86, 26, v116
    v_and_b32 v86, 0x3fc, v87
    v_lshl_add_u32 v117, v12, 26, v117
    ds_add_rtn_u32 v87, v86, v6 offset:0
L_h3_248:
    s_mov_b64 exec, -1
    s_waitcnt lgkmcnt(0)
    s_barrier
    s_cmp_lg_u32 s3, 0
    s_cbranch_scc1 L_p_268
    ds_read_b128 v[16:19], v2 offset:0
    v_mov_b32 v20, 0
    v_mov_b32 v21, 0
    v_mov_b32 v22, 0
    v_mov_b32 v23, 0
    s_waitcnt lgkmcnt(0)
    ds_write_b128 v2, v[20:23] offset:0
    v_add_u32 v26, v16, v17
    v_add_u32 v27, v26, v18
    v_add_u32 v13, v27, v19
    v_mov_b32 v12, v13
    s_nop 1
    v_add_u32_dpp v12, v12, v12 row_shr:1 row_mask:0xf bank_mask:0xf
    s_nop 1
    v_add_u32_dpp v12, v12, v12 row_shr:2 row_mask:0xf bank_mask:0xf
    s_nop 1
    v_add_u32_dpp v12, v12, v12 row_shr:4 row_mask:0xf bank_mask:0xf
    s_nop 1
    v_add_u32_dpp v12, v12, v12 row_shr:8 row_mask:0xf bank_mask:0xf
    s_nop 1
    v_add_u32_dpp v12, v12, v12 row_bcast:15 row_mask:0xa bank_mask:0xf
    s_nop 1
    v_add_u32_dpp v12, v12, v12 row_bcast:31 row_mask:0xc bank_mask:0xf
    v_sub_u32 v24, v12, v13
    v_add_u32 v25, v24, v16
    v_add_u32 v26, v24, v26
    v_add_u32 v27, v24, v27
    ds_write_b128 v2, v[24:27] offset:1024
    s_lshl_b64 exec, 1, 63
    ds_write_b32 v10, v12 offset:2064
    s_mov_b64 exec, -1
    s_waitcnt lgkmcnt(0)
L_p_268:
    s_barrier
    ds_read_b32 v12, v10 offset:2064
    s_bfm_b64 exec, s48, 0
    ds_read_b32 v58, v58 offset:1024
    s_bfm_b64 exec, s49, 0
    ds_read_b32 v60, v60 offset:1024
    s_bfm_b64 exec, s50, 0
    ds_read_b32 v62, v62 offset:1024
    s_bfm_b64 exec, s51, 0
    ds_read_b32 v64, v64 offset:1024
    s_bfm_b64 exec, s52, 0
    ds_read_b32 v66, v66 offset:1024
    s_cmp_eq_u32 s53, 0
    s_cbranch_scc1 L_sa_269
    s_bfm_b64 exec, s53, 0
    ds_read_b32 v68, v68 offset:1024
    s_bfm_b64 exec, s54, 0
    ds_read_b32 v70, v70 offset:1024
    s_bfm_b64 exec, s55, 0
    ds_read_b32 v72, v72 offset:1024
    s_bfm_b64 exec, s56, 0
    ds_read_b32 v74, v74 offset:1024
    s_bfm_b64 exec, s57, 0
    ds_read_b32 v76, v76 offset:1024
    s_bfm_b64 exec, s58, 0
    ds_read_b32 v78, v78 offset:1024
    s_bfm_b64 exec, s59, 0
    ds_read_b32 v80, v80 offset:1024
    s_bfm_b64 exec, s60, 0
    ds_read_b32 v82, v82 offset:1024
    s_bfm_b64 exec, s61, 0
    ds_read_b32 v84, v84 offset:1024
    s_cmp_eq_u32 s62, 0
    s_cbranch_scc1 L_sa_269
    s_bfm_b64 exec, s62, 0
    ds_read_b32 v86, v86 offset:1024
L_sa_269:
    s_cmp_lg_u32 s3, 0
    s_cbranch_scc1 L_os_272
    s_mov_b64 exec, -1
    s_lshl_b32 s65, s24, 8
    s_add_u32 s65, s65, s4
    s_cmp_ge_u32 s24, 5
    s_cbranch_scc1 L_ovf_273
L_ovfback_274:
    s_lshl_b32 s65, s65, 2
    s_add_u32 s25, s65, 81364992
    v_lshrrev_b32 v24, 3, v24
    v_lshrrev_b32 v25, 3, v25
    v_lshrrev_b32 v26, 3, v26
    v_lshrrev_b32 v27, 3, v27
    v_lshl_or_b32 v16, v16, 13, v24
    v_lshl_or_b32 v17, v17, 13, v25
    v_lshl_or_b32 v18, v18, 13, v26
    v_lshl_or_b32 v19, v19, 13, v27
    buffer_store_dword v16, v11, s[8:11], s25 offen
    s_add_u32 s25, s25, 65664
    buffer_store_dword v17, v11, s[8:11], s25 offen
    s_add_u32 s25, s25, 65664
    buffer_store_dword v18, v11, s[8:11], s25 offen
    s_add_u32 s25, s25, 65664
    buffer_store_dword v19, v11, s[8:11], s25 offen
    v_mov_b32 v20, s28
    s_add_u32 s25, s65, 81299456
    s_mov_b64 exec, 1
    buffer_store_dword v20, v10, s[8:11], s25 offen
L_os_272:
    s_mov_b64 exec, -1
    s_mov_b32 s19, s18
    s_lshl_b32 s64, s28, 3
    s_add_u32 s64, s64, 98174976
    s_cmp_lg_u32 s18, 0
    s_waitcnt lgkmcnt(0)
    v_readfirstlane_b32 s29, v12
    s_cbranch_scc1 L_sn_270
    s_setprio 3
    s_bfm_b64 exec, s48, 0
    v_add_u32 v58, v58, v59
    ds_write_b64 v58, v[88:89] offset:36864
    s_cmp_eq_u64 s[20:21], 0
    s_cbranch_scc1 L_pr_276
L_pb_275:
    s_ff1_i32_b64 s27, s[20:21]
    s_bitset0_b64 s[20:21], s27
    v_readlane_b32 s48, v9, s27
    s_lshr_b32 s25, s48, 6
    s_bfm_b64 exec, s48, 0
    v_add_lshl_u32 v58, s25, v1, 2
    v_lshrrev_b32 v59, 1, v58
L_pi_278:
    buffer_load_dword v58, v58, s[8:11], 0 offen
    buffer_load_ushort v59, v59, s[8:11], s31 offen
    s_bfm_b64 exec, s49, 0
    v_add_u32 v60, v60, v61
    ds_write_b64 v60, v[90:91] offset:36864
    s_cmp_eq_u64 s[20:21], 0
    s_cbranch_scc1 L_pr_280
L_pb_279:
    s_ff1_i32_b64 s27, s[20:21]
    s_bitset0_b64 s[20:21], s27
    v_readlane_b32 s49, v9, s27
    s_lshr_b32 s25, s49, 6
    s_bfm_b64 exec, s49, 0
    v_add_lshl_u32 v60, s25, v1, 2
    v_lshrrev_b32 v61, 1, v60
L_pi_282:
    buffer_load_dword v60, v60, s[8:11], 0 offen
    buffer_load_ushort v61, v61, s[8:11], s31 offen
    s_bfm_b64 exec, s50, 0
    v_add_u32 v62, v62, v63
    ds_write_b64 v62, v[92:93] offset:36864
    s_cmp_eq_u64 s[20:21], 0
    s_cbranch_scc1 L_pr_284
L_pb_283:
    s_ff1_i32_b64 s27, s[20:21]
    s_bitset0_b64 s[20:21], s27
    v_readlane_b32 s50, v9, s27
    s_lshr_b32 s25, s50, 6
    s_bfm_b64 exec, s50, 0
    v_add_lshl_u32 v62, s25, v1, 2
    v_lshrrev_b32 v63, 1, v62
L_pi_286:
    buffer_load_dword v62, v62, s[8:11], 0 offen
    buffer_load_ushort v63, v63, s[8:11], s31 offen
    s_bfm_b64 exec, s51, 0
    v_add_u32 v64, v64, v65
    ds_write_b64 v64, v[94:95] offset:36864
    s_cmp_eq_u64 s[20:21], 0
    s_cbranch_scc1 L_pr_288
L_pb_287:
    s_ff1_i32_b64 s27, s[20:21]
    s_bitset0_b64 s[20:21], s27
    v_readlane_b32 s51, v9, s27
    s_lshr_b32 s25, s51, 6
    s_bfm_b64 exec, s51, 0
    v_add_lshl_u32 v64, s25, v1, 2
    v_lshrrev_b32 v65, 1, v64
L_pi_290:
    buffer_load_dword v64, v64, s[8:11], 0 offen
    buffer_load_ushort v65, v65, s[8:11], s31 offen
    s_setprio 2
    s_bfm_b64 exec, s52, 0
    v_add_u32 v66, v66, v67
    ds_write_b64 v66, v[96:97] offset:36864
    s_cmp_eq_u64 s[20:21], 0
    s_cbranch_scc1 L_pr_292
L_pb_291:
    s_ff1_i32_b64 s27, s[20:21]
    s_bitset0_b64 s[20:21], s27
    v_readlane_b32 s52, v9, s27
    s_lshr_b32 s25, s52, 6
    s_bfm_b64 exec, s52, 0
    v_add_lshl_u32 v66, s25, v1, 2
    v_lshrrev_b32 v67, 1, v66
L_pi_294:
    buffer_load_dword v66, v66, s[8:11], 0 offen
    buffer_load_ushort v67, v67, s[8:11], s31 offen
    s_bfm_b64 exec, s53, 0
    v_add_u32 v68, v68, v69
    ds_write_b64 v68, v[98:99] offset:36864
    s_cmp_eq_u64 s[20:21], 0
    s_cbranch_scc1 L_pr_296
L_pb_295:
    s_ff1_i32_b64 s27, s[20:21]
    s_bitset0_b64 s[20:21], s27
    v_readlane_b32 s53, v9, s27
    s_lshr_b32 s25, s53, 6
    s_bfm_b64 exec, s53, 0
    v_add_lshl_u32 v68, s25, v1, 2
    v_lshrrev_b32 v69, 1, v68
L_pi_298:
    buffer_load_dword v68, v68, s[8:11], 0 offen
    buffer_load_ushort v69, v69, s[8:11], s31 offen
    s_bfm_b64 exec, s54, 0
    v_add_u32 v70, v70, v71
    ds_write_b64 v70, v[100:101] offset:36864
    s_cmp_eq_u64 s[20:21], 0
    s_cbranch_scc1 L_pr_300
L_pb_299:
    s_ff1_i32_b64 s27, s[20:21]
    s_bitset0_b64 s[20:21], s27
    v_readlane_b32 s54, v9, s27
    s_lshr_b32 s25, s54, 6
    s_bfm_b64 exec, s54, 0
    v_add_lshl_u32 v70, s25, v1, 2
    v_lshrrev_b32 v71, 1, v70
L_pi_302:
    buffer_load_dword v70, v70, s[8:11], 0 offen
    buffer_load_ushort v71, v71, s[8:11], s31 offen
    s_bfm_b64 exec, s55, 0
    v_add_u32 v72, v72, v73
    ds_write_b64 v72, v[102:103] offset:36864
    s_cmp_eq_u64 s[20:21], 0
    s_cbranch_scc1 L_pr_304
L_pb_303:
    s_ff1_i32_b64 s27, s[20:21]
    s_bitset0_b64 s[20:21], s27
    v_readlane_b32 s55, v9, s27
    s_lshr_b32 s25, s55, 6
    s_bfm_b64 exec, s55, 0
    v_add_lshl_u32 v72, s25, v1, 2
    v_lshrrev_b32 v73, 1, v72
L_pi_306:
    buffer_load_dword v72, v72, s[8:11], 0 offen
    buffer_load_ushort v73, v73, s[8:11], s31 offen
    s_setprio 1
    s_bfm_b64 exec, s56, 0
    v_add_u32 v74, v74, v75
    ds_write_b64 v74, v[104:105] offset:36864
    s_cmp_eq_u64 s[20:21], 0
    s_cbranch_scc1 L_pr_308
L_pb_307:
    s_ff1_i32_b64 s27, s[20:21]
    s_bitset0_b64 s[20:21], s27
    v_readlane_b32 s56, v9, s27
    s_lshr_b32 s25, s56, 6
    s_bfm_b64 exec, s56, 0
    v_add_lshl_u32 v74, s25, v1, 2
    v_lshrrev_b32 v75, 1, v74
L_pi_310:
    buffer_load_dword v74, v74, s[8:11], 0 offen
    buffer_load_ushort v75, v75, s[8:11], s31 offen
    s_bfm_b64 exec, s57, 0
    v_add_u32 v76, v76, v77
    ds_write_b64 v76, v[106:107] offset:36864
    s_cmp_eq_u64 s[20:21], 0
    s_cbranch_scc1 L_pr_312
L_pb_311:
    s_ff1_i32_b64 s27, s[20:21]
    s_bitset0_b64 s[20:21], s27
    v_readlane_b32 s57, v9, s27
    s_lshr_b32 s25, s57, 6
    s_bfm_b64 exec, s57, 0
    v_add_lshl_u32 v76, s25, v1, 2
    v_lshrrev_b32 v77, 1, v76
L_pi_314:
    buffer_load_dword v76, v76, s[8:11], 0 offen
    buffer_load_ushort v77, v77, s[8:11], s31 offen
    s_bfm_b64 exec, s58, 0
    v_add_u32 v78, v78, v79
    ds_write_b64 v78, v[108:109] offset:36864
    s_cmp_eq_u64 s[20:21], 0
    s_cbranch_scc1 L_pr_316
L_pb_315:
    s_ff1_i32_b64 s27, s[20:21]
    s_bitset0_b64 s[20:21], s27
    v_readlane_b32 s58, v9, s27
    s_lshr_b32 s25, s58, 6
    s_bfm_b64 exec, s58, 0
    v_add_lshl_u32 v78, s25, v1, 2
    v_lshrrev_b32 v79, 1, v78
L_pi_318:
    buffer_load_dword v78, v78, s[8:11], 0 offen
    buffer_load_ushort v79, v79, s[8:11], s31 offen
    s_setprio 0
    s_bfm_b64 exec, s59, 0
    v_add_u32 v80, v80, v81
    ds_write_b64 v80, v[110:111] offset:36864
    s_cmp_eq_u64 s[20:21], 0
    s_cbranch_scc1 L_pr_320
L_pb_319:
    s_ff1_i32_b64 s27, s[20:21]
    s_bitset0_b64 s[20:21], s27
    v_readlane_b32 s59, v9, s27
    s_lshr_b32 s25, s59, 6
    s_bfm_b64 exec, s59, 0
    v_add_lshl_u32 v80, s25, v1, 2
    v_lshrrev_b32 v81, 1, v80
L_pi_322:
    buffer_load_dword v80, v80, s[8:11], 0 offen
    buffer_load_ushort v81, v81, s[8:11], s31 offen
    s_bfm_b64 exec, s60, 0
    v_add_u32 v82, v82, v83
    ds_write_b64 v82, v[112:113] offset:36864
    s_cmp_le_u32 s22, 12
    s_cbranch_scc1 L_pe_325
    s_cmp_eq_u64 s[20:21], 0
    s_cbranch_scc1 L_pr_324
L_pb_323:
    s_ff1_i32_b64 s27, s[20:21]
    s_bitset0_b64 s[20:21], s27
    v_readlane_b32 s60, v9, s27
    s_lshr_b32 s25, s60, 6
    s_bfm_b64 exec, s60, 0
    v_add_lshl_u32 v82, s25, v1, 2
    v_lshrrev_b32 v83, 1, v82
L_pi_326:
    buffer_load_dword v82, v82, s[8:11], 0 offen
    buffer_load_ushort v83, v83, s[8:11], s31 offen
    s_bfm_b64 exec, s61, 0
    v_add_u32 v84, v84, v85
    ds_write_b64 v84, v[114:115] offset:36864
    s_cmp_le_u32 s22, 13
    s_cbranch_scc1 L_pe_329
    s_cmp_eq_u64 s[20:21], 0
    s_cbranch_scc1 L_pr_328
L_pb_327:
    s_ff1_i32_b64 s27, s[20:21]
    s_bitset0_b64 s[20:21], s27
    v_readlane_b32 s61, v9, s27
    s_lshr_b32 s25, s61, 6
    s_bfm_b64 exec, s61, 0
    v_add_lshl_u32 v84, s25, v1, 2
    v_lshrrev_b32 v85, 1, v84
L_pi_330:
    buffer_load_dword v84, v84, s[8:11], 0 offen
    buffer_load_ushort v85, v85, s[8:11], s31 offen
    s_bfm_b64 exec, s62, 0
    v_add_u32 v86, v86, v87
    ds_write_b64 v86, v[116:117] offset:36864
    s_cmp_le_u32 s22, 14
    s_cbranch_scc1 L_pe_333
    s_cmp_eq_u64 s[20:21], 0
    s_cbranch_scc1 L_pr_332
L_pb_331:
    s_ff1_i32_b64 s27, s[20:21]
    s_bitset0_b64 s[20:21], s27
    v_readlane_b32 s62, v9, s27
    s_lshr_b32 s25, s62, 6
    s_bfm_b64 exec, s62, 0
    v_add_lshl_u32 v86, s25, v1, 2
    v_lshrrev_b32 v87, 1, v86
L_pi_334:
    buffer_load_dword v86, v86, s[8:11], 0 offen
    buffer_load_ushort v87, v87, s[8:11], s31 offen
L_sf_271:
    s_lshr_b32 s29, s29, 3
    s_add_u32 s29, s29, 15
    s_and_b32 s29, s29, -16
    s_add_u32 s28, s28, s29
    s_waitcnt lgkmcnt(0)
    s_barrier
    s_add_u32 s24, s24, 1
    s_cmp_ge_u32 s24, s23
    s_cbranch_scc0 L_k2_loop
L_k2_final:
    s_mov_b64 exec, -1
    s_sub_i32 s25, s29, 0
    v_cmp_gt_i32 s[32:33], s25, v5
    s_sub_i32 s25, s29, 2048
    v_cmp_gt_i32 s[34:35], s25, v5
    s_sub_i32 s25, s29, 4096
    v_cmp_gt_i32 s[36:37], s25, v5
    s_sub_i32 s25, s29, 6144
    v_cmp_gt_i32 s[38:39], s25, v5
    s_sub_i32 s25, s29, 8192
    v_cmp_gt_i32 s[40:41], s25, v5
    s_sub_i32 s25, s29, 10240
    v_cmp_gt_i32 s[42:43], s25, v5
    s_sub_i32 s25, s29, 12288
    v_cmp_gt_i32 s[44:45], s25, v5
    s_sub_i32 s25, s29, 14336
    v_cmp_gt_i32 s[46:47], s25, v5
    s_mov_b64 exec, s[32:33]
    ds_read_b128 v[16:19], v3 offset:0
    s_mov_b64 exec, s[34:35]
    ds_read_b128 v[20:23], v3 offset:16384
    s_mov_b64 exec, s[36:37]
    ds_read_b128 v[24:27], v3 offset:32768
    s_mov_b64 exec, s[38:39]
    ds_read_b128 v[88:91], v3 offset:49152
    s_mov_b64 exec, s[40:41]
    ds_read_b128 v[92:95], v4 offset:0
    s_mov_b64 exec, s[42:43]
    ds_read_b128 v[96:99], v4 offset:16384
    s_mov_b64 exec, s[44:45]
    ds_read_b128 v[100:103], v4 offset:32768
    s_mov_b64 exec, s[46:47]
    ds_read_b128 v[104:107], v4 offset:49152
    s_waitcnt lgkmcnt(0)
    s_mov_b64 exec, s[32:33]
    s_cbranch_execz L_cs_335
    s_add_u32 s25, s64, 0
    buffer_store_dwordx4 v[16:19], v2, s[8:11], s25 offen sc0 sc1
L_cs_335:
    s_mov_b64 exec, s[34:35]
    s_cbranch_execz L_cs_336
    s_add_u32 s25, s64, 16384
    buffer_store_dwordx4 v[20:23], v2, s[8:11], s25 offen sc0 sc1
L_cs_336:
    s_mov_b64 exec, s[36:37]
    s_cbranch_execz L_cs_337
    s_add_u32 s25, s64, 32768
    buffer_store_dwordx4 v[24:27], v2, s[8:11], s25 offen sc0 sc1
L_cs_337:
    s_mov_b64 exec, s[38:39]
    s_cbranch_execz L_cs_338
    s_add_u32 s25, s64, 49152
    buffer_store_dwordx4 v[88:91], v2, s[8:11], s25 offen sc0 sc1
L_cs_338:
    s_mov_b64 exec, s[40:41]
    s_cbranch_execz L_cs_339
    s_add_u32 s25, s64, 65536
    buffer_store_dwordx4 v[92:95], v2, s[8:11], s25 offen sc0 sc1
L_cs_339:
    s_mov_b64 exec, s[42:43]
    s_cbranch_execz L_cs_340
    s_add_u32 s25, s64, 81920
    buffer_store_dwordx4 v[96:99], v2, s[8:11], s25 offen sc0 sc1
L_cs_340:
    s_mov_b64 exec, s[44:45]
    s_cbranch_execz L_cs_341
    s_add_u32 s25, s64, 98304
    buffer_store_dwordx4 v[100:103], v2, s[8:11], s25 offen sc0 sc1
L_cs_341:
    s_mov_b64 exec, s[46:47]
    s_cbranch_execz L_cs_342
    s_add_u32 s25, s64, 114688
    buffer_store_dwordx4 v[104:107], v2, s[8:11], s25 offen sc0 sc1
L_cs_342:
L_k2_end:
    s_endpgm
L_pr_42:
    s_cmp_lg_u32 s18, 0
    s_cbranch_scc1 L_pe_43
    s_mov_b64 exec, -1
    v_add_u32 v7, 63, v7
    v_subrev_u32 v8, 63, v8
    v_max_i32 v8, 0, v8
    v_min_u32 v15, 63, v8
    v_cmp_lt_u32 s[20:21], 0, v8
    v_lshl_or_b32 v9, v7, 6, v15
    s_nop 3
    s_cmp_eq_u64 s[20:21], 0
    s_cbranch_scc0 L_pb_41
    s_mov_b32 s18, 1
L_pe_43:
    s_mov_b32 s32, 0
    s_mov_b64 exec, 0
    s_branch L_pi_44
L_pr_46:
    s_cmp_lg_u32 s18, 0
    s_cbranch_scc1 L_pe_47
    s_mov_b64 exec, -1
    v_add_u32 v7, 63, v7
    v_subrev_u32 v8, 63, v8
    v_max_i32 v8, 0, v8
    v_min_u32 v15, 63, v8
    v_cmp_lt_u32 s[20:21], 0, v8
    v_lshl_or_b32 v9, v7, 6, v15
    s_nop 3
    s_cmp_eq_u64 s[20:21], 0
    s_cbranch_scc0 L_pb_45
    s_mov_b32 s18, 1
L_pe_47:
    s_mov_b32 s33, 0
    s_mov_b64 exec, 0
    s_branch L_pi_48
L_pr_50:
    s_cmp_lg_u32 s18, 0
    s_cbranch_scc1 L_pe_51
    s_mov_b64 exec, -1
    v_add_u32 v7, 63, v7
    v_subrev_u32 v8, 63, v8
    v_max_i32 v8, 0, v8
    v_min_u32 v15, 63, v8
    v_cmp_lt_u32 s[20:21], 0, v8
    v_lshl_or_b32 v9, v7, 6, v15
    s_nop 3
    s_cmp_eq_u64 s[20:21], 0
    s_cbranch_scc0 L_pb_49
    s_mov_b32 s18, 1
L_pe_51:
    s_mov_b32 s34, 0
    s_mov_b64 exec, 0
    s_branch L_pi_52
L_pr_54:
    s_cmp_lg_u32 s18, 0
    s_cbranch_scc1 L_pe_55
    s_mov_b64 exec, -1
    v_add_u32 v7, 63, v7
    v_subrev_u32 v8, 63, v8
    v_max_i32 v8, 0, v8
    v_min_u32 v15, 63, v8
    v_cmp_lt_u32 s[20:21], 0, v8
    v_lshl_or_b32 v9, v7, 6, v15
    s_nop 3
    s_cmp_eq_u64 s[20:21], 0
    s_cbranch_scc0 L_pb_53
    s_mov_b32 s18, 1
L_pe_55:
    s_mov_b32 s35, 0
    s_mov_b64 exec, 0
    s_branch L_pi_56
L_pr_58:
    s_cmp_lg_u32 s18, 0
    s_cbranch_scc1 L_pe_59
    s_mov_b64 exec, -1
    v_add_u32 v7, 63, v7
    v_subrev_u32 v8, 63, v8
    v_max_i32 v8, 0, v8
    v_min_u32 v15, 63, v8
    v_cmp_lt_u32 s[20:21], 0, v8
    v_lshl_or_b32 v9, v7, 6, v15
    s_nop 3
    s_cmp_eq_u64 s[20:21], 0
    s_cbranch_scc0 L_pb_57
    s_mov_b32 s18, 1
L_pe_59:
    s_mov_b32 s36, 0
    s_mov_b64 exec, 0
    s_branch L_pi_60
L_pr_62:
    s_cmp_lg_u32 s18, 0
    s_cbranch_scc1 L_pe_63
    s_mov_b64 exec, -1
    v_add_u32 v7, 63, v7
    v_subrev_u32 v8, 63, v8
    v_max_i32 v8, 0, v8
    v_min_u32 v15, 63, v8
    v_cmp_lt_u32 s[20:21], 0, v8
    v_lshl_or_b32 v9, v7, 6, v15
    s_nop 3
    s_cmp_eq_u64 s[20:21], 0
    s_cbranch_scc0 L_pb_61
    s_mov_b32 s18, 1
L_pe_63:
    s_mov_b32 s37, 0
    s_mov_b64 exec, 0
    s_branch L_pi_64
L_pr_66:
    s_cmp_lg_u32 s18, 0
    s_cbranch_scc1 L_pe_67
    s_mov_b64 exec, -1
    v_add_u32 v7, 63, v7
    v_subrev_u32 v8, 63, v8
    v_max_i32 v8, 0, v8
    v_min_u32 v15, 63, v8
    v_cmp_lt_u32 s[20:21], 0, v8
    v_lshl_or_b32 v9, v7, 6, v15
    s_nop 3
    s_cmp_eq_u64 s[20:21], 0
    s_cbranch_scc0 L_pb_65
    s_mov_b32 s18, 1
L_pe_67:
    s_mov_b32 s38, 0
    s_mov_b64 exec, 0
    s_branch L_pi_68
L_pr_70:
    s_cmp_lg_u32 s18, 0
    s_cbranch_scc1 L_pe_71
    s_mov_b64 exec, -1
    v_add_u32 v7, 63, v7
    v_subrev_u32 v8, 63, v8
    v_max_i32 v8, 0, v8
    v_min_u32 v15, 63, v8
    v_cmp_lt_u32 s[20:21], 0, v8
    v_lshl_or_b32 v9, v7, 6, v15
    s_nop 3
    s_cmp_eq_u64 s[20:21], 0
    s_cbranch_scc0 L_pb_69
    s_mov_b32 s18, 1
L_pe_71:
    s_mov_b32 s39, 0
    s_mov_b64 exec, 0
    s_branch L_pi_72
L_pr_74:
    s_cmp_lg_u32 s18, 0
    s_cbranch_scc1 L_pe_75
    s_mov_b64 exec, -1
    v_add_u32 v7, 63, v7
    v_subrev_u32 v8, 63, v8
    v_max_i32 v8, 0, v8
    v_min_u32 v15, 63, v8
    v_cmp_lt_u32 s[20:21], 0, v8
    v_lshl_or_b32 v9, v7, 6, v15
    s_nop 3
    s_cmp_eq_u64 s[20:21], 0
    s_cbranch_scc0 L_pb_73
    s_mov_b32 s18, 1
L_pe_75:
    s_mov_b32 s40, 0
    s_mov_b64 exec, 0
    s_branch L_pi_76
L_pr_78:
    s_cmp_lg_u32 s18, 0
    s_cbranch_scc1 L_pe_79
    s_mov_b64 exec, -1
    v_add_u32 v7, 63, v7
    v_subrev_u32 v8, 63, v8
    v_max_i32 v8, 0, v8
    v_min_u32 v15, 63, v8
    v_cmp_lt_u32 s[20:21], 0, v8
    v_lshl_or_b32 v9, v7, 6, v15
    s_nop 3
    s_cmp_eq_u64 s[20:21], 0
    s_cbranch_scc0 L_pb_77
    s_mov_b32 s18, 1
L_pe_79:
    s_mov_b32 s41, 0
    s_mov_b64 exec, 0
    s_branch L_pi_80
L_pr_82:
    s_cmp_lg_u32 s18, 0
    s_cbranch_scc1 L_pe_83
    s_mov_b64 exec, -1
    v_add_u32 v7, 63, v7
    v_subrev_u32 v8, 63, v8
    v_max_i32 v8, 0, v8
    v_min_u32 v15, 63, v8
    v_cmp_lt_u32 s[20:21], 0, v8
    v_lshl_or_b32 v9, v7, 6, v15
    s_nop 3
    s_cmp_eq_u64 s[20:21], 0
    s_cbranch_scc0 L_pb_81
    s_mov_b32 s18, 1
L_pe_83:
    s_mov_b32 s42, 0
    s_mov_b64 exec, 0
    s_branch L_pi_84
L_pr_86:
    s_cmp_lg_u32 s18, 0
    s_cbranch_scc1 L_pe_87
    s_mov_b64 exec, -1
    v_add_u32 v7, 63, v7
    v_subrev_u32 v8, 63, v8
    v_max_i32 v8, 0, v8
    v_min_u32 v15, 63, v8
    v_cmp_lt_u32 s[20:21], 0, v8
    v_lshl_or_b32 v9, v7, 6, v15
    s_nop 3
    s_cmp_eq_u64 s[20:21], 0
    s_cbranch_scc0 L_pb_85
    s_mov_b32 s18, 1
L_pe_87:
    s_mov_b32 s43, 0
    s_mov_b64 exec, 0
    s_branch L_pi_88
L_pr_90:
    s_cmp_lg_u32 s18, 0
    s_cbranch_scc1 L_pe_91
    s_mov_b64 exec, -1
    v_add_u32 v7, 63, v7
    v_subrev_u32 v8, 63, v8
    v_max_i32 v8, 0, v8
    v_min_u32 v15, 63, v8
    v_cmp_lt_u32 s[20:21], 0, v8
    v_lshl_or_b32 v9, v7, 6, v15
    s_nop 3
    s_cmp_eq_u64 s[20:21], 0
    s_cbranch_scc0 L_pb_89
    s_mov_b32 s18, 1
L_pe_91:
    s_mov_b32 s44, 0
    s_mov_b64 exec, 0
    s_branch L_pi_92
L_pr_94:
    s_cmp_lg_u32 s18, 0
    s_cbranch_scc1 L_pe_95
    s_mov_b64 exec, -1
    v_add_u32 v7, 63, v7
    v_subrev_u32 v8, 63, v8
    v_max_i32 v8, 0, v8
    v_min_u32 v15, 63, v8
    v_cmp_lt_u32 s[20:21], 0, v8
    v_lshl_or_b32 v9, v7, 6, v15
    s_nop 3
    s_cmp_eq_u64 s[20:21], 0
    s_cbranch_scc0 L_pb_93
    s_mov_b32 s18, 1
L_pe_95:
    s_mov_b32 s45, 0
    s_mov_b64 exec, 0
    s_branch L_pi_96
L_pr_98:
    s_cmp_lg_u32 s18, 0
    s_cbranch_scc1 L_pe_99
    s_mov_b64 exec, -1
    v_add_u32 v7, 63, v7
    v_subrev_u32 v8, 63, v8
    v_max_i32 v8, 0, v8
    v_min_u32 v15, 63, v8
    v_cmp_lt_u32 s[20:21], 0, v8
    v_lshl_or_b32 v9, v7, 6, v15
    s_nop 3
    s_cmp_eq_u64 s[20:21], 0
    s_cbranch_scc0 L_pb_97
    s_mov_b32 s18, 1
L_pe_99:
    s_mov_b32 s46, 0
    s_mov_b64 exec, 0
    s_branch L_pi_100
L_pr_102:
    s_cmp_lg_u32 s18, 0
    s_cbranch_scc1 L_pe_103
    s_mov_b64 exec, -1
    v_add_u32 v7, 63, v7
    v_subrev_u32 v8, 63, v8
    v_max_i32 v8, 0, v8
    v_min_u32 v15, 63, v8
    v_cmp_lt_u32 s[20:21], 0, v8
    v_lshl_or_b32 v9, v7, 6, v15
    s_nop 3
    s_cmp_eq_u64 s[20:21], 0
    s_cbranch_scc0 L_pb_101
    s_mov_b32 s18, 1
L_pe_103:
    s_mov_b32 s48, 0
    s_mov_b64 exec, 0
    s_branch L_pi_104
L_pr_106:
    s_cmp_lg_u32 s18, 0
    s_cbranch_scc1 L_pe_107
    s_mov_b64 exec, -1
    v_add_u32 v7, 63, v7
    v_subrev_u32 v8, 63, v8
    v_max_i32 v8, 0, v8
    v_min_u32 v15, 63, v8
    v_cmp_lt_u32 s[20:21], 0, v8
    v_lshl_or_b32 v9, v7, 6, v15
    s_nop 3
    s_cmp_eq_u64 s[20:21], 0
    s_cbranch_scc0 L_pb_105
    s_mov_b32 s18, 1
L_pe_107:
    s_mov_b32 s49, 0
    s_mov_b64 exec, 0
    s_branch L_pi_108
L_pr_110:
    s_cmp_lg_u32 s18, 0
    s_cbranch_scc1 L_pe_111
    s_mov_b64 exec, -1
    v_add_u32 v7, 63, v7
    v_subrev_u32 v8, 63, v8
    v_max_i32 v8, 0, v8
    v_min_u32 v15, 63, v8
    v_cmp_lt_u32 s[20:21], 0, v8
    v_lshl_or_b32 v9, v7, 6, v15
    s_nop 3
    s_cmp_eq_u64 s[20:21], 0
    s_cbranch_scc0 L_pb_109
    s_mov_b32 s18, 1
L_pe_111:
    s_mov_b32 s50, 0
    s_mov_b64 exec, 0
    s_branch L_pi_112
L_pr_114:
    s_cmp_lg_u32 s18, 0
    s_cbranch_scc1 L_pe_115
    s_mov_b64 exec, -1
    v_add_u32 v7, 63, v7
    v_subrev_u32 v8, 63, v8
    v_max_i32 v8, 0, v8
    v_min_u32 v15, 63, v8
    v_cmp_lt_u32 s[20:21], 0, v8
    v_lshl_or_b32 v9, v7, 6, v15
    s_nop 3
    s_cmp_eq_u64 s[20:21], 0
    s_cbranch_scc0 L_pb_113
    s_mov_b32 s18, 1
L_pe_115:
    s_mov_b32 s51, 0
    s_mov_b64 exec, 0
    s_branch L_pi_116
L_pr_118:
    s_cmp_lg_u32 s18, 0
    s_cbranch_scc1 L_pe_119
    s_mov_b64 exec, -1
    v_add_u32 v7, 63, v7
    v_subrev_u32 v8, 63, v8
    v_max_i32 v8, 0, v8
    v_min_u32 v15, 63, v8
    v_cmp_lt_u32 s[20:21], 0, v8
    v_lshl_or_b32 v9, v7, 6, v15
    s_nop 3
    s_cmp_eq_u64 s[20:21], 0
    s_cbranch_scc0 L_pb_117
    s_mov_b32 s18, 1
L_pe_119:
    s_mov_b32 s52, 0
    s_mov_b64 exec, 0
    s_branch L_pi_120
L_pr_122:
    s_cmp_lg_u32 s18, 0
    s_cbranch_scc1 L_pe_123
    s_mov_b64 exec, -1
    v_add_u32 v7, 63, v7
    v_subrev_u32 v8, 63, v8
    v_max_i32 v8, 0, v8
    v_min_u32 v15, 63, v8
    v_cmp_lt_u32 s[20:21], 0, v8
    v_lshl_or_b32 v9, v7, 6, v15
    s_nop 3
    s_cmp_eq_u64 s[20:21], 0
    s_cbranch_scc0 L_pb_121
    s_mov_b32 s18, 1
L_pe_123:
    s_mov_b32 s53, 0
    s_mov_b64 exec, 0
    s_branch L_pi_124
L_pr_126:
    s_cmp_lg_u32 s18, 0
    s_cbranch_scc1 L_pe_127
    s_mov_b64 exec, -1
    v_add_u32 v7, 63, v7
    v_subrev_u32 v8, 63, v8
    v_max_i32 v8, 0, v8
    v_min_u32 v15, 63, v8
    v_cmp_lt_u32 s[20:21], 0, v8
    v_lshl_or_b32 v9, v7, 6, v15
    s_nop 3
    s_cmp_eq_u64 s[20:21], 0
    s_cbranch_scc0 L_pb_125
    s_mov_b32 s18, 1
L_pe_127:
    s_mov_b32 s54, 0
    s_mov_b64 exec, 0
    s_branch L_pi_128
L_pr_130:
    s_cmp_lg_u32 s18, 0
    s_cbranch_scc1 L_pe_131
    s_mov_b64 exec, -1
    v_add_u32 v7, 63, v7
    v_subrev_u32 v8, 63, v8
    v_max_i32 v8, 0, v8
    v_min_u32 v15, 63, v8
    v_cmp_lt_u32 s[20:21], 0, v8
    v_lshl_or_b32 v9, v7, 6, v15
    s_nop 3
    s_cmp_eq_u64 s[20:21], 0
    s_cbranch_scc0 L_pb_129
    s_mov_b32 s18, 1
L_pe_131:
    s_mov_b32 s55, 0
    s_mov_b64 exec, 0
    s_branch L_pi_132
L_pr_134:
    s_cmp_lg_u32 s18, 0
    s_cbranch_scc1 L_pe_135
    s_mov_b64 exec, -1
    v_add_u32 v7, 63, v7
    v_subrev_u32 v8, 63, v8
    v_max_i32 v8, 0, v8
    v_min_u32 v15, 63, v8
    v_cmp_lt_u32 s[20:21], 0, v8
    v_lshl_or_b32 v9, v7, 6, v15
    s_nop 3
    s_cmp_eq_u64 s[20:21], 0
    s_cbranch_scc0 L_pb_133
    s_mov_b32 s18, 1
L_pe_135:
    s_mov_b32 s56, 0
    s_mov_b64 exec, 0
    s_branch L_pi_136
L_pr_138:
    s_cmp_lg_u32 s18, 0
    s_cbranch_scc1 L_pe_139
    s_mov_b64 exec, -1
    v_add_u32 v7, 63, v7
    v_subrev_u32 v8, 63, v8
    v_max_i32 v8, 0, v8
    v_min_u32 v15, 63, v8
    v_cmp_lt_u32 s[20:21], 0, v8
    v_lshl_or_b32 v9, v7, 6, v15
    s_nop 3
    s_cmp_eq_u64 s[20:21], 0
    s_cbranch_scc0 L_pb_137
    s_mov_b32 s18, 1
L_pe_139:
    s_mov_b32 s57, 0
    s_mov_b64 exec, 0
    s_branch L_pi_140
L_pr_142:
    s_cmp_lg_u32 s18, 0
    s_cbranch_scc1 L_pe_143
    s_mov_b64 exec, -1
    v_add_u32 v7, 63, v7
    v_subrev_u32 v8, 63, v8
    v_max_i32 v8, 0, v8
    v_min_u32 v15, 63, v8
    v_cmp_lt_u32 s[20:21], 0, v8
    v_lshl_or_b32 v9, v7, 6, v15
    s_nop 3
    s_cmp_eq_u64 s[20:21], 0
    s_cbranch_scc0 L_pb_141
    s_mov_b32 s18, 1
L_pe_143:
    s_mov_b32 s58, 0
    s_mov_b64 exec, 0
    s_branch L_pi_144
L_pr_146:
    s_cmp_lg_u32 s18, 0
    s_cbranch_scc1 L_pe_147
    s_mov_b64 exec, -1
    v_add_u32 v7, 63, v7
    v_subrev_u32 v8, 63, v8
    v_max_i32 v8, 0, v8
    v_min_u32 v15, 63, v8
    v_cmp_lt_u32 s[20:21], 0, v8
    v_lshl_or_b32 v9, v7, 6, v15
    s_nop 3
    s_cmp_eq_u64 s[20:21], 0
    s_cbranch_scc0 L_pb_145
    s_mov_b32 s18, 1
L_pe_147:
    s_mov_b32 s59, 0
    s_mov_b64 exec, 0
    s_branch L_pi_148
L_pr_150:
    s_cmp_lg_u32 s18, 0
    s_cbranch_scc1 L_pe_151
    s_mov_b64 exec, -1
    v_add_u32 v7, 63, v7
    v_subrev_u32 v8, 63, v8
    v_max_i32 v8, 0, v8
    v_min_u32 v15, 63, v8
    v_cmp_lt_u32 s[20:21], 0, v8
    v_lshl_or_b32 v9, v7, 6, v15
    s_nop 3
    s_cmp_eq_u64 s[20:21], 0
    s_cbranch_scc0 L_pb_149
    s_mov_b32 s18, 1
L_pe_151:
    s_mov_b32 s60, 0
    s_mov_b64 exec, 0
    s_branch L_pi_152
L_pr_154:
    s_cmp_lg_u32 s18, 0
    s_cbranch_scc1 L_pe_155
    s_mov_b64 exec, -1
    v_add_u32 v7, 63, v7
    v_subrev_u32 v8, 63, v8
    v_max_i32 v8, 0, v8
    v_min_u32 v15, 63, v8
    v_cmp_lt_u32 s[20:21], 0, v8
    v_lshl_or_b32 v9, v7, 6, v15
    s_nop 3
    s_cmp_eq_u64 s[20:21], 0
    s_cbranch_scc0 L_pb_153
    s_mov_b32 s18, 1
L_pe_155:
    s_mov_b32 s61, 0
    s_mov_b64 exec, 0
    s_branch L_pi_156
L_pr_158:
    s_cmp_lg_u32 s18, 0
    s_cbranch_scc1 L_pe_159
    s_mov_b64 exec, -1
    v_add_u32 v7, 63, v7
    v_subrev_u32 v8, 63, v8
    v_max_i32 v8, 0, v8
    v_min_u32 v15, 63, v8
    v_cmp_lt_u32 s[20:21], 0, v8
    v_lshl_or_b32 v9, v7, 6, v15
    s_nop 3
    s_cmp_eq_u64 s[20:21], 0
    s_cbranch_scc0 L_pb_157
    s_mov_b32 s18, 1
L_pe_159:
    s_mov_b32 s62, 0
    s_mov_b64 exec, 0
    s_branch L_pi_160
L_hw0_162:
    s_waitcnt vmcnt(0)
    s_branch L_hw1_163
L_hs_164:
    s_waitcnt lgkmcnt(0)
    s_mov_b64 exec, s[66:67]
    s_cbranch_execz L_cs_173
    s_add_u32 s25, s64, 0
    buffer_store_dwordx4 v[16:19], v2, s[8:11], s25 offen sc0 sc1
L_cs_173:
    s_mov_b64 exec, s[68:69]
    s_cbranch_execz L_cs_174
    s_add_u32 s25, s64, 16384
    buffer_store_dwordx4 v[20:23], v2, s[8:11], s25 offen sc0 sc1
L_cs_174:
    s_mov_b64 exec, s[70:71]
    s_cbranch_execz L_cs_175
    s_add_u32 s25, s64, 32768
    buffer_store_dwordx4 v[24:27], v2, s[8:11], s25 offen sc0 sc1
L_cs_175:
    s_mov_b64 exec, -1
    s_sub_i32 s25, s29, 6144
    v_cmp_gt_i32 s[66:67], s25, v5
    s_sub_i32 s25, s29, 8192
    v_cmp_gt_i32 s[68:69], s25, v5
    s_sub_i32 s25, s29, 10240
    v_cmp_gt_i32 s[70:71], s25, v5
    s_mov_b64 exec, s[66:67]
    ds_read_b128 v[16:19], v3 offset:49152
    s_mov_b64 exec, s[68:69]
    ds_read_b128 v[20:23], v4 offset:0
    s_mov_b64 exec, s[70:71]
    ds_read_b128 v[24:27], v4 offset:16384
    s_waitcnt lgkmcnt(0)
    s_mov_b64 exec, s[66:67]
    s_cbranch_execz L_cs_176
    s_add_u32 s25, s64, 49152
    buffer_store_dwordx4 v[16:19], v2, s[8:11], s25 offen sc0 sc1
L_cs_176:
    s_mov_b64 exec, s[68:69]
    s_cbranch_execz L_cs_177
    s_add_u32 s25, s64, 65536
    buffer_store_dwordx4 v[20:23], v2, s[8:11], s25 offen sc0 sc1
L_cs_177:
    s_mov_b64 exec, s[70:71]
    s_cbranch_execz L_cs_178
    s_add_u32 s25, s64, 81920
    buffer_store_dwordx4 v[24:27], v2, s[8:11], s25 offen sc0 sc1
L_cs_178:
    s_mov_b64 exec, -1
    s_sub_i32 s25, s29, 12288
    v_cmp_gt_i32 s[66:67], s25, v5
    s_sub_i32 s25, s29, 14336
    v_cmp_gt_i32 s[68:69], s25, v5
    s_mov_b64 exec, s[66:67]
    ds_read_b128 v[16:19], v4 offset:32768
    s_mov_b64 exec, s[68:69]
    ds_read_b128 v[20:23], v4 offset:49152
    s_bfm_b64 exec, s32, 0
    v_fma_mix_f32 v12, v88, v29, s16 op_sel_hi:[1,1,0]
    v_fma_mix_f32 v13, v88, v29, s16 op_sel:[1,0,0] op_sel_hi:[1,1,0]
    v_fma_mix_f32 v14, v89, v29, s16 op_sel_hi:[1,1,0]
    v_fma_mix_f32 v15, v89, v29, s16 op_sel:[1,0,0] op_sel_hi:[1,1,0]
    v_and_b32 v29, 0xfffff, v28
    v_lshl_add_u32 v88, v13, 13, v12
    v_mul_hi_u32_u24 v29, s17, v29
    v_lshl_add_u32 v89, v15, 13, v14
    v_lshrrev_b32 v12, 6, v28
    v_lshl_add_u32 v88, v28, 26, v88
    v_and_b32 v28, 0x3fc, v29
    v_lshl_add_u32 v89, v12, 26, v89
    ds_add_rtn_u32 v29, v28, v6 offset:0
    s_bfm_b64 exec, s33, 0
    v_fma_mix_f32 v12, v90, v31, s16 op_sel_hi:[1,1,0]
    v_fma_mix_f32 v13, v90, v31, s16 op_sel:[1,0,0] op_sel_hi:[1,1,0]
    v_fma_mix_f32 v14, v91, v31, s16 op_sel_hi:[1,1,0]
    v_fma_mix_f32 v15, v91, v31, s16 op_sel:[1,0,0] op_sel_hi:[1,1,0]
    v_and_b32 v31, 0xfffff, v30
    v_lshl_add_u32 v90, v13, 13, v12
    v_mul_hi_u32_u24 v31, s17, v31
    v_lshl_add_u32 v91, v15, 13, v14
    v_lshrrev_b32 v12, 6, v30
    v_lshl_add_u32 v90, v30, 26, v90
    v_and_b32 v30, 0x3fc, v31
    v_lshl_add_u32 v91, v12, 26, v91
    ds_add_rtn_u32 v31, v30, v6 offset:0
    s_bfm_b64 exec, s34, 0
    v_fma_mix_f32 v12, v92, v33, s16 op_sel_hi:[1,1,0]
    v_fma_mix_f32 v13, v92, v33, s16 op_sel:[1,0,0] op_sel_hi:[1,1,0]
    v_fma_mix_f32 v14, v93, v33, s16 op_sel_hi:[1,1,0]
    v_fma_mix_f32 v15, v93, v33, s16 op_sel:[1,0,0] op_sel_hi:[1,1,0]
    v_and_b32 v33, 0xfffff, v32
    v_lshl_add_u32 v92, v13, 13, v12
    v_mul_hi_u32_u24 v33, s17, v33
    v_lshl_add_u32 v93, v15, 13, v14
    v_lshrrev_b32 v12, 6, v32
    v_lshl_add_u32 v92, v32, 26, v92
    v_and_b32 v32, 0x3fc, v33
    v_lshl_add_u32 v93, v12, 26, v93
    ds_add_rtn_u32 v33, v32, v6 offset:0
    s_bfm_b64 exec, s35, 0
    v_fma_mix_f32 v12, v94, v35, s16 op_sel_hi:[1,1,0]
    v_fma_mix_f32 v13, v94, v35, s16 op_sel:[1,0,0] op_sel_hi:[1,1,0]
    v_fma_mix_f32 v14, v95, v35, s16 op_sel_hi:[1,1,0]
    v_fma_mix_f32 v15, v95, v35, s16 op_sel:[1,0,0] op_sel_hi:[1,1,0]
    v_and_b32 v35, 0xfffff, v34
    v_lshl_add_u32 v94, v13, 13, v12
    v_mul_hi_u32_u24 v35, s17, v35
    v_lshl_add_u32 v95, v15, 13, v14
    v_lshrrev_b32 v12, 6, v34
    v_lshl_add_u32 v94, v34, 26, v94
    v_and_b32 v34, 0x3fc, v35
    v_lshl_add_u32 v95, v12, 26, v95
    ds_add_rtn_u32 v35, v34, v6 offset:0
    s_bfm_b64 exec, s36, 0
    v_fma_mix_f32 v12, v96, v37, s16 op_sel_hi:[1,1,0]
    v_fma_mix_f32 v13, v96, v37, s16 op_sel:[1,0,0] op_sel_hi:[1,1,0]
    v_fma_mix_f32 v14, v97, v37, s16 op_sel_hi:[1,1,0]
    v_fma_mix_f32 v15, v97, v37, s16 op_sel:[1,0,0] op_sel_hi:[1,1,0]
    v_and_b32 v37, 0xfffff, v36
    v_lshl_add_u32 v96, v13, 13, v12
    v_mul_hi_u32_u24 v37, s17, v37
    v_lshl_add_u32 v97, v15, 13, v14
    v_lshrrev_b32 v12, 6, v36
    v_lshl_add_u32 v96, v36, 26, v96
    v_and_b32 v36, 0x3fc, v37
    v_lshl_add_u32 v97, v12, 26, v97
    ds_add_rtn_u32 v37, v36, v6 offset:0
    s_waitcnt lgkmcnt(5)
    s_mov_b64 exec, s[66:67]
    s_cbranch_execz L_cs_179
    s_add_u32 s25, s64, 98304
    buffer_store_dwordx4 v[16:19], v2, s[8:11], s25 offen sc0 sc1
L_cs_179:
    s_mov_b64 exec, s[68:69]
    s_cbranch_execz L_cs_180
    s_add_u32 s25, s64, 114688
    buffer_store_dwordx4 v[20:23], v2, s[8:11], s25 offen sc0 sc1
L_cs_180:
    s_branch L_h3_161
L_ovf_186:
    s_mov_b64 exec, 1
    v_mov_b32 v20, 1
    s_mov_b32 s25, 81297408
    buffer_atomic_add v20, v10, s[8:11], s25 offen sc0
    s_waitcnt vmcnt(0)
    v_readfirstlane_b32 s65, v20
    s_mov_b64 exec, -1
    s_nop 3
    s_add_u32 s65, s65, 1280
    s_branch L_ovfback_187
L_pr_189:
    s_cmp_lg_u32 s18, 0
    s_cbranch_scc1 L_pe_190
    s_mov_b64 exec, -1
    v_add_u32 v7, 63, v7
    v_subrev_u32 v8, 63, v8
    v_max_i32 v8, 0, v8
    v_min_u32 v15, 63, v8
    v_cmp_lt_u32 s[20:21], 0, v8
    v_lshl_or_b32 v9, v7, 6, v15
    s_nop 3
    s_cmp_eq_u64 s[20:21], 0
    s_cbranch_scc0 L_pb_188
    s_mov_b32 s18, 1
L_pe_190:
    s_mov_b32 s32, 0
    s_mov_b64 exec, 0
    s_branch L_pi_191
L_pr_193:
    s_cmp_lg_u32 s18, 0
    s_cbranch_scc1 L_pe_194
    s_mov_b64 exec, -1
    v_add_u32 v7, 63, v7
    v_subrev_u32 v8, 63, v8
    v_max_i32 v8, 0, v8
    v_min_u32 v15, 63, v8
    v_cmp_lt_u32 s[20:21], 0, v8
    v_lshl_or_b32 v9, v7, 6, v15
    s_nop 3
    s_cmp_eq_u64 s[20:21], 0
    s_cbranch_scc0 L_pb_192
    s_mov_b32 s18, 1
L_pe_194:
    s_mov_b32 s33, 0
    s_mov_b64 exec, 0
    s_branch L_pi_195
L_pr_197:
    s_cmp_lg_u32 s18, 0
    s_cbranch_scc1 L_pe_198
    s_mov_b64 exec, -1
    v_add_u32 v7, 63, v7
    v_subrev_u32 v8, 63, v8
    v_max_i32 v8, 0, v8
    v_min_u32 v15, 63, v8
    v_cmp_lt_u32 s[20:21], 0, v8
    v_lshl_or_b32 v9, v7, 6, v15
    s_nop 3
    s_cmp_eq_u64 s[20:21], 0
    s_cbranch_scc0 L_pb_196
    s_mov_b32 s18, 1
L_pe_198:
    s_mov_b32 s34, 0
    s_mov_b64 exec, 0
    s_branch L_pi_199
L_pr_201:
    s_cmp_lg_u32 s18, 0
    s_cbranch_scc1 L_pe_202
    s_mov_b64 exec, -1
    v_add_u32 v7, 63, v7
    v_subrev_u32 v8, 63, v8
    v_max_i32 v8, 0, v8
    v_min_u32 v15, 63, v8
    v_cmp_lt_u32 s[20:21], 0, v8
    v_lshl_or_b32 v9, v7, 6, v15
    s_nop 3
    s_cmp_eq_u64 s[20:21], 0
    s_cbranch_scc0 L_pb_200
    s_mov_b32 s18, 1
L_pe_202:
    s_mov_b32 s35, 0
    s_mov_b64 exec, 0
    s_branch L_pi_203
L_pr_205:
    s_cmp_lg_u32 s18, 0
    s_cbranch_scc1 L_pe_206
    s_mov_b64 exec, -1
    v_add_u32 v7, 63, v7
    v_subrev_u32 v8, 63, v8
    v_max_i32 v8, 0, v8
    v_min_u32 v15, 63, v8
    v_cmp_lt_u32 s[20:21], 0, v8
    v_lshl_or_b32 v9, v7, 6, v15
    s_nop 3
    s_cmp_eq_u64 s[20:21], 0
    s_cbranch_scc0 L_pb_204
    s_mov_b32 s18, 1
L_pe_206:
    s_mov_b32 s36, 0
    s_mov_b64 exec, 0
    s_branch L_pi_207
L_pr_209:
    s_cmp_lg_u32 s18, 0
    s_cbranch_scc1 L_pe_210
    s_mov_b64 exec, -1
    v_add_u32 v7, 63, v7
    v_subrev_u32 v8, 63, v8
    v_max_i32 v8, 0, v8
    v_min_u32 v15, 63, v8
    v_cmp_lt_u32 s[20:21], 0, v8
    v_lshl_or_b32 v9, v7, 6, v15
    s_nop 3
    s_cmp_eq_u64 s[20:21], 0
    s_cbranch_scc0 L_pb_208
    s_mov_b32 s18, 1
L_pe_210:
    s_mov_b32 s37, 0
    s_mov_b64 exec, 0
    s_branch L_pi_211
L_pr_213:
    s_cmp_lg_u32 s18, 0
    s_cbranch_scc1 L_pe_214
    s_mov_b64 exec, -1
    v_add_u32 v7, 63, v7
    v_subrev_u32 v8, 63, v8
    v_max_i32 v8, 0, v8
    v_min_u32 v15, 63, v8
    v_cmp_lt_u32 s[20:21], 0, v8
    v_lshl_or_b32 v9, v7, 6, v15
    s_nop 3
    s_cmp_eq_u64 s[20:21], 0
    s_cbranch_scc0 L_pb_212
    s_mov_b32 s18, 1
L_pe_214:
    s_mov_b32 s38, 0
    s_mov_b64 exec, 0
    s_branch L_pi_215
L_pr_217:
    s_cmp_lg_u32 s18, 0
    s_cbranch_scc1 L_pe_218
    s_mov_b64 exec, -1
    v_add_u32 v7, 63, v7
    v_subrev_u32 v8, 63, v8
    v_max_i32 v8, 0, v8
    v_min_u32 v15, 63, v8
    v_cmp_lt_u32 s[20:21], 0, v8
    v_lshl_or_b32 v9, v7, 6, v15
    s_nop 3
    s_cmp_eq_u64 s[20:21], 0
    s_cbranch_scc0 L_pb_216
    s_mov_b32 s18, 1
L_pe_218:
    s_mov_b32 s39, 0
    s_mov_b64 exec, 0
    s_branch L_pi_219
L_pr_221:
    s_cmp_lg_u32 s18, 0
    s_cbranch_scc1 L_pe_222
    s_mov_b64 exec, -1
    v_add_u32 v7, 63, v7
    v_subrev_u32 v8, 63, v8
    v_max_i32 v8, 0, v8
    v_min_u32 v15, 63, v8
    v_cmp_lt_u32 s[20:21], 0, v8
    v_lshl_or_b32 v9, v7, 6, v15
    s_nop 3
    s_cmp_eq_u64 s[20:21], 0
    s_cbranch_scc0 L_pb_220
    s_mov_b32 s18, 1
L_pe_222:
    s_mov_b32 s40, 0
    s_mov_b64 exec, 0
    s_branch L_pi_223
L_pr_225:
    s_cmp_lg_u32 s18, 0
    s_cbranch_scc1 L_pe_226
    s_mov_b64 exec, -1
    v_add_u32 v7, 63, v7
    v_subrev_u32 v8, 63, v8
    v_max_i32 v8, 0, v8
    v_min_u32 v15, 63, v8
    v_cmp_lt_u32 s[20:21], 0, v8
    v_lshl_or_b32 v9, v7, 6, v15
    s_nop 3
    s_cmp_eq_u64 s[20:21], 0
    s_cbranch_scc0 L_pb_224
    s_mov_b32 s18, 1
L_pe_226:
    s_mov_b32 s41, 0
    s_mov_b64 exec, 0
    s_branch L_pi_227
L_pr_229:
    s_cmp_lg_u32 s18, 0
    s_cbranch_scc1 L_pe_230
    s_mov_b64 exec, -1
    v_add_u32 v7, 63, v7
    v_subrev_u32 v8, 63, v8
    v_max_i32 v8, 0, v8
    v_min_u32 v15, 63, v8
    v_cmp_lt_u32 s[20:21], 0, v8
    v_lshl_or_b32 v9, v7, 6, v15
    s_nop 3
    s_cmp_eq_u64 s[20:21], 0
    s_cbranch_scc0 L_pb_228
    s_mov_b32 s18, 1
L_pe_230:
    s_mov_b32 s42, 0
    s_mov_b64 exec, 0
    s_branch L_pi_231
L_pr_233:
    s_cmp_lg_u32 s18, 0
    s_cbranch_scc1 L_pe_234
    s_mov_b64 exec, -1
    v_add_u32 v7, 63, v7
    v_subrev_u32 v8, 63, v8
    v_max_i32 v8, 0, v8
    v_min_u32 v15, 63, v8
    v_cmp_lt_u32 s[20:21], 0, v8
    v_lshl_or_b32 v9, v7, 6, v15
    s_nop 3
    s_cmp_eq_u64 s[20:21], 0
    s_cbranch_scc0 L_pb_232
    s_mov_b32 s18, 1
L_pe_234:
    s_mov_b32 s43, 0
    s_mov_b64 exec, 0
    s_branch L_pi_235
L_pr_237:
    s_cmp_lg_u32 s18, 0
    s_cbranch_scc1 L_pe_238
    s_mov_b64 exec, -1
    v_add_u32 v7, 63, v7
    v_subrev_u32 v8, 63, v8
    v_max_i32 v8, 0, v8
    v_min_u32 v15, 63, v8
    v_cmp_lt_u32 s[20:21], 0, v8
    v_lshl_or_b32 v9, v7, 6, v15
    s_nop 3
    s_cmp_eq_u64 s[20:21], 0
    s_cbranch_scc0 L_pb_236
    s_mov_b32 s18, 1
L_pe_238:
    s_mov_b32 s44, 0
    s_mov_b64 exec, 0
    s_branch L_pi_239
L_pr_241:
    s_cmp_lg_u32 s18, 0
    s_cbranch_scc1 L_pe_242
    s_mov_b64 exec, -1
    v_add_u32 v7, 63, v7
    v_subrev_u32 v8, 63, v8
    v_max_i32 v8, 0, v8
    v_min_u32 v15, 63, v8
    v_cmp_lt_u32 s[20:21], 0, v8
    v_lshl_or_b32 v9, v7, 6, v15
    s_nop 3
    s_cmp_eq_u64 s[20:21], 0
    s_cbranch_scc0 L_pb_240
    s_mov_b32 s18, 1
L_pe_242:
    s_mov_b32 s45, 0
    s_mov_b64 exec, 0
    s_branch L_pi_243
L_pr_245:
    s_cmp_lg_u32 s18, 0
    s_cbranch_scc1 L_pe_246
    s_mov_b64 exec, -1
    v_add_u32 v7, 63, v7
    v_subrev_u32 v8, 63, v8
    v_max_i32 v8, 0, v8
    v_min_u32 v15, 63, v8
    v_cmp_lt_u32 s[20:21], 0, v8
    v_lshl_or_b32 v9, v7, 6, v15
    s_nop 3
    s_cmp_eq_u64 s[20:21], 0
    s_cbranch_scc0 L_pb_244
    s_mov_b32 s18, 1
L_pe_246:
    s_mov_b32 s46, 0
    s_mov_b64 exec, 0
    s_branch L_pi_247
L_sn_183:
    s_bfm_b64 exec, s32, 0
    v_add_u32 v28, v28, v29
    ds_write_b64 v28, v[88:89] offset:36864
    s_mov_b32 s32, 0
    s_bfm_b64 exec, s33, 0
    v_add_u32 v30, v30, v31
    ds_write_b64 v30, v[90:91] offset:36864
    s_mov_b32 s33, 0
    s_bfm_b64 exec, s34, 0
    v_add_u32 v32, v32, v33
    ds_write_b64 v32, v[92:93] offset:36864
    s_mov_b32 s34, 0
    s_bfm_b64 exec, s35, 0
    v_add_u32 v34, v34, v35
    ds_write_b64 v34, v[94:95] offset:36864
    s_mov_b32 s35, 0
    s_bfm_b64 exec, s36, 0
    v_add_u32 v36, v36, v37
    ds_write_b64 v36, v[96:97] offset:36864
    s_mov_b32 s36, 0
    s_cmp_eq_u32 s37, 0
    s_cbranch_scc1 L_sf_184
    s_bfm_b64 exec, s37, 0
    v_add_u32 v38, v38, v39
    ds_write_b64 v38, v[98:99] offset:36864
    s_mov_b32 s37, 0
    s_bfm_b64 exec, s38, 0
    v_add_u32 v40, v40, v41
    ds_write_b64 v40, v[100:101] offset:36864
    s_mov_b32 s38, 0
    s_bfm_b64 exec, s39, 0
    v_add_u32 v42, v42, v43
    ds_write_b64 v42, v[102:103] offset:36864
    s_mov_b32 s39, 0
    s_bfm_b64 exec, s40, 0
    v_add_u32 v44, v44, v45
    ds_write_b64 v44, v[104:105] offset:36864
    s_mov_b32 s40, 0
    s_bfm_b64 exec, s41, 0
    v_add_u32 v46, v46, v47
    ds_write_b64 v46, v[106:107] offset:36864
    s_mov_b32 s41, 0
    s_cmp_eq_u32 s42, 0
    s_cbranch_scc1 L_sf_184
    s_bfm_b64 exec, s42, 0
    v_add_u32 v48, v48, v49
    ds_write_b64 v48, v[108:109] offset:36864
    s_mov_b32 s42, 0
    s_bfm_b64 exec, s43, 0
    v_add_u32 v50, v50, v51
    ds_write_b64 v50, v[110:111] offset:36864
    s_mov_b32 s43, 0
    s_bfm_b64 exec, s44, 0
    v_add_u32 v52, v52, v53
    ds_write_b64 v52, v[112:113] offset:36864
    s_mov_b32 s44, 0
    s_bfm_b64 exec, s45, 0
    v_add_u32 v54, v54, v55
    ds_write_b64 v54, v[114:115] offset:36864
    s_mov_b32 s45, 0
    s_bfm_b64 exec, s46, 0
    v_add_u32 v56, v56, v57
    ds_write_b64 v56, v[116:117] offset:36864
    s_mov_b32 s46, 0
    s_branch L_sf_184
L_hw0_249:
    s_waitcnt vmcnt(0)
    s_branch L_hw1_250
L_hs_251:
    s_waitcnt lgkmcnt(0)
    s_mov_b64 exec, s[66:67]
    s_cbranch_execz L_cs_260
    s_add_u32 s25, s64, 0
    buffer_store_dwordx4 v[16:19], v2, s[8:11], s25 offen sc0 sc1
L_cs_260:
    s_mov_b64 exec, s[68:69]
    s_cbranch_execz L_cs_261
    s_add_u32 s25, s64, 16384
    buffer_store_dwordx4 v[20:23], v2, s[8:11], s25 offen sc0 sc1
L_cs_261:
    s_mov_b64 exec, s[70:71]
    s_cbranch_execz L_cs_262
    s_add_u32 s25, s64, 32768
    buffer_store_dwordx4 v[24:27], v2, s[8:11], s25 offen sc0 sc1
L_cs_262:
    s_mov_b64 exec, -1
    s_sub_i32 s25, s29, 6144
    v_cmp_gt_i32 s[66:67], s25, v5
    s_sub_i32 s25, s29, 8192
    v_cmp_gt_i32 s[68:69], s25, v5
    s_sub_i32 s25, s29, 10240
    v_cmp_gt_i32 s[70:71], s25, v5
    s_mov_b64 exec, s[66:67]
    ds_read_b128 v[16:19], v3 offset:49152
    s_mov_b64 exec, s[68:69]
    ds_read_b128 v[20:23], v4 offset:0
    s_mov_b64 exec, s[70:71]
    ds_read_b128 v[24:27], v4 offset:16384
    s_waitcnt lgkmcnt(0)
    s_mov_b64 exec, s[66:67]
    s_cbranch_execz L_cs_263
    s_add_u32 s25, s64, 49152
    buffer_store_dwordx4 v[16:19], v2, s[8:11], s25 offen sc0 sc1
L_cs_263:
    s_mov_b64 exec, s[68:69]
    s_cbranch_execz L_cs_264
    s_add_u32 s25, s64, 65536
    buffer_store_dwordx4 v[20:23], v2, s[8:11], s25 offen sc0 sc1
L_cs_264:
    s_mov_b64 exec, s[70:71]
    s_cbranch_execz L_cs_265
    s_add_u32 s25, s64, 81920
    buffer_store_dwordx4 v[24:27], v2, s[8:11], s25 offen sc0 sc1
L_cs_265:
    s_mov_b64 exec, -1
    s_sub_i32 s25, s29, 12288
    v_cmp_gt_i32 s[66:67], s25, v5
    s_sub_i32 s25, s29, 14336
    v_cmp_gt_i32 s[68:69], s25, v5
    s_mov_b64 exec, s[66:67]
    ds_read_b128 v[16:19], v4 offset:32768
    s_mov_b64 exec, s[68:69]
    ds_read_b128 v[20:23], v4 offset:49152
    s_bfm_b64 exec, s48, 0
    v_fma_mix_f32 v12, v88, v59, s16 op_sel_hi:[1,1,0]
    v_fma_mix_f32 v13, v88, v59, s16 op_sel:[1,0,0] op_sel_hi:[1,1,0]
    v_fma_mix_f32 v14, v89, v59, s16 op_sel_hi:[1,1,0]
    v_fma_mix_f32 v15, v89, v59, s16 op_sel:[1,0,0] op_sel_hi:[1,1,0]
    v_and_b32 v59, 0xfffff, v58
    v_lshl_add_u32 v88, v13, 13, v12
    v_mul_hi_u32_u24 v59, s17, v59
    v_lshl_add_u32 v89, v15, 13, v14
    v_lshrrev_b32 v12, 6, v58
    v_lshl_add_u32 v88, v58, 26, v88
    v_and_b32 v58, 0x3fc, v59
    v_lshl_add_u32 v89, v12, 26, v89
    ds_add_rtn_u32 v59, v58, v6 offset:0
    s_bfm_b64 exec, s49, 0
    v_fma_mix_f32 v12, v90, v61, s16 op_sel_hi:[1,1,0]
    v_fma_mix_f32 v13, v90, v61, s16 op_sel:[1,0,0] op_sel_hi:[1,1,0]
    v_fma_mix_f32 v14, v91, v61, s16 op_sel_hi:[1,1,0]
    v_fma_mix_f32 v15, v91, v61, s16 op_sel:[1,0,0] op_sel_hi:[1,1,0]
    v_and_b32 v61, 0xfffff, v60
    v_lshl_add_u32 v90, v13, 13, v12
    v_mul_hi_u32_u24 v61, s17, v61
    v_lshl_add_u32 v91, v15, 13, v14
    v_lshrrev_b32 v12, 6, v60
    v_lshl_add_u32 v90, v60, 26, v90
    v_and_b32 v60, 0x3fc, v61
    v_lshl_add_u32 v91, v12, 26, v91
    ds_add_rtn_u32 v61, v60, v6 offset:0
    s_bfm_b64 exec, s50, 0
    v_fma_mix_f32 v12, v92, v63, s16 op_sel_hi:[1,1,0]
    v_fma_mix_f32 v13, v92, v63, s16 op_sel:[1,0,0] op_sel_hi:[1,1,0]
    v_fma_mix_f32 v14, v93, v63, s16 op_sel_hi:[1,1,0]
    v_fma_mix_f32 v15, v93, v63, s16 op_sel:[1,0,0] op_sel_hi:[1,1,0]
    v_and_b32 v63, 0xfffff, v62
    v_lshl_add_u32 v92, v13, 13, v12
    v_mul_hi_u32_u24 v63, s17, v63
    v_lshl_add_u32 v93, v15, 13, v14
    v_lshrrev_b32 v12, 6, v62
    v_lshl_add_u32 v92, v62, 26, v92
    v_and_b32 v62, 0x3fc, v63
    v_lshl_add_u32 v93, v12, 26, v93
    ds_add_rtn_u32 v63, v62, v6 offset:0
    s_bfm_b64 exec, s51, 0
    v_fma_mix_f32 v12, v94, v65, s16 op_sel_hi:[1,1,0]
    v_fma_mix_f32 v13, v94, v65, s16 op_sel:[1,0,0] op_sel_hi:[1,1,0]
    v_fma_mix_f32 v14, v95, v65, s16 op_sel_hi:[1,1,0]
    v_fma_mix_f32 v15, v95, v65, s16 op_sel:[1,0,0] op_sel_hi:[1,1,0]
    v_and_b32 v65, 0xfffff, v64
    v_lshl_add_u32 v94, v13, 13, v12
    v_mul_hi_u32_u24 v65, s17, v65
    v_lshl_add_u32 v95, v15, 13, v14
    v_lshrrev_b32 v12, 6, v64
    v_lshl_add_u32 v94, v64, 26, v94
    v_and_b32 v64, 0x3fc, v65
    v_lshl_add_u32 v95, v12, 26, v95
    ds_add_rtn_u32 v65, v64, v6 offset:0
    s_bfm_b64 exec, s52, 0
    v_fma_mix_f32 v12, v96, v67, s16 op_sel_hi:[1,1,0]
    v_fma_mix_f32 v13, v96, v67, s16 op_sel:[1,0,0] op_sel_hi:[1,1,0]
    v_fma_mix_f32 v14, v97, v67, s16 op_sel_hi:[1,1,0]
    v_fma_mix_f32 v15, v97, v67, s16 op_sel:[1,0,0] op_sel_hi:[1,1,0]
    v_and_b32 v67, 0xfffff, v66
    v_lshl_add_u32 v96, v13, 13, v12
    v_mul_hi_u32_u24 v67, s17, v67
    v_lshl_add_u32 v97, v15, 13, v14
    v_lshrrev_b32 v12, 6, v66
    v_lshl_add_u32 v96, v66, 26, v96
    v_and_b32 v66, 0x3fc, v67
    v_lshl_add_u32 v97, v12, 26, v97
    ds_add_rtn_u32 v67, v66, v6 offset:0
    s_waitcnt lgkmcnt(5)
    s_mov_b64 exec, s[66:67]
    s_cbranch_execz L_cs_266
    s_add_u32 s25, s64, 98304
    buffer_store_dwordx4 v[16:19], v2, s[8:11], s25 offen sc0 sc1
L_cs_266:
    s_mov_b64 exec, s[68:69]
    s_cbranch_execz L_cs_267
    s_add_u32 s25, s64, 114688
    buffer_store_dwordx4 v[20:23], v2, s[8:11], s25 offen sc0 sc1
L_cs_267:
    s_branch L_h3_248
L_ovf_273:
    s_mov_b64 exec, 1
    v_mov_b32 v20, 1
    s_mov_b32 s25, 81297408
    buffer_atomic_add v20, v10, s[8:11], s25 offen sc0
    s_waitcnt vmcnt(0)
    v_readfirstlane_b32 s65, v20
    s_mov_b64 exec, -1
    s_nop 3
    s_add_u32 s65, s65, 1280
    s_branch L_ovfback_274
L_pr_276:
    s_cmp_lg_u32 s18, 0
    s_cbranch_scc1 L_pe_277
    s_mov_b64 exec, -1
    v_add_u32 v7, 63, v7
    v_subrev_u32 v8, 63, v8
    v_max_i32 v8, 0, v8
    v_min_u32 v15, 63, v8
    v_cmp_lt_u32 s[20:21], 0, v8
    v_lshl_or_b32 v9, v7, 6, v15
    s_nop 3
    s_cmp_eq_u64 s[20:21], 0
    s_cbranch_scc0 L_pb_275
    s_mov_b32 s18, 1
L_pe_277:
    s_mov_b32 s48, 0
    s_mov_b64 exec, 0
    s_branch L_pi_278
L_pr_280:
    s_cmp_lg_u32 s18, 0
    s_cbranch_scc1 L_pe_281
    s_mov_b64 exec, -1
    v_add_u32 v7, 63, v7
    v_subrev_u32 v8, 63, v8
    v_max_i32 v8, 0, v8
    v_min_u32 v15, 63, v8
    v_cmp_lt_u32 s[20:21], 0, v8
    v_lshl_or_b32 v9, v7, 6, v15
    s_nop 3
    s_cmp_eq_u64 s[20:21], 0
    s_cbranch_scc0 L_pb_279
    s_mov_b32 s18, 1
L_pe_281:
    s_mov_b32 s49, 0
    s_mov_b64 exec, 0
    s_branch L_pi_282
L_pr_284:
    s_cmp_lg_u32 s18, 0
    s_cbranch_scc1 L_pe_285
    s_mov_b64 exec, -1
    v_add_u32 v7, 63, v7
    v_subrev_u32 v8, 63, v8
    v_max_i32 v8, 0, v8
    v_min_u32 v15, 63, v8
    v_cmp_lt_u32 s[20:21], 0, v8
    v_lshl_or_b32 v9, v7, 6, v15
    s_nop 3
    s_cmp_eq_u64 s[20:21], 0
    s_cbranch_scc0 L_pb_283
    s_mov_b32 s18, 1
L_pe_285:
    s_mov_b32 s50, 0
    s_mov_b64 exec, 0
    s_branch L_pi_286
L_pr_288:
    s_cmp_lg_u32 s18, 0
    s_cbranch_scc1 L_pe_289
    s_mov_b64 exec, -1
    v_add_u32 v7, 63, v7
    v_subrev_u32 v8, 63, v8
    v_max_i32 v8, 0, v8
    v_min_u32 v15, 63, v8
    v_cmp_lt_u32 s[20:21], 0, v8
    v_lshl_or_b32 v9, v7, 6, v15
    s_nop 3
    s_cmp_eq_u64 s[20:21], 0
    s_cbranch_scc0 L_pb_287
    s_mov_b32 s18, 1
L_pe_289:
    s_mov_b32 s51, 0
    s_mov_b64 exec, 0
    s_branch L_pi_290
L_pr_292:
    s_cmp_lg_u32 s18, 0
    s_cbranch_scc1 L_pe_293
    s_mov_b64 exec, -1
    v_add_u32 v7, 63, v7
    v_subrev_u32 v8, 63, v8
    v_max_i32 v8, 0, v8
    v_min_u32 v15, 63, v8
    v_cmp_lt_u32 s[20:21], 0, v8
    v_lshl_or_b32 v9, v7, 6, v15
    s_nop 3
    s_cmp_eq_u64 s[20:21], 0
    s_cbranch_scc0 L_pb_291
    s_mov_b32 s18, 1
L_pe_293:
    s_mov_b32 s52, 0
    s_mov_b64 exec, 0
    s_branch L_pi_294
L_pr_296:
    s_cmp_lg_u32 s18, 0
    s_cbranch_scc1 L_pe_297
    s_mov_b64 exec, -1
    v_add_u32 v7, 63, v7
    v_subrev_u32 v8, 63, v8
    v_max_i32 v8, 0, v8
    v_min_u32 v15, 63, v8
    v_cmp_lt_u32 s[20:21], 0, v8
    v_lshl_or_b32 v9, v7, 6, v15
    s_nop 3
    s_cmp_eq_u64 s[20:21], 0
    s_cbranch_scc0 L_pb_295
    s_mov_b32 s18, 1
L_pe_297:
    s_mov_b32 s53, 0
    s_mov_b64 exec, 0
    s_branch L_pi_298
L_pr_300:
    s_cmp_lg_u32 s18, 0
    s_cbranch_scc1 L_pe_301
    s_mov_b64 exec, -1
    v_add_u32 v7, 63, v7
    v_subrev_u32 v8, 63, v8
    v_max_i32 v8, 0, v8
    v_min_u32 v15, 63, v8
    v_cmp_lt_u32 s[20:21], 0, v8
    v_lshl_or_b32 v9, v7, 6, v15
    s_nop 3
    s_cmp_eq_u64 s[20:21], 0
    s_cbranch_scc0 L_pb_299
    s_mov_b32 s18, 1
L_pe_301:
    s_mov_b32 s54, 0
    s_mov_b64 exec, 0
    s_branch L_pi_302
L_pr_304:
    s_cmp_lg_u32 s18, 0
    s_cbranch_scc1 L_pe_305
    s_mov_b64 exec, -1
    v_add_u32 v7, 63, v7
    v_subrev_u32 v8, 63, v8
    v_max_i32 v8, 0, v8
    v_min_u32 v15, 63, v8
    v_cmp_lt_u32 s[20:21], 0, v8
    v_lshl_or_b32 v9, v7, 6, v15
    s_nop 3
    s_cmp_eq_u64 s[20:21], 0
    s_cbranch_scc0 L_pb_303
    s_mov_b32 s18, 1
L_pe_305:
    s_mov_b32 s55, 0
    s_mov_b64 exec, 0
    s_branch L_pi_306
L_pr_308:
    s_cmp_lg_u32 s18, 0
    s_cbranch_scc1 L_pe_309
    s_mov_b64 exec, -1
    v_add_u32 v7, 63, v7
    v_subrev_u32 v8, 63, v8
    v_max_i32 v8, 0, v8
    v_min_u32 v15, 63, v8
    v_cmp_lt_u32 s[20:21], 0, v8
    v_lshl_or_b32 v9, v7, 6, v15
    s_nop 3
    s_cmp_eq_u64 s[20:21], 0
    s_cbranch_scc0 L_pb_307
    s_mov_b32 s18, 1
L_pe_309:
    s_mov_b32 s56, 0
    s_mov_b64 exec, 0
    s_branch L_pi_310
L_pr_312:
    s_cmp_lg_u32 s18, 0
    s_cbranch_scc1 L_pe_313
    s_mov_b64 exec, -1
    v_add_u32 v7, 63, v7
    v_subrev_u32 v8, 63, v8
    v_max_i32 v8, 0, v8
    v_min_u32 v15, 63, v8
    v_cmp_lt_u32 s[20:21], 0, v8
    v_lshl_or_b32 v9, v7, 6, v15
    s_nop 3
    s_cmp_eq_u64 s[20:21], 0
    s_cbranch_scc0 L_pb_311
    s_mov_b32 s18, 1
L_pe_313:
    s_mov_b32 s57, 0
    s_mov_b64 exec, 0
    s_branch L_pi_314
L_pr_316:
    s_cmp_lg_u32 s18, 0
    s_cbranch_scc1 L_pe_317
    s_mov_b64 exec, -1
    v_add_u32 v7, 63, v7
    v_subrev_u32 v8, 63, v8
    v_max_i32 v8, 0, v8
    v_min_u32 v15, 63, v8
    v_cmp_lt_u32 s[20:21], 0, v8
    v_lshl_or_b32 v9, v7, 6, v15
    s_nop 3
    s_cmp_eq_u64 s[20:21], 0
    s_cbranch_scc0 L_pb_315
    s_mov_b32 s18, 1
L_pe_317:
    s_mov_b32 s58, 0
    s_mov_b64 exec, 0
    s_branch L_pi_318
L_pr_320:
    s_cmp_lg_u32 s18, 0
    s_cbranch_scc1 L_pe_321
    s_mov_b64 exec, -1
    v_add_u32 v7, 63, v7
    v_subrev_u32 v8, 63, v8
    v_max_i32 v8, 0, v8
    v_min_u32 v15, 63, v8
    v_cmp_lt_u32 s[20:21], 0, v8
    v_lshl_or_b32 v9, v7, 6, v15
    s_nop 3
    s_cmp_eq_u64 s[20:21], 0
    s_cbranch_scc0 L_pb_319
    s_mov_b32 s18, 1
L_pe_321:
    s_mov_b32 s59, 0
    s_mov_b64 exec, 0
    s_branch L_pi_322
L_pr_324:
    s_cmp_lg_u32 s18, 0
    s_cbranch_scc1 L_pe_325
    s_mov_b64 exec, -1
    v_add_u32 v7, 63, v7
    v_subrev_u32 v8, 63, v8
    v_max_i32 v8, 0, v8
    v_min_u32 v15, 63, v8
    v_cmp_lt_u32 s[20:21], 0, v8
    v_lshl_or_b32 v9, v7, 6, v15
    s_nop 3
    s_cmp_eq_u64 s[20:21], 0
    s_cbranch_scc0 L_pb_323
    s_mov_b32 s18, 1
L_pe_325:
    s_mov_b32 s60, 0
    s_mov_b64 exec, 0
    s_branch L_pi_326
L_pr_328:
    s_cmp_lg_u32 s18, 0
    s_cbranch_scc1 L_pe_329
    s_mov_b64 exec, -1
    v_add_u32 v7, 63, v7
    v_subrev_u32 v8, 63, v8
    v_max_i32 v8, 0, v8
    v_min_u32 v15, 63, v8
    v_cmp_lt_u32 s[20:21], 0, v8
    v_lshl_or_b32 v9, v7, 6, v15
    s_nop 3
    s_cmp_eq_u64 s[20:21], 0
    s_cbranch_scc0 L_pb_327
    s_mov_b32 s18, 1
L_pe_329:
    s_mov_b32 s61, 0
    s_mov_b64 exec, 0
    s_branch L_pi_330
L_pr_332:
    s_cmp_lg_u32 s18, 0
    s_cbranch_scc1 L_pe_333
    s_mov_b64 exec, -1
    v_add_u32 v7, 63, v7
    v_subrev_u32 v8, 63, v8
    v_max_i32 v8, 0, v8
    v_min_u32 v15, 63, v8
    v_cmp_lt_u32 s[20:21], 0, v8
    v_lshl_or_b32 v9, v7, 6, v15
    s_nop 3
    s_cmp_eq_u64 s[20:21], 0
    s_cbranch_scc0 L_pb_331
    s_mov_b32 s18, 1
L_pe_333:
    s_mov_b32 s62, 0
    s_mov_b64 exec, 0
    s_branch L_pi_334
L_sn_270:
    s_bfm_b64 exec, s48, 0
    v_add_u32 v58, v58, v59
    ds_write_b64 v58, v[88:89] offset:36864
    s_mov_b32 s48, 0
    s_bfm_b64 exec, s49, 0
    v_add_u32 v60, v60, v61
    ds_write_b64 v60, v[90:91] offset:36864
    s_mov_b32 s49, 0
    s_bfm_b64 exec, s50, 0
    v_add_u32 v62, v62, v63
    ds_write_b64 v62, v[92:93] offset:36864
    s_mov_b32 s50, 0
    s_bfm_b64 exec, s51, 0
    v_add_u32 v64, v64, v65
    ds_write_b64 v64, v[94:95] offset:36864
    s_mov_b32 s51, 0
    s_bfm_b64 exec, s52, 0
    v_add_u32 v66, v66, v67
    ds_write_b64 v66, v[96:97] offset:36864
    s_mov_b32 s52, 0
    s_cmp_eq_u32 s53, 0
    s_cbranch_scc1 L_sf_271
    s_bfm_b64 exec, s53, 0
    v_add_u32 v68, v68, v69
    ds_write_b64 v68, v[98:99] offset:36864
    s_mov_b32 s53, 0
    s_bfm_b64 exec, s54, 0
    v_add_u32 v70, v70, v71
    ds_write_b64 v70, v[100:101] offset:36864
    s_mov_b32 s54, 0
    s_bfm_b64 exec, s55, 0
    v_add_u32 v72, v72, v73
    ds_write_b64 v72, v[102:103] offset:36864
    s_mov_b32 s55, 0
    s_bfm_b64 exec, s56, 0
    v_add_u32 v74, v74, v75
    ds_write_b64 v74, v[104:105] offset:36864
    s_mov_b32 s56, 0
    s_bfm_b64 exec, s57, 0
    v_add_u32 v76, v76, v77
    ds_write_b64 v76, v[106:107] offset:36864
    s_mov_b32 s57, 0
    s_cmp_eq_u32 s58, 0
    s_cbranch_scc1 L_sf_271
    s_bfm_b64 exec, s58, 0
    v_add_u32 v78, v78, v79
    ds_write_b64 v78, v[108:109] offset:36864
    s_mov_b32 s58, 0
    s_bfm_b64 exec, s59, 0
    v_add_u32 v80, v80, v81
    ds_write_b64 v80, v[110:111] offset:36864
    s_mov_b32 s59, 0
    s_bfm_b64 exec, s60, 0
    v_add_u32 v82, v82, v83
    ds_write_b64 v82, v[112:113] offset:36864
    s_mov_b32 s60, 0
    s_bfm_b64 exec, s61, 0
    v_add_u32 v84, v84, v85
    ds_write_b64 v84, v[114:115] offset:36864
    s_mov_b32 s61, 0
    s_bfm_b64 exec, s62, 0
    v_add_u32 v86, v86, v87
    ds_write_b64 v86, v[116:117] offset:36864
    s_mov_b32 s62, 0
    s_branch L_sf_271
L_k2_last:
.globl accum_out_kernel
.p2align 8
.type accum_out_kernel,@function
accum_out_kernel:
    s_cmp_ge_u32 s2, 256
    s_cbranch_scc1 L_k3_end
    v_readfirstlane_b32 s78, v0
    s_lshr_b32 s79, s2, 3
    s_cmp_lg_u32 s78, 960
    s_cbranch_scc1 L_cpf_343
    s_cmp_ge_u32 s79, 2
    s_cbranch_scc1 L_cpf_343
    s_getpc_b64 s[76:77]
L_cpa_344:
    s_sub_u32 s76, s76, L_cpa_344-accum_out_kernel
    s_subb_u32 s77, s77, 0
    v_and_b32 v110, 63, v0
    v_lshlrev_b32 v110, 7, v110
    s_lshl_b32 s79, s79, 13
    v_add_u32 v110, s79, v110
    v_min_u32 v110, L_text_end-accum_out_kernel-4, v110
    global_load_dword v110, v110, s[76:77]
L_cpf_343:
    s_load_dwordx2 s[6:7], s[0:1], 104
    s_load_dwordx2 s[36:37], s[0:1], 0
    s_load_dwordx2 s[38:39], s[0:1], 24
    s_load_dwordx2 s[40:41], s[0:1], 88
    s_load_dwordx2 s[42:43], s[0:1], 40
    s_load_dwordx8 s[44:51], s[0:1], 56
    v_lshrrev_b32 v10, 6, v0
    v_and_b32 v1, 63, v0
    v_readfirstlane_b32 s3, v10
    s_and_b32 s4, s2, 7
    s_lshl_b32 s4, s4, 5
    s_lshr_b32 s26, s2, 3
    s_add_u32 s4, s4, s26
    v_mov_b32 v2, 0
    s_lshr_b32 s26, s3, 2
    s_and_b32 s27, s3, 3
    s_lshl_b32 s28, s26, 3
    s_lshr_b32 s33, 151851544, s28
    s_and_b32 s33, s33, 0xff
    s_lshr_b32 s34, 925505536, s28
    s_and_b32 s34, s34, 0xff
    s_mul_i32 s28, s27, s33
    s_lshl2_add_u32 s28, s34, s28
    s_lshl_b32 s26, s3, 6
    s_sub_u32 s26, s26, s28
    s_sub_u32 s26, s26, s33
    s_add_u32 s26, s26, 0x500
    s_add_u32 s28, s28, 0x400
    v_cmp_gt_u32 vcc, s33, v1
    v_add_u32 v11, s28, v1
    v_add_u32 v8, s26, v1
    v_cndmask_b32 v8, v8, v11, vcc
    s_mov_b32 s30, 98174976
    s_mov_b32 s32, 0
    s_waitcnt lgkmcnt(0)
    s_mov_b32 s8, s6
    s_and_b32 s9, s7, 0xffff
    s_mov_b32 s10, 268435456
    s_mov_b32 s11, 0x20000
    v_add_lshl_u32 v10, s32, v0, 2
    v_add_lshl_u32 v11, s32, v8, 2
    s_mul_i32 s26, s4, 65664
    s_add_u32 s26, s26, 81364992
    s_mov_b32 s27, 81299456
    buffer_load_dword v4, v10, s[8:11], s26 offen
    buffer_load_dword v3, v10, s[8:11], s27 offen
    buffer_load_dword v6, v11, s[8:11], s26 offen
    buffer_load_dword v5, v11, s[8:11], s27 offen
    s_mov_b32 s12, s36
    s_and_b32 s13, s37, 0xffff
    s_mov_b32 s14, 6400000
    s_mov_b32 s15, 0x20000
    s_mov_b32 s16, s38
    s_and_b32 s17, s39, 0xffff
    s_mov_b32 s18, 1600000
    s_mov_b32 s19, 0x20000
    s_mov_b32 s20, s40
    s_and_b32 s21, s41, 0xffff
    s_mov_b32 s22, 6400000
    s_mov_b32 s23, 0x20000
    s_add_u32 s6, s6, 81297408
    s_addc_u32 s7, s7, 0
    s_load_dword s31, s[6:7], 0
    s_load_dwordx8 s[56:63], s[48:49], 0
    s_load_dwordx8 s[64:71], s[50:51], 0
    s_load_dwordx4 s[72:75], s[42:43], 0
    s_mov_b64 s[92:93], s[44:45]
    s_mov_b64 s[94:95], s[46:47]
    v_mov_b32 v20, 0
    v_mov_b32 v22, 0
    v_mov_b32 v24, 0
    v_mov_b32 v26, 0
    v_mov_b32 v28, 0
    v_mov_b32 v70, 0
    v_mov_b32 v71, 0
    v_mov_b32 v72, 0
    v_mov_b32 v73, 0
    v_mov_b32 v74, 0
    v_mov_b32 v75, 0
    v_mov_b32 v76, 0
    v_mov_b32 v77, 0
    v_mov_b32 v78, 0
    v_mov_b32 v79, 0
    v_mov_b32 v80, 0
    v_mov_b32 v81, 0
    v_mov_b32 v82, 0
    v_mov_b32 v83, 0
    v_mov_b32 v84, 0
    v_mov_b32 v85, 0
    v_mov_b32 v10, 0
    v_mov_b32 v11, 0
    v_mov_b32 v12, 0
    v_mov_b32 v13, 0
    v_lshlrev_b32 v14, 4, v1
    s_lshl_b32 s26, s3, 11
    v_add_u32 v14, s26, v14
    v_add_u32 v15, 0x10000, v14
    ds_write_b128 v14, v[10:13] offset:0
    ds_write_b128 v14, v[10:13] offset:32768
    ds_write_b128 v15, v[10:13] offset:0
    ds_write_b128 v15, v[10:13] offset:32768
    ds_write_b32 v2, v2 offset:1024
    s_mul_i32 s26, s4, 3125
    v_mov_b32 v18, 0x8000000
    v_add_u32 v90, s26, v0
    v_add_u32 v91, 0x400, v90
    v_add_u32 v92, 0x800, v90
    v_add_u32 v93, 0xc00, v90
    v_cmp_gt_u32 vcc, 53, v0
    s_mov_b32 s36, 0xfffff000
    s_mov_b32 s37, 0xffffefff
    v_cndmask_b32 v93, v18, v93, vcc
    s_lshr_b32 s34, s3, 2
    s_xor_b32 s34, s34, 0
    s_mul_i32 s34, s34, 2
    s_add_u32 s34, s34, 1
    s_mov_b32 s33, 0
    s_waitcnt lgkmcnt(0)
    s_mov_b32 s6, 0x0c0c0703
    s_add_u32 s31, s31, 1280
    s_waitcnt vmcnt(0)
    v_add_u32 v10, s32, v0
    v_add_u32 v11, s32, v8
    v_cmp_gt_u32 vcc, s31, v10
    v_cmp_gt_u32 s[24:25], s31, v11
    s_mov_b32 s5, 0
    s_nop 0
    v_cndmask_b32 v4, 0, v4, vcc
    v_cndmask_b32 v6, 0, v6, s[24:25]
    v_and_b32 v10, 0xffff, v4
    v_and_b32 v11, 0xffff, v6
    v_lshrrev_b32 v4, 16, v4
    v_lshrrev_b32 v6, 16, v6
    v_add_u32 v3, v3, v10
    v_add_u32 v5, v5, v11
    v_min_u32 v10, 63, v4
    v_cmp_lt_u32 s[24:25], 0, v4
    v_lshl_or_b32 v7, v3, 6, v10
    s_nop 3
    s_cmp_eq_u64 s[24:25], 0
    s_cbranch_scc1 L_pr_346
L_pb_345:
    s_ff1_i32_b64 s28, s[24:25]
    s_bitset0_b64 s[24:25], s28
    v_readlane_b32 s40, v7, s28
    s_lshr_b32 s26, s40, 6
    s_bfm_b64 exec, s40, 0
    v_add_lshl_u32 v20, s26, v1, 3
L_pi_348:
    buffer_load_dwordx2 v[20:21], v20, s[8:11], s30 offen
    s_cmp_eq_u64 s[24:25], 0
    s_cbranch_scc1 L_pr_350
L_pb_349:
    s_ff1_i32_b64 s28, s[24:25]
    s_bitset0_b64 s[24:25], s28
    v_readlane_b32 s41, v7, s28
    s_lshr_b32 s26, s41, 6
    s_bfm_b64 exec, s41, 0
    v_add_lshl_u32 v22, s26, v1, 3
L_pi_352:
    buffer_load_dwordx2 v[22:23], v22, s[8:11], s30 offen
    s_cmp_eq_u64 s[24:25], 0
    s_cbranch_scc1 L_pr_354
L_pb_353:
    s_ff1_i32_b64 s28, s[24:25]
    s_bitset0_b64 s[24:25], s28
    v_readlane_b32 s42, v7, s28
    s_lshr_b32 s26, s42, 6
    s_bfm_b64 exec, s42, 0
    v_add_lshl_u32 v24, s26, v1, 3
L_pi_356:
    buffer_load_dwordx2 v[24:25], v24, s[8:11], s30 offen
    s_cmp_eq_u64 s[24:25], 0
    s_cbranch_scc1 L_pr_358
L_pb_357:
    s_ff1_i32_b64 s28, s[24:25]
    s_bitset0_b64 s[24:25], s28
    v_readlane_b32 s43, v7, s28
    s_lshr_b32 s26, s43, 6
    s_bfm_b64 exec, s43, 0
    v_add_lshl_u32 v26, s26, v1, 3
L_pi_360:
    buffer_load_dwordx2 v[26:27], v26, s[8:11], s30 offen
    s_cmp_eq_u64 s[24:25], 0
    s_cbranch_scc1 L_pr_362
L_pb_361:
    s_ff1_i32_b64 s28, s[24:25]
    s_bitset0_b64 s[24:25], s28
    v_readlane_b32 s44, v7, s28
    s_lshr_b32 s26, s44, 6
    s_bfm_b64 exec, s44, 0
    v_add_lshl_u32 v28, s26, v1, 3
L_pi_364:
    buffer_load_dwordx2 v[28:29], v28, s[8:11], s30 offen
    s_setprio 3
    s_barrier
    s_mov_b64 exec, -1
    v_lshlrev_b32 v18, 4, v1
    s_mov_b32 s26, 81298432
    buffer_load_dwordx4 v[38:41], v18, s[8:11], s26 offen
    v_lshlrev_b32 v86, 1, v90
    v_lshlrev_b32 v87, 1, v91
    v_lshlrev_b32 v88, 1, v92
    v_lshlrev_b32 v89, 1, v93
    buffer_load_ushort v86, v86, s[16:19], 0 offen
    buffer_load_ushort v87, v87, s[16:19], 0 offen
    buffer_load_ushort v88, v88, s[16:19], 0 offen
    buffer_load_ushort v89, v89, s[16:19], 0 offen
    v_lshlrev_b32 v90, 3, v90
    v_lshlrev_b32 v91, 3, v91
    v_lshlrev_b32 v92, 3, v92
    v_lshlrev_b32 v93, 3, v93
    buffer_load_dwordx2 v[30:31], v90, s[12:15], 0 offen
    buffer_load_dwordx2 v[32:33], v91, s[12:15], 0 offen
    buffer_load_dwordx2 v[34:35], v92, s[12:15], 0 offen
    buffer_load_dwordx2 v[36:37], v93, s[12:15], 0 offen
    s_waitcnt vmcnt(13)
    s_bfm_b64 exec, s40, 0
    v_perm_b32 v14, v21, v20, s6
    v_and_b32 v10, 0x1fff, v20
    v_bfe_u32 v11, v20, 13, 13
    v_and_b32 v14, 0xfcfc, v14
    v_and_b32 v12, 0x1fff, v21
    v_bfe_u32 v13, v21, 13, 13
    v_add_u32 v14, v14, v14
    v_lshl_add_u64 v[10:11], v[10:11], 0, s[36:37]
    v_lshl_add_u64 v[12:13], v[12:13], 0, s[36:37]
    ds_add_u64 v14, v[10:11] offset:0
    ds_add_u64 v14, v[12:13] offset:512
    s_cmp_eq_u64 s[24:25], 0
    s_cbranch_scc1 L_pr_366
L_pb_365:
    s_ff1_i32_b64 s28, s[24:25]
    s_bitset0_b64 s[24:25], s28
    v_readlane_b32 s40, v7, s28
    s_lshr_b32 s26, s40, 6
    s_bfm_b64 exec, s40, 0
    v_add_lshl_u32 v20, s26, v1, 3
L_pi_368:
    buffer_load_dwordx2 v[20:21], v20, s[8:11], s30 offen
    s_waitcnt vmcnt(13)
    s_bfm_b64 exec, s41, 0
    v_perm_b32 v14, v23, v22, s6
    v_and_b32 v10, 0x1fff, v22
    v_bfe_u32 v11, v22, 13, 13
    v_and_b32 v14, 0xfcfc, v14
    v_and_b32 v12, 0x1fff, v23
    v_bfe_u32 v13, v23, 13, 13
    v_add_u32 v14, v14, v14
    v_lshl_add_u64 v[10:11], v[10:11], 0, s[36:37]
    v_lshl_add_u64 v[12:13], v[12:13], 0, s[36:37]
    ds_add_u64 v14, v[10:11] offset:0
    ds_add_u64 v14, v[12:13] offset:512
    s_cmp_eq_u64 s[24:25], 0
    s_cbranch_scc1 L_pr_370
L_pb_369:
    s_ff1_i32_b64 s28, s[24:25]
    s_bitset0_b64 s[24:25], s28
    v_readlane_b32 s41, v7, s28
    s_lshr_b32 s26, s41, 6
    s_bfm_b64 exec, s41, 0
    v_add_lshl_u32 v22, s26, v1, 3
L_pi_372:
    buffer_load_dwordx2 v[22:23], v22, s[8:11], s30 offen
    s_waitcnt vmcnt(13)
    s_bfm_b64 exec, s42, 0
    v_perm_b32 v14, v25, v24, s6
    v_and_b32 v10, 0x1fff, v24
    v_bfe_u32 v11, v24, 13, 13
    v_and_b32 v14, 0xfcfc, v14
    v_and_b32 v12, 0x1fff, v25
    v_bfe_u32 v13, v25, 13, 13
    v_add_u32 v14, v14, v14
    v_lshl_add_u64 v[10:11], v[10:11], 0, s[36:37]
    v_lshl_add_u64 v[12:13], v[12:13], 0, s[36:37]
    ds_add_u64 v14, v[10:11] offset:0
    ds_add_u64 v14, v[12:13] offset:512
    s_cmp_eq_u64 s[24:25], 0
    s_cbranch_scc1 L_pr_374
L_pb_373:
    s_ff1_i32_b64 s28, s[24:25]
    s_bitset0_b64 s[24:25], s28
    v_readlane_b32 s42, v7, s28
    s_lshr_b32 s26, s42, 6
    s_bfm_b64 exec, s42, 0
    v_add_lshl_u32 v24, s26, v1, 3
L_pi_376:
    buffer_load_dwordx2 v[24:25], v24, s[8:11], s30 offen
    s_waitcnt vmcnt(13)
    s_bfm_b64 exec, s43, 0
    v_perm_b32 v14, v27, v26, s6
    v_and_b32 v10, 0x1fff, v26
    v_bfe_u32 v11, v26, 13, 13
    v_and_b32 v14, 0xfcfc, v14
    v_and_b32 v12, 0x1fff, v27
    v_bfe_u32 v13, v27, 13, 13
    v_add_u32 v14, v14, v14
    v_lshl_add_u64 v[10:11], v[10:11], 0, s[36:37]
    v_lshl_add_u64 v[12:13], v[12:13], 0, s[36:37]
    ds_add_u64 v14, v[10:11] offset:0
    ds_add_u64 v14, v[12:13] offset:512
    s_cmp_eq_u64 s[24:25], 0
    s_cbranch_scc1 L_pr_378
L_pb_377:
    s_ff1_i32_b64 s28, s[24:25]
    s_bitset0_b64 s[24:25], s28
    v_readlane_b32 s43, v7, s28
    s_lshr_b32 s26, s43, 6
    s_bfm_b64 exec, s43, 0
    v_add_lshl_u32 v26, s26, v1, 3
L_pi_380:
    buffer_load_dwordx2 v[26:27], v26, s[8:11], s30 offen
    s_waitcnt vmcnt(13)
    s_bfm_b64 exec, s44, 0
    v_perm_b32 v14, v29, v28, s6
    v_and_b32 v10, 0x1fff, v28
    v_bfe_u32 v11, v28, 13, 13
    v_and_b32 v14, 0xfcfc, v14
    v_and_b32 v12, 0x1fff, v29
    v_bfe_u32 v13, v29, 13, 13
    v_add_u32 v14, v14, v14
    v_lshl_add_u64 v[10:11], v[10:11], 0, s[36:37]
    v_lshl_add_u64 v[12:13], v[12:13], 0, s[36:37]
    ds_add_u64 v14, v[10:11] offset:0
    ds_add_u64 v14, v[12:13] offset:512
    s_cmp_eq_u64 s[24:25], 0
    s_cbranch_scc1 L_pr_382
L_pb_381:
    s_ff1_i32_b64 s28, s[24:25]
    s_bitset0_b64 s[24:25], s28
    v_readlane_b32 s44, v7, s28
    s_lshr_b32 s26, s44, 6
    s_bfm_b64 exec, s44, 0
    v_add_lshl_u32 v28, s26, v1, 3
L_pi_384:
    buffer_load_dwordx2 v[28:29], v28, s[8:11], s30 offen
L_k3_loop:
    s_add_u32 s33, s33, 1
    s_cmp_eq_u32 s33, s34
    s_cbranch_scc1 L_k3_basis
L_k3_basisback:
    s_cmp_lg_u32 s33, 4
    s_cbranch_scc1 L_prio_385
    s_setprio 2
L_prio_385:
    s_cmp_lg_u32 s33, 9
    s_cbranch_scc1 L_prio_386
    s_setprio 1
L_prio_386:
    s_cmp_lg_u32 s33, 12
    s_cbranch_scc1 L_prio_387
    s_setprio 0
L_prio_387:
    s_cmp_eq_u32 s40, 0
    s_cbranch_scc1 L_k3_drained
    s_cmp_ge_u32 s33, 102
    s_cbranch_scc1 L_k3_full
L_k3_pass:
    s_waitcnt vmcnt(4)
    s_bfm_b64 exec, s40, 0
    v_perm_b32 v14, v21, v20, s6
    v_and_b32 v10, 0x1fff, v20
    v_bfe_u32 v11, v20, 13, 13
    v_and_b32 v14, 0xfcfc, v14
    v_and_b32 v12, 0x1fff, v21
    v_bfe_u32 v13, v21, 13, 13
    v_add_u32 v14, v14, v14
    v_lshl_add_u64 v[10:11], v[10:11], 0, s[36:37]
    v_lshl_add_u64 v[12:13], v[12:13], 0, s[36:37]
    ds_add_u64 v14, v[10:11] offset:0
    ds_add_u64 v14, v[12:13] offset:512
    s_cmp_eq_u64 s[24:25], 0
    s_cbranch_scc1 L_pr_389
L_pb_388:
    s_ff1_i32_b64 s28, s[24:25]
    s_bitset0_b64 s[24:25], s28
    v_readlane_b32 s40, v7, s28
    s_lshr_b32 s26, s40, 6
    s_bfm_b64 exec, s40, 0
    v_add_lshl_u32 v20, s26, v1, 3
L_pi_391:
    buffer_load_dwordx2 v[20:21], v20, s[8:11], s30 offen
    s_waitcnt vmcnt(4)
    s_bfm_b64 exec, s41, 0
    v_perm_b32 v14, v23, v22, s6
    v_and_b32 v10, 0x1fff, v22
    v_bfe_u32 v11, v22, 13, 13
    v_and_b32 v14, 0xfcfc, v14
    v_and_b32 v12, 0x1fff, v23
    v_bfe_u32 v13, v23, 13, 13
    v_add_u32 v14, v14, v14
    v_lshl_add_u64 v[10:11], v[10:11], 0, s[36:37]
    v_lshl_add_u64 v[12:13], v[12:13], 0, s[36:37]
    ds_add_u64 v14, v[10:11] offset:0
    ds_add_u64 v14, v[12:13] offset:512
    s_cmp_eq_u64 s[24:25], 0
    s_cbranch_scc1 L_pr_393
L_pb_392:
    s_ff1_i32_b64 s28, s[24:25]
    s_bitset0_b64 s[24:25], s28
    v_readlane_b32 s41, v7, s28
    s_lshr_b32 s26, s41, 6
    s_bfm_b64 exec, s41, 0
    v_add_lshl_u32 v22, s26, v1, 3
L_pi_395:
    buffer_load_dwordx2 v[22:23], v22, s[8:11], s30 offen
    s_waitcnt vmcnt(4)
    s_bfm_b64 exec, s42, 0
    v_perm_b32 v14, v25, v24, s6
    v_and_b32 v10, 0x1fff, v24
    v_bfe_u32 v11, v24, 13, 13
    v_and_b32 v14, 0xfcfc, v14
    v_and_b32 v12, 0x1fff, v25
    v_bfe_u32 v13, v25, 13, 13
    v_add_u32 v14, v14, v14
    v_lshl_add_u64 v[10:11], v[10:11], 0, s[36:37]
    v_lshl_add_u64 v[12:13], v[12:13], 0, s[36:37]
    ds_add_u64 v14, v[10:11] offset:0
    ds_add_u64 v14, v[12:13] offset:512
    s_cmp_eq_u64 s[24:25], 0
    s_cbranch_scc1 L_pr_397
L_pb_396:
    s_ff1_i32_b64 s28, s[24:25]
    s_bitset0_b64 s[24:25], s28
    v_readlane_b32 s42, v7, s28
    s_lshr_b32 s26, s42, 6
    s_bfm_b64 exec, s42, 0
    v_add_lshl_u32 v24, s26, v1, 3
L_pi_399:
    buffer_load_dwordx2 v[24:25], v24, s[8:11], s30 offen
    s_waitcnt vmcnt(4)
    s_bfm_b64 exec, s43, 0
    v_perm_b32 v14, v27, v26, s6
    v_and_b32 v10, 0x1fff, v26
    v_bfe_u32 v11, v26, 13, 13
    v_and_b32 v14, 0xfcfc, v14
    v_and_b32 v12, 0x1fff, v27
    v_bfe_u32 v13, v27, 13, 13
    v_add_u32 v14, v14, v14
    v_lshl_add_u64 v[10:11], v[10:11], 0, s[36:37]
    v_lshl_add_u64 v[12:13], v[12:13], 0, s[36:37]
    ds_add_u64 v14, v[10:11] offset:0
    ds_add_u64 v14, v[12:13] offset:512
    s_cmp_eq_u64 s[24:25], 0
    s_cbranch_scc1 L_pr_401
L_pb_400:
    s_ff1_i32_b64 s28, s[24:25]
    s_bitset0_b64 s[24:25], s28
    v_readlane_b32 s43, v7, s28
    s_lshr_b32 s26, s43, 6
    s_bfm_b64 exec, s43, 0
    v_add_lshl_u32 v26, s26, v1, 3
L_pi_403:
    buffer_load_dwordx2 v[26:27], v26, s[8:11], s30 offen
    s_waitcnt vmcnt(4)
    s_bfm_b64 exec, s44, 0
    v_perm_b32 v14, v29, v28, s6
    v_and_b32 v10, 0x1fff, v28
    v_bfe_u32 v11, v28, 13, 13
    v_and_b32 v14, 0xfcfc, v14
    v_and_b32 v12, 0x1fff, v29
    v_bfe_u32 v13, v29, 13, 13
    v_add_u32 v14, v14, v14
    v_lshl_add_u64 v[10:11], v[10:11], 0, s[36:37]
    v_lshl_add_u64 v[12:13], v[12:13], 0, s[36:37]
    ds_add_u64 v14, v[10:11] offset:0
    ds_add_u64 v14, v[12:13] offset:512
    s_cmp_eq_u64 s[24:25], 0
    s_cbranch_scc1 L_pr_405
L_pb_404:
    s_ff1_i32_b64 s28, s[24:25]
    s_bitset0_b64 s[24:25], s28
    v_readlane_b32 s44, v7, s28
    s_lshr_b32 s26, s44, 6
    s_bfm_b64 exec, s44, 0
    v_add_lshl_u32 v28, s26, v1, 3
L_pi_407:
    buffer_load_dwordx2 v[28:29], v28, s[8:11], s30 offen
    s_branch L_k3_loop
L_k3_drained:
    s_mov_b64 exec, -1
    s_add_u32 s32, s32, 2048
    s_cmp_lt_u32 s32, s31
    s_cbranch_scc1 L_k3_next
    s_sub_u32 s32, s32, 2048
    s_cmp_lt_u32 s33, s34
    s_cbranch_scc0 L_k3_join
    s_mov_b32 s34, s33
    s_branch L_k3_basis
L_k3_join:
    s_waitcnt lgkmcnt(0)
    s_barrier
    s_cmp_lg_u32 s3, 0
    s_cbranch_scc1 L_k3_fold3
    v_lshrrev_b32 v10, 3, v93
    v_add_u32 v11, 19, v10
    v_add_u32 v10, 1216, v10
    v_and_b32 v11, 63, v11
    v_and_b32 v10, 0xfc0, v10
    v_lshl_or_b32 v10, v10, 2, v11
    v_lshlrev_b32 v10, 3, v10
    ds_read_b64 v[106:107], v10 offset:0
    ds_read_b64 v[108:109], v10 offset:512
    ds_read_b32 v14, v2 offset:1024
    s_waitcnt lgkmcnt(0)
    v_readfirstlane_b32 s29, v14
    v_lshrrev_b32 v10, 31, v106
    v_lshrrev_b32 v11, 31, v108
    v_add_u32 v107, v107, v10
    v_add_u32 v109, v109, v11
    v_cvt_f32_i32 v106, v106
    v_cvt_f32_i32 v107, v107
    v_cvt_f32_i32 v108, v108
    v_cvt_f32_i32 v109, v109
    v_add_f32 v82, v82, v106
    v_add_f32 v83, v83, v107
    v_add_f32 v84, v84, v108
    v_add_f32 v85, v85, v109
L_k3_fold3:
    v_lshrrev_b32 v10, 3, v90
    v_add_u32 v11, 19, v10
    v_add_u32 v10, 1216, v10
    v_and_b32 v11, 63, v11
    v_and_b32 v10, 0xfc0, v10
    v_lshl_or_b32 v10, v10, 2, v11
    v_lshlrev_b32 v10, 3, v10
    ds_read_b64 v[94:95], v10 offset:0
    ds_read_b64 v[96:97], v10 offset:512
    v_lshrrev_b32 v10, 3, v91
    v_add_u32 v11, 19, v10
    v_add_u32 v10, 1216, v10
    v_and_b32 v11, 63, v11
    v_and_b32 v10, 0xfc0, v10
    v_lshl_or_b32 v10, v10, 2, v11
    v_lshlrev_b32 v10, 3, v10
    ds_read_b64 v[98:99], v10 offset:0
    ds_read_b64 v[100:101], v10 offset:512
    v_lshrrev_b32 v10, 3, v92
    v_add_u32 v11, 19, v10
    v_add_u32 v10, 1216, v10
    v_and_b32 v11, 63, v11
    v_and_b32 v10, 0xfc0, v10
    v_lshl_or_b32 v10, v10, 2, v11
    v_lshlrev_b32 v10, 3, v10
    ds_read_b64 v[102:103], v10 offset:0
    ds_read_b64 v[104:105], v10 offset:512
    ds_read_b32 v14, v2 offset:1024
    s_waitcnt lgkmcnt(0)
    v_readfirstlane_b32 s29, v14
    v_lshrrev_b32 v10, 31, v94
    v_lshrrev_b32 v11, 31, v96
    v_add_u32 v95, v95, v10
    v_add_u32 v97, v97, v11
    v_cvt_f32_i32 v94, v94
    v_cvt_f32_i32 v95, v95
    v_cvt_f32_i32 v96, v96
    v_cvt_f32_i32 v97, v97
    v_add_f32 v70, v70, v94
    v_add_f32 v71, v71, v95
    v_add_f32 v72, v72, v96
    v_add_f32 v73, v73, v97
    v_lshrrev_b32 v10, 31, v98
    v_lshrrev_b32 v11, 31, v100
    v_add_u32 v99, v99, v10
    v_add_u32 v101, v101, v11
    v_cvt_f32_i32 v98, v98
    v_cvt_f32_i32 v99, v99
    v_cvt_f32_i32 v100, v100
    v_cvt_f32_i32 v101, v101
    v_add_f32 v74, v74, v98
    v_add_f32 v75, v75, v99
    v_add_f32 v76, v76, v100
    v_add_f32 v77, v77, v101
    v_lshrrev_b32 v10, 31, v102
    v_lshrrev_b32 v11, 31, v104
    v_add_u32 v103, v103, v10
    v_add_u32 v105, v105, v11
    v_cvt_f32_i32 v102, v102
    v_cvt_f32_i32 v103, v103
    v_cvt_f32_i32 v104, v104
    v_cvt_f32_i32 v105, v105
    v_add_f32 v78, v78, v102
    v_add_f32 v79, v79, v103
    v_add_f32 v80, v80, v104
    v_add_f32 v81, v81, v105
    s_cmp_lg_u32 s29, 0
    s_cbranch_scc1 L_k3_again
    s_lshl_b32 s38, s56, 16
    s_and_b32 s39, s56, 0xffff0000
    v_pk_mul_f32 v[94:95], v[70:71], s[38:39] op_sel:[0,0] op_sel_hi:[0,1]
    v_pk_mul_f32 v[98:99], v[74:75], s[38:39] op_sel:[0,0] op_sel_hi:[0,1]
    v_pk_mul_f32 v[102:103], v[78:79], s[38:39] op_sel:[0,0] op_sel_hi:[0,1]
    s_lshl_b32 s38, s57, 16
    s_and_b32 s39, s57, 0xffff0000
    v_pk_mul_f32 v[96:97], v[70:71], s[38:39] op_sel:[0,0] op_sel_hi:[0,1]
    v_pk_mul_f32 v[100:101], v[74:75], s[38:39] op_sel:[0,0] op_sel_hi:[0,1]
    v_pk_mul_f32 v[104:105], v[78:79], s[38:39] op_sel:[0,0] op_sel_hi:[0,1]
    s_lshl_b32 s38, s58, 16
    s_and_b32 s39, s58, 0xffff0000
    v_pk_fma_f32 v[94:95], v[70:71], s[38:39], v[94:95] op_sel:[1,0,0] op_sel_hi:[1,1,1]
    v_pk_fma_f32 v[98:99], v[74:75], s[38:39], v[98:99] op_sel:[1,0,0] op_sel_hi:[1,1,1]
    v_pk_fma_f32 v[102:103], v[78:79], s[38:39], v[102:103] op_sel:[1,0,0] op_sel_hi:[1,1,1]
    s_lshl_b32 s38, s59, 16
    s_and_b32 s39, s59, 0xffff0000
    v_pk_fma_f32 v[96:97], v[70:71], s[38:39], v[96:97] op_sel:[1,0,0] op_sel_hi:[1,1,1]
    v_pk_fma_f32 v[100:101], v[74:75], s[38:39], v[100:101] op_sel:[1,0,0] op_sel_hi:[1,1,1]
    v_pk_fma_f32 v[104:105], v[78:79], s[38:39], v[104:105] op_sel:[1,0,0] op_sel_hi:[1,1,1]
    s_lshl_b32 s38, s60, 16
    s_and_b32 s39, s60, 0xffff0000
    v_pk_fma_f32 v[94:95], v[72:73], s[38:39], v[94:95] op_sel:[0,0,0] op_sel_hi:[0,1,1]
    v_pk_fma_f32 v[98:99], v[76:77], s[38:39], v[98:99] op_sel:[0,0,0] op_sel_hi:[0,1,1]
    v_pk_fma_f32 v[102:103], v[80:81], s[38:39], v[102:103] op_sel:[0,0,0] op_sel_hi:[0,1,1]
    s_lshl_b32 s38, s61, 16
    s_and_b32 s39, s61, 0xffff0000
    v_pk_fma_f32 v[96:97], v[72:73], s[38:39], v[96:97] op_sel:[0,0,0] op_sel_hi:[0,1,1]
    v_pk_fma_f32 v[100:101], v[76:77], s[38:39], v[100:101] op_sel:[0,0,0] op_sel_hi:[0,1,1]
    v_pk_fma_f32 v[104:105], v[80:81], s[38:39], v[104:105] op_sel:[0,0,0] op_sel_hi:[0,1,1]
    s_lshl_b32 s38, s62, 16
    s_and_b32 s39, s62, 0xffff0000
    v_pk_fma_f32 v[94:95], v[72:73], s[38:39], v[94:95] op_sel:[1,0,0] op_sel_hi:[1,1,1]
    v_pk_fma_f32 v[98:99], v[76:77], s[38:39], v[98:99] op_sel:[1,0,0] op_sel_hi:[1,1,1]
    v_pk_fma_f32 v[102:103], v[80:81], s[38:39], v[102:103] op_sel:[1,0,0] op_sel_hi:[1,1,1]
    s_lshl_b32 s38, s63, 16
    s_and_b32 s39, s63, 0xffff0000
    v_pk_fma_f32 v[96:97], v[72:73], s[38:39], v[96:97] op_sel:[1,0,0] op_sel_hi:[1,1,1]
    v_pk_fma_f32 v[100:101], v[76:77], s[38:39], v[100:101] op_sel:[1,0,0] op_sel_hi:[1,1,1]
    v_pk_fma_f32 v[104:105], v[80:81], s[38:39], v[104:105] op_sel:[1,0,0] op_sel_hi:[1,1,1]
    v_mul_f32 v94, v94, v38
    v_mul_f32 v95, v95, v39
    v_mul_f32 v96, v96, v40
    v_mul_f32 v97, v97, v41
    v_mul_f32 v98, v98, v42
    v_mul_f32 v99, v99, v43
    v_mul_f32 v100, v100, v44
    v_mul_f32 v101, v101, v45
    v_mul_f32 v102, v102, v46
    v_mul_f32 v103, v103, v47
    v_mul_f32 v104, v104, v48
    v_mul_f32 v105, v105, v49
    s_lshl_b32 s38, s64, 16
    s_and_b32 s39, s64, 0xffff0000
    v_pk_mul_f32 v[70:71], v[94:95], s[38:39] op_sel:[0,0] op_sel_hi:[0,1]
    v_pk_mul_f32 v[74:75], v[98:99], s[38:39] op_sel:[0,0] op_sel_hi:[0,1]
    v_pk_mul_f32 v[78:79], v[102:103], s[38:39] op_sel:[0,0] op_sel_hi:[0,1]
    s_lshl_b32 s38, s65, 16
    s_and_b32 s39, s65, 0xffff0000
    v_pk_mul_f32 v[72:73], v[94:95], s[38:39] op_sel:[0,0] op_sel_hi:[0,1]
    v_pk_mul_f32 v[76:77], v[98:99], s[38:39] op_sel:[0,0] op_sel_hi:[0,1]
    v_pk_mul_f32 v[80:81], v[102:103], s[38:39] op_sel:[0,0] op_sel_hi:[0,1]
    s_lshl_b32 s38, s66, 16
    s_and_b32 s39, s66, 0xffff0000
    v_pk_fma_f32 v[70:71], v[94:95], s[38:39], v[70:71] op_sel:[1,0,0] op_sel_hi:[1,1,1]
    v_pk_fma_f32 v[74:75], v[98:99], s[38:39], v[74:75] op_sel:[1,0,0] op_sel_hi:[1,1,1]
    v_pk_fma_f32 v[78:79], v[102:103], s[38:39], v[78:79] op_sel:[1,0,0] op_sel_hi:[1,1,1]
    s_lshl_b32 s38, s67, 16
    s_and_b32 s39, s67, 0xffff0000
    v_pk_fma_f32 v[72:73], v[94:95], s[38:39], v[72:73] op_sel:[1,0,0] op_sel_hi:[1,1,1]
    v_pk_fma_f32 v[76:77], v[98:99], s[38:39], v[76:77] op_sel:[1,0,0] op_sel_hi:[1,1,1]
    v_pk_fma_f32 v[80:81], v[102:103], s[38:39], v[80:81] op_sel:[1,0,0] op_sel_hi:[1,1,1]
    s_lshl_b32 s38, s68, 16
    s_and_b32 s39, s68, 0xffff0000
    v_pk_fma_f32 v[70:71], v[96:97], s[38:39], v[70:71] op_sel:[0,0,0] op_sel_hi:[0,1,1]
    v_pk_fma_f32 v[74:75], v[100:101], s[38:39], v[74:75] op_sel:[0,0,0] op_sel_hi:[0,1,1]
    v_pk_fma_f32 v[78:79], v[104:105], s[38:39], v[78:79] op_sel:[0,0,0] op_sel_hi:[0,1,1]
    s_lshl_b32 s38, s69, 16
    s_and_b32 s39, s69, 0xffff0000
    v_pk_fma_f32 v[72:73], v[96:97], s[38:39], v[72:73] op_sel:[0,0,0] op_sel_hi:[0,1,1]
    v_pk_fma_f32 v[76:77], v[100:101], s[38:39], v[76:77] op_sel:[0,0,0] op_sel_hi:[0,1,1]
    v_pk_fma_f32 v[80:81], v[104:105], s[38:39], v[80:81] op_sel:[0,0,0] op_sel_hi:[0,1,1]
    s_lshl_b32 s38, s70, 16
    s_and_b32 s39, s70, 0xffff0000
    v_pk_fma_f32 v[70:71], v[96:97], s[38:39], v[70:71] op_sel:[1,0,0] op_sel_hi:[1,1,1]
    v_pk_fma_f32 v[74:75], v[100:101], s[38:39], v[74:75] op_sel:[1,0,0] op_sel_hi:[1,1,1]
    v_pk_fma_f32 v[78:79], v[104:105], s[38:39], v[78:79] op_sel:[1,0,0] op_sel_hi:[1,1,1]
    s_lshl_b32 s38, s71, 16
    s_and_b32 s39, s71, 0xffff0000
    v_pk_fma_f32 v[72:73], v[96:97], s[38:39], v[72:73] op_sel:[1,0,0] op_sel_hi:[1,1,1]
    v_pk_fma_f32 v[76:77], v[100:101], s[38:39], v[76:77] op_sel:[1,0,0] op_sel_hi:[1,1,1]
    v_pk_fma_f32 v[80:81], v[104:105], s[38:39], v[80:81] op_sel:[1,0,0] op_sel_hi:[1,1,1]
    v_lshlrev_b32 v94, 16, v30
    v_and_b32 v95, 0xffff0000, v30
    v_lshlrev_b32 v96, 16, v31
    v_and_b32 v97, 0xffff0000, v31
    v_fmac_f32 v94, v70, v54
    v_fmac_f32 v95, v71, v55
    v_fmac_f32 v96, v72, v56
    v_fmac_f32 v97, v73, v57
    v_cvt_pk_bf16_f32 v94, v94, v95
    v_cvt_pk_bf16_f32 v95, v96, v97
    buffer_store_dwordx2 v[94:95], v90, s[20:23], 0 offen
    v_lshlrev_b32 v98, 16, v32
    v_and_b32 v99, 0xffff0000, v32
    v_lshlrev_b32 v100, 16, v33
    v_and_b32 v101, 0xffff0000, v33
    v_fmac_f32 v98, v74, v58
    v_fmac_f32 v99, v75, v59
    v_fmac_f32 v100, v76, v60
    v_fmac_f32 v101, v77, v61
    v_cvt_pk_bf16_f32 v98, v98, v99
    v_cvt_pk_bf16_f32 v99, v100, v101
    buffer_store_dwordx2 v[98:99], v91, s[20:23], 0 offen
    v_lshlrev_b32 v102, 16, v34
    v_and_b32 v103, 0xffff0000, v34
    v_lshlrev_b32 v104, 16, v35
    v_and_b32 v105, 0xffff0000, v35
    v_fmac_f32 v102, v78, v62
    v_fmac_f32 v103, v79, v63
    v_fmac_f32 v104, v80, v64
    v_fmac_f32 v105, v81, v65
    v_cvt_pk_bf16_f32 v102, v102, v103
    v_cvt_pk_bf16_f32 v103, v104, v105
    buffer_store_dwordx2 v[102:103], v92, s[20:23], 0 offen
    s_cmp_lg_u32 s3, 0
    s_cbranch_scc1 L_k3_epi3
    s_lshl_b32 s38, s56, 16
    s_and_b32 s39, s56, 0xffff0000
    v_pk_mul_f32 v[106:107], v[82:83], s[38:39] op_sel:[0,0] op_sel_hi:[0,1]
    s_lshl_b32 s38, s57, 16
    s_and_b32 s39, s57, 0xffff0000
    v_pk_mul_f32 v[108:109], v[82:83], s[38:39] op_sel:[0,0] op_sel_hi:[0,1]
    s_lshl_b32 s38, s58, 16
    s_and_b32 s39, s58, 0xffff0000
    v_pk_fma_f32 v[106:107], v[82:83], s[38:39], v[106:107] op_sel:[1,0,0] op_sel_hi:[1,1,1]
    s_lshl_b32 s38, s59, 16
    s_and_b32 s39, s59, 0xffff0000
    v_pk_fma_f32 v[108:109], v[82:83], s[38:39], v[108:109] op_sel:[1,0,0] op_sel_hi:[1,1,1]
    s_lshl_b32 s38, s60, 16
    s_and_b32 s39, s60, 0xffff0000
    v_pk_fma_f32 v[106:107], v[84:85], s[38:39], v[106:107] op_sel:[0,0,0] op_sel_hi:[0,1,1]
    s_lshl_b32 s38, s61, 16
    s_and_b32 s39, s61, 0xffff0000
    v_pk_fma_f32 v[108:109], v[84:85], s[38:39], v[108:109] op_sel:[0,0,0] op_sel_hi:[0,1,1]
    s_lshl_b32 s38, s62, 16
    s_and_b32 s39, s62, 0xffff0000
    v_pk_fma_f32 v[106:107], v[84:85], s[38:39], v[106:107] op_sel:[1,0,0] op_sel_hi:[1,1,1]
    s_lshl_b32 s38, s63, 16
    s_and_b32 s39, s63, 0xffff0000
    v_pk_fma_f32 v[108:109], v[84:85], s[38:39], v[108:109] op_sel:[1,0,0] op_sel_hi:[1,1,1]
    v_mul_f32 v106, v106, v50
    v_mul_f32 v107, v107, v51
    v_mul_f32 v108, v108, v52
    v_mul_f32 v109, v109, v53
    s_lshl_b32 s38, s64, 16
    s_and_b32 s39, s64, 0xffff0000
    v_pk_mul_f32 v[82:83], v[106:107], s[38:39] op_sel:[0,0] op_sel_hi:[0,1]
    s_lshl_b32 s38, s65, 16
    s_and_b32 s39, s65, 0xffff0000
    v_pk_mul_f32 v[84:85], v[106:107], s[38:39] op_sel:[0,0] op_sel_hi:[0,1]
    s_lshl_b32 s38, s66, 16
    s_and_b32 s39, s66, 0xffff0000
    v_pk_fma_f32 v[82:83], v[106:107], s[38:39], v[82:83] op_sel:[1,0,0] op_sel_hi:[1,1,1]
    s_lshl_b32 s38, s67, 16
    s_and_b32 s39, s67, 0xffff0000
    v_pk_fma_f32 v[84:85], v[106:107], s[38:39], v[84:85] op_sel:[1,0,0] op_sel_hi:[1,1,1]
    s_lshl_b32 s38, s68, 16
    s_and_b32 s39, s68, 0xffff0000
    v_pk_fma_f32 v[82:83], v[108:109], s[38:39], v[82:83] op_sel:[0,0,0] op_sel_hi:[0,1,1]
    s_lshl_b32 s38, s69, 16
    s_and_b32 s39, s69, 0xffff0000
    v_pk_fma_f32 v[84:85], v[108:109], s[38:39], v[84:85] op_sel:[0,0,0] op_sel_hi:[0,1,1]
    s_lshl_b32 s38, s70, 16
    s_and_b32 s39, s70, 0xffff0000
    v_pk_fma_f32 v[82:83], v[108:109], s[38:39], v[82:83] op_sel:[1,0,0] op_sel_hi:[1,1,1]
    s_lshl_b32 s38, s71, 16
    s_and_b32 s39, s71, 0xffff0000
    v_pk_fma_f32 v[84:85], v[108:109], s[38:39], v[84:85] op_sel:[1,0,0] op_sel_hi:[1,1,1]
    v_lshlrev_b32 v106, 16, v36
    v_and_b32 v107, 0xffff0000, v36
    v_lshlrev_b32 v108, 16, v37
    v_and_b32 v109, 0xffff0000, v37
    v_fmac_f32 v106, v82, v66
    v_fmac_f32 v107, v83, v67
    v_fmac_f32 v108, v84, v68
    v_fmac_f32 v109, v85, v69
    v_cvt_pk_bf16_f32 v106, v106, v107
    v_cvt_pk_bf16_f32 v107, v108, v109
    buffer_store_dwordx2 v[106:107], v93, s[20:23], 0 offen
L_k3_epi3:
    s_endpgm
L_k3_again:
    s_barrier
    v_mov_b32 v10, 0
    v_mov_b32 v11, 0
    v_mov_b32 v12, 0
    v_mov_b32 v13, 0
    v_lshlrev_b32 v14, 4, v1
    s_lshl_b32 s26, s3, 11
    v_add_u32 v14, s26, v14
    v_add_u32 v15, 0x10000, v14
    ds_write_b128 v14, v[10:13] offset:0
    ds_write_b128 v14, v[10:13] offset:32768
    ds_write_b128 v15, v[10:13] offset:0
    ds_write_b128 v15, v[10:13] offset:32768
    ds_write_b32 v2, v2 offset:1024
    s_mov_b32 s33, s34
    s_waitcnt lgkmcnt(0)
    s_barrier
    s_branch L_k3_basisback
L_k3_prime:
    s_cmp_eq_u64 s[24:25], 0
    s_cbranch_scc1 L_pr_409
L_pb_408:
    s_ff1_i32_b64 s28, s[24:25]
    s_bitset0_b64 s[24:25], s28
    v_readlane_b32 s40, v7, s28
    s_lshr_b32 s26, s40, 6
    s_bfm_b64 exec, s40, 0
    v_add_lshl_u32 v20, s26, v1, 3
L_pi_411:
    buffer_load_dwordx2 v[20:21], v20, s[8:11], s30 offen
    s_cmp_eq_u64 s[24:25], 0
    s_cbranch_scc1 L_pr_413
L_pb_412:
    s_ff1_i32_b64 s28, s[24:25]
    s_bitset0_b64 s[24:25], s28
    v_readlane_b32 s41, v7, s28
    s_lshr_b32 s26, s41, 6
    s_bfm_b64 exec, s41, 0
    v_add_lshl_u32 v22, s26, v1, 3
L_pi_415:
    buffer_load_dwordx2 v[22:23], v22, s[8:11], s30 offen
    s_cmp_eq_u64 s[24:25], 0
    s_cbranch_scc1 L_pr_417
L_pb_416:
    s_ff1_i32_b64 s28, s[24:25]
    s_bitset0_b64 s[24:25], s28
    v_readlane_b32 s42, v7, s28
    s_lshr_b32 s26, s42, 6
    s_bfm_b64 exec, s42, 0
    v_add_lshl_u32 v24, s26, v1, 3
L_pi_419:
    buffer_load_dwordx2 v[24:25], v24, s[8:11], s30 offen
    s_cmp_eq_u64 s[24:25], 0
    s_cbranch_scc1 L_pr_421
L_pb_420:
    s_ff1_i32_b64 s28, s[24:25]
    s_bitset0_b64 s[24:25], s28
    v_readlane_b32 s43, v7, s28
    s_lshr_b32 s26, s43, 6
    s_bfm_b64 exec, s43, 0
    v_add_lshl_u32 v26, s26, v1, 3
L_pi_423:
    buffer_load_dwordx2 v[26:27], v26, s[8:11], s30 offen
    s_cmp_eq_u64 s[24:25], 0
    s_cbranch_scc1 L_pr_425
L_pb_424:
    s_ff1_i32_b64 s28, s[24:25]
    s_bitset0_b64 s[24:25], s28
    v_readlane_b32 s44, v7, s28
    s_lshr_b32 s26, s44, 6
    s_bfm_b64 exec, s44, 0
    v_add_lshl_u32 v28, s26, v1, 3
L_pi_427:
    buffer_load_dwordx2 v[28:29], v28, s[8:11], s30 offen
    s_branch L_k3_basisback
L_k3_basis:
    s_mov_b64 exec, -1
    s_waitcnt vmcnt(5)
    v_max3_u32 v38, v38, v39, v40
    v_max_u32 v38, v38, v41
    s_nop 1
    v_max_u32_dpp v38, v38, v38 row_shr:1 row_mask:0xf bank_mask:0xf
    s_nop 1
    v_max_u32_dpp v38, v38, v38 row_shr:2 row_mask:0xf bank_mask:0xf
    s_nop 1
    v_max_u32_dpp v38, v38, v38 row_shr:4 row_mask:0xf bank_mask:0xf
    s_nop 1
    v_max_u32_dpp v38, v38, v38 row_shr:8 row_mask:0xf bank_mask:0xf
    s_nop 1
    v_max_u32_dpp v38, v38, v38 row_bcast:15 row_mask:0xa bank_mask:0xf
    s_nop 1
    v_max_u32_dpp v38, v38, v38 row_bcast:31 row_mask:0xc bank_mask:0xf
    s_nop 0
    v_readlane_b32 s35, v38, 63
    s_nop 3
    s_max_u32 s35, s35, 2176
    s_lshl_b32 s35, s35, 16
    v_mov_b32 v19, s35
    v_mul_f32 v19, 0x39808081, v19
    v_lshlrev_b32 v86, 16, v86
    v_lshlrev_b32 v87, 16, v87
    s_lshl_b32 s38, s72, 16
    s_and_b32 s39, s72, 0xffff0000
    v_pk_add_f32 v[94:95], v[86:87], s[38:39] op_sel:[0,0] op_sel_hi:[0,1] neg_lo:[0,1] neg_hi:[0,1]
    v_pk_add_f32 v[102:103], v[86:87], s[38:39] op_sel:[1,0] op_sel_hi:[1,1] neg_lo:[0,1] neg_hi:[0,1]
    v_cvt_pk_bf16_f32 v94, v94, v95
    v_cvt_pk_bf16_f32 v102, v102, v103
    v_and_b32 v95, 0xffff0000, v94
    v_and_b32 v103, 0xffff0000, v102
    v_lshlrev_b32 v94, 16, v94
    v_lshlrev_b32 v102, 16, v102
    v_mul_f32 v94, v94, v94
    v_mul_f32 v95, v95, v95
    v_mul_f32 v102, v102, v102
    v_mul_f32 v103, v103, v103
    v_cvt_pk_bf16_f32 v94, v94, v95
    v_cvt_pk_bf16_f32 v102, v102, v103
    v_and_b32 v95, 0xffff0000, v94
    v_and_b32 v103, 0xffff0000, v102
    v_lshlrev_b32 v94, 16, v94
    v_lshlrev_b32 v102, 16, v102
    v_mul_f32 v94, 0xc1200000, v94
    v_mul_f32 v95, 0xc1200000, v95
    v_mul_f32 v102, 0xc1200000, v102
    v_mul_f32 v103, 0xc1200000, v103
    v_cvt_pk_bf16_f32 v94, v94, v95
    v_cvt_pk_bf16_f32 v102, v102, v103
    v_and_b32 v95, 0xffff0000, v94
    v_and_b32 v103, 0xffff0000, v102
    v_lshlrev_b32 v94, 16, v94
    v_lshlrev_b32 v102, 16, v102
    v_mul_f32 v94, 0x3fb8aa3b, v94
    v_mul_f32 v95, 0x3fb8aa3b, v95
    v_mul_f32 v102, 0x3fb8aa3b, v102
    v_mul_f32 v103, 0x3fb8aa3b, v103
    v_exp_f32 v94, v94
    v_exp_f32 v95, v95
    v_exp_f32 v102, v102
    v_exp_f32 v103, v103
    s_nop 0
    v_cvt_pk_bf16_f32 v94, v94, v95
    v_cvt_pk_bf16_f32 v102, v102, v103
    v_and_b32 v95, 0xffff0000, v94
    v_and_b32 v103, 0xffff0000, v102
    v_lshlrev_b32 v94, 16, v94
    v_lshlrev_b32 v102, 16, v102
    s_lshl_b32 s38, s73, 16
    s_and_b32 s39, s73, 0xffff0000
    v_pk_add_f32 v[96:97], v[86:87], s[38:39] op_sel:[0,0] op_sel_hi:[0,1] neg_lo:[0,1] neg_hi:[0,1]
    v_pk_add_f32 v[104:105], v[86:87], s[38:39] op_sel:[1,0] op_sel_hi:[1,1] neg_lo:[0,1] neg_hi:[0,1]
    v_cvt_pk_bf16_f32 v96, v96, v97
    v_cvt_pk_bf16_f32 v104, v104, v105
    v_and_b32 v97, 0xffff0000, v96
    v_and_b32 v105, 0xffff0000, v104
    v_lshlrev_b32 v96, 16, v96
    v_lshlrev_b32 v104, 16, v104
    v_mul_f32 v96, v96, v96
    v_mul_f32 v97, v97, v97
    v_mul_f32 v104, v104, v104
    v_mul_f32 v105, v105, v105
    v_cvt_pk_bf16_f32 v96, v96, v97
    v_cvt_pk_bf16_f32 v104, v104, v105
    v_and_b32 v97, 0xffff0000, v96
    v_and_b32 v105, 0xffff0000, v104
    v_lshlrev_b32 v96, 16, v96
    v_lshlrev_b32 v104, 16, v104
    v_mul_f32 v96, 0xc1200000, v96
    v_mul_f32 v97, 0xc1200000, v97
    v_mul_f32 v104, 0xc1200000, v104
    v_mul_f32 v105, 0xc1200000, v105
    v_cvt_pk_bf16_f32 v96, v96, v97
    v_cvt_pk_bf16_f32 v104, v104, v105
    v_and_b32 v97, 0xffff0000, v96
    v_and_b32 v105, 0xffff0000, v104
    v_lshlrev_b32 v96, 16, v96
    v_lshlrev_b32 v104, 16, v104
    v_mul_f32 v96, 0x3fb8aa3b, v96
    v_mul_f32 v97, 0x3fb8aa3b, v97
    v_mul_f32 v104, 0x3fb8aa3b, v104
    v_mul_f32 v105, 0x3fb8aa3b, v105
    v_exp_f32 v96, v96
    v_exp_f32 v97, v97
    v_exp_f32 v104, v104
    v_exp_f32 v105, v105
    s_nop 0
    v_cvt_pk_bf16_f32 v96, v96, v97
    v_cvt_pk_bf16_f32 v104, v104, v105
    v_and_b32 v97, 0xffff0000, v96
    v_and_b32 v105, 0xffff0000, v104
    v_lshlrev_b32 v96, 16, v96
    v_lshlrev_b32 v104, 16, v104
    s_lshl_b32 s38, s74, 16
    s_and_b32 s39, s74, 0xffff0000
    v_pk_add_f32 v[98:99], v[86:87], s[38:39] op_sel:[0,0] op_sel_hi:[0,1] neg_lo:[0,1] neg_hi:[0,1]
    v_pk_add_f32 v[106:107], v[86:87], s[38:39] op_sel:[1,0] op_sel_hi:[1,1] neg_lo:[0,1] neg_hi:[0,1]
    v_cvt_pk_bf16_f32 v98, v98, v99
    v_cvt_pk_bf16_f32 v106, v106, v107
    v_and_b32 v99, 0xffff0000, v98
    v_and_b32 v107, 0xffff0000, v106
    v_lshlrev_b32 v98, 16, v98
    v_lshlrev_b32 v106, 16, v106
    v_mul_f32 v98, v98, v98
    v_mul_f32 v99, v99, v99
    v_mul_f32 v106, v106, v106
    v_mul_f32 v107, v107, v107
    v_cvt_pk_bf16_f32 v98, v98, v99
    v_cvt_pk_bf16_f32 v106, v106, v107
    v_and_b32 v99, 0xffff0000, v98
    v_and_b32 v107, 0xffff0000, v106
    v_lshlrev_b32 v98, 16, v98
    v_lshlrev_b32 v106, 16, v106
    v_mul_f32 v98, 0xc1200000, v98
    v_mul_f32 v99, 0xc1200000, v99
    v_mul_f32 v106, 0xc1200000, v106
    v_mul_f32 v107, 0xc1200000, v107
    v_cvt_pk_bf16_f32 v98, v98, v99
    v_cvt_pk_bf16_f32 v106, v106, v107
    v_and_b32 v99, 0xffff0000, v98
    v_and_b32 v107, 0xffff0000, v106
    v_lshlrev_b32 v98, 16, v98
    v_lshlrev_b32 v106, 16, v106
    v_mul_f32 v98, 0x3fb8aa3b, v98
    v_mul_f32 v99, 0x3fb8aa3b, v99
    v_mul_f32 v106, 0x3fb8aa3b, v106
    v_mul_f32 v107, 0x3fb8aa3b, v107
    v_exp_f32 v98, v98
    v_exp_f32 v99, v99
    v_exp_f32 v106, v106
    v_exp_f32 v107, v107
    s_nop 0
    v_cvt_pk_bf16_f32 v98, v98, v99
    v_cvt_pk_bf16_f32 v106, v106, v107
    v_and_b32 v99, 0xffff0000, v98
    v_and_b32 v107, 0xffff0000, v106
    v_lshlrev_b32 v98, 16, v98
    v_lshlrev_b32 v106, 16, v106
    s_lshl_b32 s38, s75, 16
    s_and_b32 s39, s75, 0xffff0000
    v_pk_add_f32 v[100:101], v[86:87], s[38:39] op_sel:[0,0] op_sel_hi:[0,1] neg_lo:[0,1] neg_hi:[0,1]
    v_pk_add_f32 v[108:109], v[86:87], s[38:39] op_sel:[1,0] op_sel_hi:[1,1] neg_lo:[0,1] neg_hi:[0,1]
    v_cvt_pk_bf16_f32 v100, v100, v101
    v_cvt_pk_bf16_f32 v108, v108, v109
    v_and_b32 v101, 0xffff0000, v100
    v_and_b32 v109, 0xffff0000, v108
    v_lshlrev_b32 v100, 16, v100
    v_lshlrev_b32 v108, 16, v108
    v_mul_f32 v100, v100, v100
    v_mul_f32 v101, v101, v101
    v_mul_f32 v108, v108, v108
    v_mul_f32 v109, v109, v109
    v_cvt_pk_bf16_f32 v100, v100, v101
    v_cvt_pk_bf16_f32 v108, v108, v109
    v_and_b32 v101, 0xffff0000, v100
    v_and_b32 v109, 0xffff0000, v108
    v_lshlrev_b32 v100, 16, v100
    v_lshlrev_b32 v108, 16, v108
    v_mul_f32 v100, 0xc1200000, v100
    v_mul_f32 v101, 0xc1200000, v101
    v_mul_f32 v108, 0xc1200000, v108
    v_mul_f32 v109, 0xc1200000, v109
    v_cvt_pk_bf16_f32 v100, v100, v101
    v_cvt_pk_bf16_f32 v108, v108, v109
    v_and_b32 v101, 0xffff0000, v100
    v_and_b32 v109, 0xffff0000, v108
    v_lshlrev_b32 v100, 16, v100
    v_lshlrev_b32 v108, 16, v108
    v_mul_f32 v100, 0x3fb8aa3b, v100
    v_mul_f32 v101, 0x3fb8aa3b, v101
    v_mul_f32 v108, 0x3fb8aa3b, v108
    v_mul_f32 v109, 0x3fb8aa3b, v109
    v_exp_f32 v100, v100
    v_exp_f32 v101, v101
    v_exp_f32 v108, v108
    v_exp_f32 v109, v109
    s_nop 0
    v_cvt_pk_bf16_f32 v100, v100, v101
    v_cvt_pk_bf16_f32 v108, v108, v109
    v_and_b32 v101, 0xffff0000, v100
    v_and_b32 v109, 0xffff0000, v108
    v_lshlrev_b32 v100, 16, v100
    v_lshlrev_b32 v108, 16, v108
    s_load_dwordx16 s[76:91], s[94:95], 0
    s_waitcnt lgkmcnt(0)
    s_lshl_b32 s38, s76, 16
    s_and_b32 s39, s76, 0xffff0000
    v_pk_mul_f32 v[38:39], v[94:95], s[38:39] op_sel:[0,0] op_sel_hi:[0,1]
    v_pk_mul_f32 v[42:43], v[102:103], s[38:39] op_sel:[0,0] op_sel_hi:[0,1]
    s_lshl_b32 s38, s77, 16
    s_and_b32 s39, s77, 0xffff0000
    v_pk_mul_f32 v[40:41], v[94:95], s[38:39] op_sel:[0,0] op_sel_hi:[0,1]
    v_pk_mul_f32 v[44:45], v[102:103], s[38:39] op_sel:[0,0] op_sel_hi:[0,1]
    s_lshl_b32 s38, s78, 16
    s_and_b32 s39, s78, 0xffff0000
    v_pk_fma_f32 v[38:39], v[94:95], s[38:39], v[38:39] op_sel:[1,0,0] op_sel_hi:[1,1,1]
    v_pk_fma_f32 v[42:43], v[102:103], s[38:39], v[42:43] op_sel:[1,0,0] op_sel_hi:[1,1,1]
    s_lshl_b32 s38, s79, 16
    s_and_b32 s39, s79, 0xffff0000
    v_pk_fma_f32 v[40:41], v[94:95], s[38:39], v[40:41] op_sel:[1,0,0] op_sel_hi:[1,1,1]
    v_pk_fma_f32 v[44:45], v[102:103], s[38:39], v[44:45] op_sel:[1,0,0] op_sel_hi:[1,1,1]
    s_lshl_b32 s38, s80, 16
    s_and_b32 s39, s80, 0xffff0000
    v_pk_fma_f32 v[38:39], v[96:97], s[38:39], v[38:39] op_sel:[0,0,0] op_sel_hi:[0,1,1]
    v_pk_fma_f32 v[42:43], v[104:105], s[38:39], v[42:43] op_sel:[0,0,0] op_sel_hi:[0,1,1]
    s_lshl_b32 s38, s81, 16
    s_and_b32 s39, s81, 0xffff0000
    v_pk_fma_f32 v[40:41], v[96:97], s[38:39], v[40:41] op_sel:[0,0,0] op_sel_hi:[0,1,1]
    v_pk_fma_f32 v[44:45], v[104:105], s[38:39], v[44:45] op_sel:[0,0,0] op_sel_hi:[0,1,1]
    s_lshl_b32 s38, s82, 16
    s_and_b32 s39, s82, 0xffff0000
    v_pk_fma_f32 v[38:39], v[96:97], s[38:39], v[38:39] op_sel:[1,0,0] op_sel_hi:[1,1,1]
    v_pk_fma_f32 v[42:43], v[104:105], s[38:39], v[42:43] op_sel:[1,0,0] op_sel_hi:[1,1,1]
    s_lshl_b32 s38, s83, 16
    s_and_b32 s39, s83, 0xffff0000
    v_pk_fma_f32 v[40:41], v[96:97], s[38:39], v[40:41] op_sel:[1,0,0] op_sel_hi:[1,1,1]
    v_pk_fma_f32 v[44:45], v[104:105], s[38:39], v[44:45] op_sel:[1,0,0] op_sel_hi:[1,1,1]
    s_lshl_b32 s38, s84, 16
    s_and_b32 s39, s84, 0xffff0000
    v_pk_fma_f32 v[38:39], v[98:99], s[38:39], v[38:39] op_sel:[0,0,0] op_sel_hi:[0,1,1]
    v_pk_fma_f32 v[42:43], v[106:107], s[38:39], v[42:43] op_sel:[0,0,0] op_sel_hi:[0,1,1]
    s_lshl_b32 s38, s85, 16
    s_and_b32 s39, s85, 0xffff0000
    v_pk_fma_f32 v[40:41], v[98:99], s[38:39], v[40:41] op_sel:[0,0,0] op_sel_hi:[0,1,1]
    v_pk_fma_f32 v[44:45], v[106:107], s[38:39], v[44:45] op_sel:[0,0,0] op_sel_hi:[0,1,1]
    s_lshl_b32 s38, s86, 16
    s_and_b32 s39, s86, 0xffff0000
    v_pk_fma_f32 v[38:39], v[98:99], s[38:39], v[38:39] op_sel:[1,0,0] op_sel_hi:[1,1,1]
    v_pk_fma_f32 v[42:43], v[106:107], s[38:39], v[42:43] op_sel:[1,0,0] op_sel_hi:[1,1,1]
    s_lshl_b32 s38, s87, 16
    s_and_b32 s39, s87, 0xffff0000
    v_pk_fma_f32 v[40:41], v[98:99], s[38:39], v[40:41] op_sel:[1,0,0] op_sel_hi:[1,1,1]
    v_pk_fma_f32 v[44:45], v[106:107], s[38:39], v[44:45] op_sel:[1,0,0] op_sel_hi:[1,1,1]
    s_lshl_b32 s38, s88, 16
    s_and_b32 s39, s88, 0xffff0000
    v_pk_fma_f32 v[38:39], v[100:101], s[38:39], v[38:39] op_sel:[0,0,0] op_sel_hi:[0,1,1]
    v_pk_fma_f32 v[42:43], v[108:109], s[38:39], v[42:43] op_sel:[0,0,0] op_sel_hi:[0,1,1]
    s_lshl_b32 s38, s89, 16
    s_and_b32 s39, s89, 0xffff0000
    v_pk_fma_f32 v[40:41], v[100:101], s[38:39], v[40:41] op_sel:[0,0,0] op_sel_hi:[0,1,1]
    v_pk_fma_f32 v[44:45], v[108:109], s[38:39], v[44:45] op_sel:[0,0,0] op_sel_hi:[0,1,1]
    s_lshl_b32 s38, s90, 16
    s_and_b32 s39, s90, 0xffff0000
    v_pk_fma_f32 v[38:39], v[100:101], s[38:39], v[38:39] op_sel:[1,0,0] op_sel_hi:[1,1,1]
    v_pk_fma_f32 v[42:43], v[108:109], s[38:39], v[42:43] op_sel:[1,0,0] op_sel_hi:[1,1,1]
    s_lshl_b32 s38, s91, 16
    s_and_b32 s39, s91, 0xffff0000
    v_pk_fma_f32 v[40:41], v[100:101], s[38:39], v[40:41] op_sel:[1,0,0] op_sel_hi:[1,1,1]
    v_pk_fma_f32 v[44:45], v[108:109], s[38:39], v[44:45] op_sel:[1,0,0] op_sel_hi:[1,1,1]
    s_load_dwordx16 s[76:91], s[92:93], 0
    s_waitcnt lgkmcnt(0)
    s_lshl_b32 s38, s76, 16
    s_and_b32 s39, s76, 0xffff0000
    v_pk_mul_f32 v[54:55], v[94:95], s[38:39] op_sel:[0,0] op_sel_hi:[0,1]
    v_pk_mul_f32 v[58:59], v[102:103], s[38:39] op_sel:[0,0] op_sel_hi:[0,1]
    s_lshl_b32 s38, s77, 16
    s_and_b32 s39, s77, 0xffff0000
    v_pk_mul_f32 v[56:57], v[94:95], s[38:39] op_sel:[0,0] op_sel_hi:[0,1]
    v_pk_mul_f32 v[60:61], v[102:103], s[38:39] op_sel:[0,0] op_sel_hi:[0,1]
    s_lshl_b32 s38, s78, 16
    s_and_b32 s39, s78, 0xffff0000
    v_pk_fma_f32 v[54:55], v[94:95], s[38:39], v[54:55] op_sel:[1,0,0] op_sel_hi:[1,1,1]
    v_pk_fma_f32 v[58:59], v[102:103], s[38:39], v[58:59] op_sel:[1,0,0] op_sel_hi:[1,1,1]
    s_lshl_b32 s38, s79, 16
    s_and_b32 s39, s79, 0xffff0000
    v_pk_fma_f32 v[56:57], v[94:95], s[38:39], v[56:57] op_sel:[1,0,0] op_sel_hi:[1,1,1]
    v_pk_fma_f32 v[60:61], v[102:103], s[38:39], v[60:61] op_sel:[1,0,0] op_sel_hi:[1,1,1]
    s_lshl_b32 s38, s80, 16
    s_and_b32 s39, s80, 0xffff0000
    v_pk_fma_f32 v[54:55], v[96:97], s[38:39], v[54:55] op_sel:[0,0,0] op_sel_hi:[0,1,1]
    v_pk_fma_f32 v[58:59], v[104:105], s[38:39], v[58:59] op_sel:[0,0,0] op_sel_hi:[0,1,1]
    s_lshl_b32 s38, s81, 16
    s_and_b32 s39, s81, 0xffff0000
    v_pk_fma_f32 v[56:57], v[96:97], s[38:39], v[56:57] op_sel:[0,0,0] op_sel_hi:[0,1,1]
    v_pk_fma_f32 v[60:61], v[104:105], s[38:39], v[60:61] op_sel:[0,0,0] op_sel_hi:[0,1,1]
    s_lshl_b32 s38, s82, 16
    s_and_b32 s39, s82, 0xffff0000
    v_pk_fma_f32 v[54:55], v[96:97], s[38:39], v[54:55] op_sel:[1,0,0] op_sel_hi:[1,1,1]
    v_pk_fma_f32 v[58:59], v[104:105], s[38:39], v[58:59] op_sel:[1,0,0] op_sel_hi:[1,1,1]
    s_lshl_b32 s38, s83, 16
    s_and_b32 s39, s83, 0xffff0000
    v_pk_fma_f32 v[56:57], v[96:97], s[38:39], v[56:57] op_sel:[1,0,0] op_sel_hi:[1,1,1]
    v_pk_fma_f32 v[60:61], v[104:105], s[38:39], v[60:61] op_sel:[1,0,0] op_sel_hi:[1,1,1]
    s_lshl_b32 s38, s84, 16
    s_and_b32 s39, s84, 0xffff0000
    v_pk_fma_f32 v[54:55], v[98:99], s[38:39], v[54:55] op_sel:[0,0,0] op_sel_hi:[0,1,1]
    v_pk_fma_f32 v[58:59], v[106:107], s[38:39], v[58:59] op_sel:[0,0,0] op_sel_hi:[0,1,1]
    s_lshl_b32 s38, s85, 16
    s_and_b32 s39, s85, 0xffff0000
    v_pk_fma_f32 v[56:57], v[98:99], s[38:39], v[56:57] op_sel:[0,0,0] op_sel_hi:[0,1,1]
    v_pk_fma_f32 v[60:61], v[106:107], s[38:39], v[60:61] op_sel:[0,0,0] op_sel_hi:[0,1,1]
    s_lshl_b32 s38, s86, 16
    s_and_b32 s39, s86, 0xffff0000
    v_pk_fma_f32 v[54:55], v[98:99], s[38:39], v[54:55] op_sel:[1,0,0] op_sel_hi:[1,1,1]
    v_pk_fma_f32 v[58:59], v[106:107], s[38:39], v[58:59] op_sel:[1,0,0] op_sel_hi:[1,1,1]
    s_lshl_b32 s38, s87, 16
    s_and_b32 s39, s87, 0xffff0000
    v_pk_fma_f32 v[56:57], v[98:99], s[38:39], v[56:57] op_sel:[1,0,0] op_sel_hi:[1,1,1]
    v_pk_fma_f32 v[60:61], v[106:107], s[38:39], v[60:61] op_sel:[1,0,0] op_sel_hi:[1,1,1]
    s_lshl_b32 s38, s88, 16
    s_and_b32 s39, s88, 0xffff0000
    v_pk_fma_f32 v[54:55], v[100:101], s[38:39], v[54:55] op_sel:[0,0,0] op_sel_hi:[0,1,1]
    v_pk_fma_f32 v[58:59], v[108:109], s[38:39], v[58:59] op_sel:[0,0,0] op_sel_hi:[0,1,1]
    s_lshl_b32 s38, s89, 16
    s_and_b32 s39, s89, 0xffff0000
    v_pk_fma_f32 v[56:57], v[100:101], s[38:39], v[56:57] op_sel:[0,0,0] op_sel_hi:[0,1,1]
    v_pk_fma_f32 v[60:61], v[108:109], s[38:39], v[60:61] op_sel:[0,0,0] op_sel_hi:[0,1,1]
    s_lshl_b32 s38, s90, 16
    s_and_b32 s39, s90, 0xffff0000
    v_pk_fma_f32 v[54:55], v[100:101], s[38:39], v[54:55] op_sel:[1,0,0] op_sel_hi:[1,1,1]
    v_pk_fma_f32 v[58:59], v[108:109], s[38:39], v[58:59] op_sel:[1,0,0] op_sel_hi:[1,1,1]
    s_lshl_b32 s38, s91, 16
    s_and_b32 s39, s91, 0xffff0000
    v_pk_fma_f32 v[56:57], v[100:101], s[38:39], v[56:57] op_sel:[1,0,0] op_sel_hi:[1,1,1]
    v_pk_fma_f32 v[60:61], v[108:109], s[38:39], v[60:61] op_sel:[1,0,0] op_sel_hi:[1,1,1]
    v_mul_f32 v38, v19, v38
    v_mul_f32 v39, v19, v39
    v_mul_f32 v40, v19, v40
    v_mul_f32 v41, v19, v41
    v_cvt_pk_bf16_f32 v54, v54, v55
    v_and_b32 v55, 0xffff0000, v54
    v_lshlrev_b32 v54, 16, v54
    v_cvt_pk_bf16_f32 v56, v56, v57
    v_and_b32 v57, 0xffff0000, v56
    v_lshlrev_b32 v56, 16, v56
    v_mul_f32 v42, v19, v42
    v_mul_f32 v43, v19, v43
    v_mul_f32 v44, v19, v44
    v_mul_f32 v45, v19, v45
    v_cvt_pk_bf16_f32 v58, v58, v59
    v_and_b32 v59, 0xffff0000, v58
    v_lshlrev_b32 v58, 16, v58
    v_cvt_pk_bf16_f32 v60, v60, v61
    v_and_b32 v61, 0xffff0000, v60
    v_lshlrev_b32 v60, 16, v60
    v_lshlrev_b32 v88, 16, v88
    s_lshl_b32 s38, s72, 16
    s_and_b32 s39, s72, 0xffff0000
    v_pk_add_f32 v[94:95], v[88:89], s[38:39] op_sel:[0,0] op_sel_hi:[0,1] neg_lo:[0,1] neg_hi:[0,1]
    v_cvt_pk_bf16_f32 v94, v94, v95
    v_and_b32 v95, 0xffff0000, v94
    v_lshlrev_b32 v94, 16, v94
    v_mul_f32 v94, v94, v94
    v_mul_f32 v95, v95, v95
    v_cvt_pk_bf16_f32 v94, v94, v95
    v_and_b32 v95, 0xffff0000, v94
    v_lshlrev_b32 v94, 16, v94
    v_mul_f32 v94, 0xc1200000, v94
    v_mul_f32 v95, 0xc1200000, v95
    v_cvt_pk_bf16_f32 v94, v94, v95
    v_and_b32 v95, 0xffff0000, v94
    v_lshlrev_b32 v94, 16, v94
    v_mul_f32 v94, 0x3fb8aa3b, v94
    v_mul_f32 v95, 0x3fb8aa3b, v95
    v_exp_f32 v94, v94
    v_exp_f32 v95, v95
    s_nop 0
    v_cvt_pk_bf16_f32 v94, v94, v95
    v_and_b32 v95, 0xffff0000, v94
    v_lshlrev_b32 v94, 16, v94
    s_lshl_b32 s38, s73, 16
    s_and_b32 s39, s73, 0xffff0000
    v_pk_add_f32 v[96:97], v[88:89], s[38:39] op_sel:[0,0] op_sel_hi:[0,1] neg_lo:[0,1] neg_hi:[0,1]
    v_cvt_pk_bf16_f32 v96, v96, v97
    v_and_b32 v97, 0xffff0000, v96
    v_lshlrev_b32 v96, 16, v96
    v_mul_f32 v96, v96, v96
    v_mul_f32 v97, v97, v97
    v_cvt_pk_bf16_f32 v96, v96, v97
    v_and_b32 v97, 0xffff0000, v96
    v_lshlrev_b32 v96, 16, v96
    v_mul_f32 v96, 0xc1200000, v96
    v_mul_f32 v97, 0xc1200000, v97
    v_cvt_pk_bf16_f32 v96, v96, v97
    v_and_b32 v97, 0xffff0000, v96
    v_lshlrev_b32 v96, 16, v96
    v_mul_f32 v96, 0x3fb8aa3b, v96
    v_mul_f32 v97, 0x3fb8aa3b, v97
    v_exp_f32 v96, v96
    v_exp_f32 v97, v97
    s_nop 0
    v_cvt_pk_bf16_f32 v96, v96, v97
    v_and_b32 v97, 0xffff0000, v96
    v_lshlrev_b32 v96, 16, v96
    s_lshl_b32 s38, s74, 16
    s_and_b32 s39, s74, 0xffff0000
    v_pk_add_f32 v[98:99], v[88:89], s[38:39] op_sel:[0,0] op_sel_hi:[0,1] neg_lo:[0,1] neg_hi:[0,1]
    v_cvt_pk_bf16_f32 v98, v98, v99
    v_and_b32 v99, 0xffff0000, v98
    v_lshlrev_b32 v98, 16, v98
    v_mul_f32 v98, v98, v98
    v_mul_f32 v99, v99, v99
    v_cvt_pk_bf16_f32 v98, v98, v99
    v_and_b32 v99, 0xffff0000, v98
    v_lshlrev_b32 v98, 16, v98
    v_mul_f32 v98, 0xc1200000, v98
    v_mul_f32 v99, 0xc1200000, v99
    v_cvt_pk_bf16_f32 v98, v98, v99
    v_and_b32 v99, 0xffff0000, v98
    v_lshlrev_b32 v98, 16, v98
    v_mul_f32 v98, 0x3fb8aa3b, v98
    v_mul_f32 v99, 0x3fb8aa3b, v99
    v_exp_f32 v98, v98
    v_exp_f32 v99, v99
    s_nop 0
    v_cvt_pk_bf16_f32 v98, v98, v99
    v_and_b32 v99, 0xffff0000, v98
    v_lshlrev_b32 v98, 16, v98
    s_lshl_b32 s38, s75, 16
    s_and_b32 s39, s75, 0xffff0000
    v_pk_add_f32 v[100:101], v[88:89], s[38:39] op_sel:[0,0] op_sel_hi:[0,1] neg_lo:[0,1] neg_hi:[0,1]
    v_cvt_pk_bf16_f32 v100, v100, v101
    v_and_b32 v101, 0xffff0000, v100
    v_lshlrev_b32 v100, 16, v100
    v_mul_f32 v100, v100, v100
    v_mul_f32 v101, v101, v101
    v_cvt_pk_bf16_f32 v100, v100, v101
    v_and_b32 v101, 0xffff0000, v100
    v_lshlrev_b32 v100, 16, v100
    v_mul_f32 v100, 0xc1200000, v100
    v_mul_f32 v101, 0xc1200000, v101
    v_cvt_pk_bf16_f32 v100, v100, v101
    v_and_b32 v101, 0xffff0000, v100
    v_lshlrev_b32 v100, 16, v100
    v_mul_f32 v100, 0x3fb8aa3b, v100
    v_mul_f32 v101, 0x3fb8aa3b, v101
    v_exp_f32 v100, v100
    v_exp_f32 v101, v101
    s_nop 0
    v_cvt_pk_bf16_f32 v100, v100, v101
    v_and_b32 v101, 0xffff0000, v100
    v_lshlrev_b32 v100, 16, v100
    s_load_dwordx16 s[76:91], s[94:95], 0
    s_waitcnt lgkmcnt(0)
    s_lshl_b32 s38, s76, 16
    s_and_b32 s39, s76, 0xffff0000
    v_pk_mul_f32 v[46:47], v[94:95], s[38:39] op_sel:[0,0] op_sel_hi:[0,1]
    s_lshl_b32 s38, s77, 16
    s_and_b32 s39, s77, 0xffff0000
    v_pk_mul_f32 v[48:49], v[94:95], s[38:39] op_sel:[0,0] op_sel_hi:[0,1]
    s_lshl_b32 s38, s78, 16
    s_and_b32 s39, s78, 0xffff0000
    v_pk_fma_f32 v[46:47], v[94:95], s[38:39], v[46:47] op_sel:[1,0,0] op_sel_hi:[1,1,1]
    s_lshl_b32 s38, s79, 16
    s_and_b32 s39, s79, 0xffff0000
    v_pk_fma_f32 v[48:49], v[94:95], s[38:39], v[48:49] op_sel:[1,0,0] op_sel_hi:[1,1,1]
    s_lshl_b32 s38, s80, 16
    s_and_b32 s39, s80, 0xffff0000
    v_pk_fma_f32 v[46:47], v[96:97], s[38:39], v[46:47] op_sel:[0,0,0] op_sel_hi:[0,1,1]
    s_lshl_b32 s38, s81, 16
    s_and_b32 s39, s81, 0xffff0000
    v_pk_fma_f32 v[48:49], v[96:97], s[38:39], v[48:49] op_sel:[0,0,0] op_sel_hi:[0,1,1]
    s_lshl_b32 s38, s82, 16
    s_and_b32 s39, s82, 0xffff0000
    v_pk_fma_f32 v[46:47], v[96:97], s[38:39], v[46:47] op_sel:[1,0,0] op_sel_hi:[1,1,1]
    s_lshl_b32 s38, s83, 16
    s_and_b32 s39, s83, 0xffff0000
    v_pk_fma_f32 v[48:49], v[96:97], s[38:39], v[48:49] op_sel:[1,0,0] op_sel_hi:[1,1,1]
    s_lshl_b32 s38, s84, 16
    s_and_b32 s39, s84, 0xffff0000
    v_pk_fma_f32 v[46:47], v[98:99], s[38:39], v[46:47] op_sel:[0,0,0] op_sel_hi:[0,1,1]
    s_lshl_b32 s38, s85, 16
    s_and_b32 s39, s85, 0xffff0000
    v_pk_fma_f32 v[48:49], v[98:99], s[38:39], v[48:49] op_sel:[0,0,0] op_sel_hi:[0,1,1]
    s_lshl_b32 s38, s86, 16
    s_and_b32 s39, s86, 0xffff0000
    v_pk_fma_f32 v[46:47], v[98:99], s[38:39], v[46:47] op_sel:[1,0,0] op_sel_hi:[1,1,1]
    s_lshl_b32 s38, s87, 16
    s_and_b32 s39, s87, 0xffff0000
    v_pk_fma_f32 v[48:49], v[98:99], s[38:39], v[48:49] op_sel:[1,0,0] op_sel_hi:[1,1,1]
    s_lshl_b32 s38, s88, 16
    s_and_b32 s39, s88, 0xffff0000
    v_pk_fma_f32 v[46:47], v[100:101], s[38:39], v[46:47] op_sel:[0,0,0] op_sel_hi:[0,1,1]
    s_lshl_b32 s38, s89, 16
    s_and_b32 s39, s89, 0xffff0000
    v_pk_fma_f32 v[48:49], v[100:101], s[38:39], v[48:49] op_sel:[0,0,0] op_sel_hi:[0,1,1]
    s_lshl_b32 s38, s90, 16
    s_and_b32 s39, s90, 0xffff0000
    v_pk_fma_f32 v[46:47], v[100:101], s[38:39], v[46:47] op_sel:[1,0,0] op_sel_hi:[1,1,1]
    s_lshl_b32 s38, s91, 16
    s_and_b32 s39, s91, 0xffff0000
    v_pk_fma_f32 v[48:49], v[100:101], s[38:39], v[48:49] op_sel:[1,0,0] op_sel_hi:[1,1,1]
    s_load_dwordx16 s[76:91], s[92:93], 0
    s_waitcnt lgkmcnt(0)
    s_lshl_b32 s38, s76, 16
    s_and_b32 s39, s76, 0xffff0000
    v_pk_mul_f32 v[62:63], v[94:95], s[38:39] op_sel:[0,0] op_sel_hi:[0,1]
    s_lshl_b32 s38, s77, 16
    s_and_b32 s39, s77, 0xffff0000
    v_pk_mul_f32 v[64:65], v[94:95], s[38:39] op_sel:[0,0] op_sel_hi:[0,1]
    s_lshl_b32 s38, s78, 16
    s_and_b32 s39, s78, 0xffff0000
    v_pk_fma_f32 v[62:63], v[94:95], s[38:39], v[62:63] op_sel:[1,0,0] op_sel_hi:[1,1,1]
    s_lshl_b32 s38, s79, 16
    s_and_b32 s39, s79, 0xffff0000
    v_pk_fma_f32 v[64:65], v[94:95], s[38:39], v[64:65] op_sel:[1,0,0] op_sel_hi:[1,1,1]
    s_lshl_b32 s38, s80, 16
    s_and_b32 s39, s80, 0xffff0000
    v_pk_fma_f32 v[62:63], v[96:97], s[38:39], v[62:63] op_sel:[0,0,0] op_sel_hi:[0,1,1]
    s_lshl_b32 s38, s81, 16
    s_and_b32 s39, s81, 0xffff0000
    v_pk_fma_f32 v[64:65], v[96:97], s[38:39], v[64:65] op_sel:[0,0,0] op_sel_hi:[0,1,1]
    s_lshl_b32 s38, s82, 16
    s_and_b32 s39, s82, 0xffff0000
    v_pk_fma_f32 v[62:63], v[96:97], s[38:39], v[62:63] op_sel:[1,0,0] op_sel_hi:[1,1,1]
    s_lshl_b32 s38, s83, 16
    s_and_b32 s39, s83, 0xffff0000
    v_pk_fma_f32 v[64:65], v[96:97], s[38:39], v[64:65] op_sel:[1,0,0] op_sel_hi:[1,1,1]
    s_lshl_b32 s38, s84, 16
    s_and_b32 s39, s84, 0xffff0000
    v_pk_fma_f32 v[62:63], v[98:99], s[38:39], v[62:63] op_sel:[0,0,0] op_sel_hi:[0,1,1]
    s_lshl_b32 s38, s85, 16
    s_and_b32 s39, s85, 0xffff0000
    v_pk_fma_f32 v[64:65], v[98:99], s[38:39], v[64:65] op_sel:[0,0,0] op_sel_hi:[0,1,1]
    s_lshl_b32 s38, s86, 16
    s_and_b32 s39, s86, 0xffff0000
    v_pk_fma_f32 v[62:63], v[98:99], s[38:39], v[62:63] op_sel:[1,0,0] op_sel_hi:[1,1,1]
    s_lshl_b32 s38, s87, 16
    s_and_b32 s39, s87, 0xffff0000
    v_pk_fma_f32 v[64:65], v[98:99], s[38:39], v[64:65] op_sel:[1,0,0] op_sel_hi:[1,1,1]
    s_lshl_b32 s38, s88, 16
    s_and_b32 s39, s88, 0xffff0000
    v_pk_fma_f32 v[62:63], v[100:101], s[38:39], v[62:63] op_sel:[0,0,0] op_sel_hi:[0,1,1]
    s_lshl_b32 s38, s89, 16
    s_and_b32 s39, s89, 0xffff0000
    v_pk_fma_f32 v[64:65], v[100:101], s[38:39], v[64:65] op_sel:[0,0,0] op_sel_hi:[0,1,1]
    s_lshl_b32 s38, s90, 16
    s_and_b32 s39, s90, 0xffff0000
    v_pk_fma_f32 v[62:63], v[100:101], s[38:39], v[62:63] op_sel:[1,0,0] op_sel_hi:[1,1,1]
    s_lshl_b32 s38, s91, 16
    s_and_b32 s39, s91, 0xffff0000
    v_pk_fma_f32 v[64:65], v[100:101], s[38:39], v[64:65] op_sel:[1,0,0] op_sel_hi:[1,1,1]
    v_mul_f32 v46, v19, v46
    v_mul_f32 v47, v19, v47
    v_mul_f32 v48, v19, v48
    v_mul_f32 v49, v19, v49
    v_cvt_pk_bf16_f32 v62, v62, v63
    v_and_b32 v63, 0xffff0000, v62
    v_lshlrev_b32 v62, 16, v62
    v_cvt_pk_bf16_f32 v64, v64, v65
    v_and_b32 v65, 0xffff0000, v64
    v_lshlrev_b32 v64, 16, v64
    s_cmp_lg_u32 s3, 0
    s_cbranch_scc1 L_k3_basisback
    v_lshlrev_b32 v89, 16, v89
    s_lshl_b32 s38, s72, 16
    s_and_b32 s39, s72, 0xffff0000
    v_pk_add_f32 v[94:95], v[88:89], s[38:39] op_sel:[1,0] op_sel_hi:[1,1] neg_lo:[0,1] neg_hi:[0,1]
    v_cvt_pk_bf16_f32 v94, v94, v95
    v_and_b32 v95, 0xffff0000, v94
    v_lshlrev_b32 v94, 16, v94
    v_mul_f32 v94, v94, v94
    v_mul_f32 v95, v95, v95
    v_cvt_pk_bf16_f32 v94, v94, v95
    v_and_b32 v95, 0xffff0000, v94
    v_lshlrev_b32 v94, 16, v94
    v_mul_f32 v94, 0xc1200000, v94
    v_mul_f32 v95, 0xc1200000, v95
    v_cvt_pk_bf16_f32 v94, v94, v95
    v_and_b32 v95, 0xffff0000, v94
    v_lshlrev_b32 v94, 16, v94
    v_mul_f32 v94, 0x3fb8aa3b, v94
    v_mul_f32 v95, 0x3fb8aa3b, v95
    v_exp_f32 v94, v94
    v_exp_f32 v95, v95
    s_nop 0
    v_cvt_pk_bf16_f32 v94, v94, v95
    v_and_b32 v95, 0xffff0000, v94
    v_lshlrev_b32 v94, 16, v94
    s_lshl_b32 s38, s73, 16
    s_and_b32 s39, s73, 0xffff0000
    v_pk_add_f32 v[96:97], v[88:89], s[38:39] op_sel:[1,0] op_sel_hi:[1,1] neg_lo:[0,1] neg_hi:[0,1]
    v_cvt_pk_bf16_f32 v96, v96, v97
    v_and_b32 v97, 0xffff0000, v96
    v_lshlrev_b32 v96, 16, v96
    v_mul_f32 v96, v96, v96
    v_mul_f32 v97, v97, v97
    v_cvt_pk_bf16_f32 v96, v96, v97
    v_and_b32 v97, 0xffff0000, v96
    v_lshlrev_b32 v96, 16, v96
    v_mul_f32 v96, 0xc1200000, v96
    v_mul_f32 v97, 0xc1200000, v97
    v_cvt_pk_bf16_f32 v96, v96, v97
    v_and_b32 v97, 0xffff0000, v96
    v_lshlrev_b32 v96, 16, v96
    v_mul_f32 v96, 0x3fb8aa3b, v96
    v_mul_f32 v97, 0x3fb8aa3b, v97
    v_exp_f32 v96, v96
    v_exp_f32 v97, v97
    s_nop 0
    v_cvt_pk_bf16_f32 v96, v96, v97
    v_and_b32 v97, 0xffff0000, v96
    v_lshlrev_b32 v96, 16, v96
    s_lshl_b32 s38, s74, 16
    s_and_b32 s39, s74, 0xffff0000
    v_pk_add_f32 v[98:99], v[88:89], s[38:39] op_sel:[1,0] op_sel_hi:[1,1] neg_lo:[0,1] neg_hi:[0,1]
    v_cvt_pk_bf16_f32 v98, v98, v99
    v_and_b32 v99, 0xffff0000, v98
    v_lshlrev_b32 v98, 16, v98
    v_mul_f32 v98, v98, v98
    v_mul_f32 v99, v99, v99
    v_cvt_pk_bf16_f32 v98, v98, v99
    v_and_b32 v99, 0xffff0000, v98
    v_lshlrev_b32 v98, 16, v98
    v_mul_f32 v98, 0xc1200000, v98
    v_mul_f32 v99, 0xc1200000, v99
    v_cvt_pk_bf16_f32 v98, v98, v99
    v_and_b32 v99, 0xffff0000, v98
    v_lshlrev_b32 v98, 16, v98
    v_mul_f32 v98, 0x3fb8aa3b, v98
    v_mul_f32 v99, 0x3fb8aa3b, v99
    v_exp_f32 v98, v98
    v_exp_f32 v99, v99
    s_nop 0
    v_cvt_pk_bf16_f32 v98, v98, v99
    v_and_b32 v99, 0xffff0000, v98
    v_lshlrev_b32 v98, 16, v98
    s_lshl_b32 s38, s75, 16
    s_and_b32 s39, s75, 0xffff0000
    v_pk_add_f32 v[100:101], v[88:89], s[38:39] op_sel:[1,0] op_sel_hi:[1,1] neg_lo:[0,1] neg_hi:[0,1]
    v_cvt_pk_bf16_f32 v100, v100, v101
    v_and_b32 v101, 0xffff0000, v100
    v_lshlrev_b32 v100, 16, v100
    v_mul_f32 v100, v100, v100
    v_mul_f32 v101, v101, v101
    v_cvt_pk_bf16_f32 v100, v100, v101
    v_and_b32 v101, 0xffff0000, v100
    v_lshlrev_b32 v100, 16, v100
    v_mul_f32 v100, 0xc1200000, v100
    v_mul_f32 v101, 0xc1200000, v101
    v_cvt_pk_bf16_f32 v100, v100, v101
    v_and_b32 v101, 0xffff0000, v100
    v_lshlrev_b32 v100, 16, v100
    v_mul_f32 v100, 0x3fb8aa3b, v100
    v_mul_f32 v101, 0x3fb8aa3b, v101
    v_exp_f32 v100, v100
    v_exp_f32 v101, v101
    s_nop 0
    v_cvt_pk_bf16_f32 v100, v100, v101
    v_and_b32 v101, 0xffff0000, v100
    v_lshlrev_b32 v100, 16, v100
    s_load_dwordx16 s[76:91], s[94:95], 0
    s_waitcnt lgkmcnt(0)
    s_lshl_b32 s38, s76, 16
    s_and_b32 s39, s76, 0xffff0000
    v_pk_mul_f32 v[50:51], v[94:95], s[38:39] op_sel:[0,0] op_sel_hi:[0,1]
    s_lshl_b32 s38, s77, 16
    s_and_b32 s39, s77, 0xffff0000
    v_pk_mul_f32 v[52:53], v[94:95], s[38:39] op_sel:[0,0] op_sel_hi:[0,1]
    s_lshl_b32 s38, s78, 16
    s_and_b32 s39, s78, 0xffff0000
    v_pk_fma_f32 v[50:51], v[94:95], s[38:39], v[50:51] op_sel:[1,0,0] op_sel_hi:[1,1,1]
    s_lshl_b32 s38, s79, 16
    s_and_b32 s39, s79, 0xffff0000
    v_pk_fma_f32 v[52:53], v[94:95], s[38:39], v[52:53] op_sel:[1,0,0] op_sel_hi:[1,1,1]
    s_lshl_b32 s38, s80, 16
    s_and_b32 s39, s80, 0xffff0000
    v_pk_fma_f32 v[50:51], v[96:97], s[38:39], v[50:51] op_sel:[0,0,0] op_sel_hi:[0,1,1]
    s_lshl_b32 s38, s81, 16
    s_and_b32 s39, s81, 0xffff0000
    v_pk_fma_f32 v[52:53], v[96:97], s[38:39], v[52:53] op_sel:[0,0,0] op_sel_hi:[0,1,1]
    s_lshl_b32 s38, s82, 16
    s_and_b32 s39, s82, 0xffff0000
    v_pk_fma_f32 v[50:51], v[96:97], s[38:39], v[50:51] op_sel:[1,0,0] op_sel_hi:[1,1,1]
    s_lshl_b32 s38, s83, 16
    s_and_b32 s39, s83, 0xffff0000
    v_pk_fma_f32 v[52:53], v[96:97], s[38:39], v[52:53] op_sel:[1,0,0] op_sel_hi:[1,1,1]
    s_lshl_b32 s38, s84, 16
    s_and_b32 s39, s84, 0xffff0000
    v_pk_fma_f32 v[50:51], v[98:99], s[38:39], v[50:51] op_sel:[0,0,0] op_sel_hi:[0,1,1]
    s_lshl_b32 s38, s85, 16
    s_and_b32 s39, s85, 0xffff0000
    v_pk_fma_f32 v[52:53], v[98:99], s[38:39], v[52:53] op_sel:[0,0,0] op_sel_hi:[0,1,1]
    s_lshl_b32 s38, s86, 16
    s_and_b32 s39, s86, 0xffff0000
    v_pk_fma_f32 v[50:51], v[98:99], s[38:39], v[50:51] op_sel:[1,0,0] op_sel_hi:[1,1,1]
    s_lshl_b32 s38, s87, 16
    s_and_b32 s39, s87, 0xffff0000
    v_pk_fma_f32 v[52:53], v[98:99], s[38:39], v[52:53] op_sel:[1,0,0] op_sel_hi:[1,1,1]
    s_lshl_b32 s38, s88, 16
    s_and_b32 s39, s88, 0xffff0000
    v_pk_fma_f32 v[50:51], v[100:101], s[38:39], v[50:51] op_sel:[0,0,0] op_sel_hi:[0,1,1]
    s_lshl_b32 s38, s89, 16
    s_and_b32 s39, s89, 0xffff0000
    v_pk_fma_f32 v[52:53], v[100:101], s[38:39], v[52:53] op_sel:[0,0,0] op_sel_hi:[0,1,1]
    s_lshl_b32 s38, s90, 16
    s_and_b32 s39, s90, 0xffff0000
    v_pk_fma_f32 v[50:51], v[100:101], s[38:39], v[50:51] op_sel:[1,0,0] op_sel_hi:[1,1,1]
    s_lshl_b32 s38, s91, 16
    s_and_b32 s39, s91, 0xffff0000
    v_pk_fma_f32 v[52:53], v[100:101], s[38:39], v[52:53] op_sel:[1,0,0] op_sel_hi:[1,1,1]
    s_load_dwordx16 s[76:91], s[92:93], 0
    s_waitcnt lgkmcnt(0)
    s_lshl_b32 s38, s76, 16
    s_and_b32 s39, s76, 0xffff0000
    v_pk_mul_f32 v[66:67], v[94:95], s[38:39] op_sel:[0,0] op_sel_hi:[0,1]
    s_lshl_b32 s38, s77, 16
    s_and_b32 s39, s77, 0xffff0000
    v_pk_mul_f32 v[68:69], v[94:95], s[38:39] op_sel:[0,0] op_sel_hi:[0,1]
    s_lshl_b32 s38, s78, 16
    s_and_b32 s39, s78, 0xffff0000
    v_pk_fma_f32 v[66:67], v[94:95], s[38:39], v[66:67] op_sel:[1,0,0] op_sel_hi:[1,1,1]
    s_lshl_b32 s38, s79, 16
    s_and_b32 s39, s79, 0xffff0000
    v_pk_fma_f32 v[68:69], v[94:95], s[38:39], v[68:69] op_sel:[1,0,0] op_sel_hi:[1,1,1]
    s_lshl_b32 s38, s80, 16
    s_and_b32 s39, s80, 0xffff0000
    v_pk_fma_f32 v[66:67], v[96:97], s[38:39], v[66:67] op_sel:[0,0,0] op_sel_hi:[0,1,1]
    s_lshl_b32 s38, s81, 16
    s_and_b32 s39, s81, 0xffff0000
    v_pk_fma_f32 v[68:69], v[96:97], s[38:39], v[68:69] op_sel:[0,0,0] op_sel_hi:[0,1,1]
    s_lshl_b32 s38, s82, 16
    s_and_b32 s39, s82, 0xffff0000
    v_pk_fma_f32 v[66:67], v[96:97], s[38:39], v[66:67] op_sel:[1,0,0] op_sel_hi:[1,1,1]
    s_lshl_b32 s38, s83, 16
    s_and_b32 s39, s83, 0xffff0000
    v_pk_fma_f32 v[68:69], v[96:97], s[38:39], v[68:69] op_sel:[1,0,0] op_sel_hi:[1,1,1]
    s_lshl_b32 s38, s84, 16
    s_and_b32 s39, s84, 0xffff0000
    v_pk_fma_f32 v[66:67], v[98:99], s[38:39], v[66:67] op_sel:[0,0,0] op_sel_hi:[0,1,1]
    s_lshl_b32 s38, s85, 16
    s_and_b32 s39, s85, 0xffff0000
    v_pk_fma_f32 v[68:69], v[98:99], s[38:39], v[68:69] op_sel:[0,0,0] op_sel_hi:[0,1,1]
    s_lshl_b32 s38, s86, 16
    s_and_b32 s39, s86, 0xffff0000
    v_pk_fma_f32 v[66:67], v[98:99], s[38:39], v[66:67] op_sel:[1,0,0] op_sel_hi:[1,1,1]
    s_lshl_b32 s38, s87, 16
    s_and_b32 s39, s87, 0xffff0000
    v_pk_fma_f32 v[68:69], v[98:99], s[38:39], v[68:69] op_sel:[1,0,0] op_sel_hi:[1,1,1]
    s_lshl_b32 s38, s88, 16
    s_and_b32 s39, s88, 0xffff0000
    v_pk_fma_f32 v[66:67], v[100:101], s[38:39], v[66:67] op_sel:[0,0,0] op_sel_hi:[0,1,1]
    s_lshl_b32 s38, s89, 16
    s_and_b32 s39, s89, 0xffff0000
    v_pk_fma_f32 v[68:69], v[100:101], s[38:39], v[68:69] op_sel:[0,0,0] op_sel_hi:[0,1,1]
    s_lshl_b32 s38, s90, 16
    s_and_b32 s39, s90, 0xffff0000
    v_pk_fma_f32 v[66:67], v[100:101], s[38:39], v[66:67] op_sel:[1,0,0] op_sel_hi:[1,1,1]
    s_lshl_b32 s38, s91, 16
    s_and_b32 s39, s91, 0xffff0000
    v_pk_fma_f32 v[68:69], v[100:101], s[38:39], v[68:69] op_sel:[1,0,0] op_sel_hi:[1,1,1]
    v_mul_f32 v50, v19, v50
    v_mul_f32 v51, v19, v51
    v_mul_f32 v52, v19, v52
    v_mul_f32 v53, v19, v53
    v_cvt_pk_bf16_f32 v66, v66, v67
    v_and_b32 v67, 0xffff0000, v66
    v_lshlrev_b32 v66, 16, v66
    v_cvt_pk_bf16_f32 v68, v68, v69
    v_and_b32 v69, 0xffff0000, v68
    v_lshlrev_b32 v68, 16, v68
    s_branch L_k3_basisback
L_k3_end:
    s_endpgm
L_pr_346:
    s_cmp_lg_u32 s5, 0
    s_cbranch_scc1 L_pe_347
    s_mov_b64 exec, -1
    v_add_u32 v3, 63, v3
    v_subrev_u32 v4, 63, v4
    v_max_i32 v4, 0, v4
    v_cmp_eq_u32 vcc, 0, v4
    s_nop 1
    v_cndmask_b32 v3, v3, v5, vcc
    v_cndmask_b32 v4, v4, v6, vcc
    v_cndmask_b32 v6, v6, 0, vcc
    v_min_u32 v18, 63, v4
    v_cmp_lt_u32 s[24:25], 0, v4
    v_lshl_or_b32 v7, v3, 6, v18
    s_nop 3
    s_cmp_eq_u64 s[24:25], 0
    s_cbranch_scc0 L_pb_345
    s_mov_b32 s5, 1
L_pe_347:
    s_mov_b32 s40, 0
    s_mov_b64 exec, 0
    s_branch L_pi_348
L_pr_350:
    s_cmp_lg_u32 s5, 0
    s_cbranch_scc1 L_pe_351
    s_mov_b64 exec, -1
    v_add_u32 v3, 63, v3
    v_subrev_u32 v4, 63, v4
    v_max_i32 v4, 0, v4
    v_cmp_eq_u32 vcc, 0, v4
    s_nop 1
    v_cndmask_b32 v3, v3, v5, vcc
    v_cndmask_b32 v4, v4, v6, vcc
    v_cndmask_b32 v6, v6, 0, vcc
    v_min_u32 v18, 63, v4
    v_cmp_lt_u32 s[24:25], 0, v4
    v_lshl_or_b32 v7, v3, 6, v18
    s_nop 3
    s_cmp_eq_u64 s[24:25], 0
    s_cbranch_scc0 L_pb_349
    s_mov_b32 s5, 1
L_pe_351:
    s_mov_b32 s41, 0
    s_mov_b64 exec, 0
    s_branch L_pi_352
L_pr_354:
    s_cmp_lg_u32 s5, 0
    s_cbranch_scc1 L_pe_355
    s_mov_b64 exec, -1
    v_add_u32 v3, 63, v3
    v_subrev_u32 v4, 63, v4
    v_max_i32 v4, 0, v4
    v_cmp_eq_u32 vcc, 0, v4
    s_nop 1
    v_cndmask_b32 v3, v3, v5, vcc
    v_cndmask_b32 v4, v4, v6, vcc
    v_cndmask_b32 v6, v6, 0, vcc
    v_min_u32 v18, 63, v4
    v_cmp_lt_u32 s[24:25], 0, v4
    v_lshl_or_b32 v7, v3, 6, v18
    s_nop 3
    s_cmp_eq_u64 s[24:25], 0
    s_cbranch_scc0 L_pb_353
    s_mov_b32 s5, 1
L_pe_355:
    s_mov_b32 s42, 0
    s_mov_b64 exec, 0
    s_branch L_pi_356
L_pr_358:
    s_cmp_lg_u32 s5, 0
    s_cbranch_scc1 L_pe_359
    s_mov_b64 exec, -1
    v_add_u32 v3, 63, v3
    v_subrev_u32 v4, 63, v4
    v_max_i32 v4, 0, v4
    v_cmp_eq_u32 vcc, 0, v4
    s_nop 1
    v_cndmask_b32 v3, v3, v5, vcc
    v_cndmask_b32 v4, v4, v6, vcc
    v_cndmask_b32 v6, v6, 0, vcc
    v_min_u32 v18, 63, v4
    v_cmp_lt_u32 s[24:25], 0, v4
    v_lshl_or_b32 v7, v3, 6, v18
    s_nop 3
    s_cmp_eq_u64 s[24:25], 0
    s_cbranch_scc0 L_pb_357
    s_mov_b32 s5, 1
L_pe_359:
    s_mov_b32 s43, 0
    s_mov_b64 exec, 0
    s_branch L_pi_360
L_pr_362:
    s_cmp_lg_u32 s5, 0
    s_cbranch_scc1 L_pe_363
    s_mov_b64 exec, -1
    v_add_u32 v3, 63, v3
    v_subrev_u32 v4, 63, v4
    v_max_i32 v4, 0, v4
    v_cmp_eq_u32 vcc, 0, v4
    s_nop 1
    v_cndmask_b32 v3, v3, v5, vcc
    v_cndmask_b32 v4, v4, v6, vcc
    v_cndmask_b32 v6, v6, 0, vcc
    v_min_u32 v18, 63, v4
    v_cmp_lt_u32 s[24:25], 0, v4
    v_lshl_or_b32 v7, v3, 6, v18
    s_nop 3
    s_cmp_eq_u64 s[24:25], 0
    s_cbranch_scc0 L_pb_361
    s_mov_b32 s5, 1
L_pe_363:
    s_mov_b32 s44, 0
    s_mov_b64 exec, 0
    s_branch L_pi_364
L_pr_366:
    s_cmp_lg_u32 s5, 0
    s_cbranch_scc1 L_pe_367
    s_mov_b64 exec, -1
    v_add_u32 v3, 63, v3
    v_subrev_u32 v4, 63, v4
    v_max_i32 v4, 0, v4
    v_cmp_eq_u32 vcc, 0, v4
    s_nop 1
    v_cndmask_b32 v3, v3, v5, vcc
    v_cndmask_b32 v4, v4, v6, vcc
    v_cndmask_b32 v6, v6, 0, vcc
    v_min_u32 v18, 63, v4
    v_cmp_lt_u32 s[24:25], 0, v4
    v_lshl_or_b32 v7, v3, 6, v18
    s_nop 3
    s_cmp_eq_u64 s[24:25], 0
    s_cbranch_scc0 L_pb_365
    s_mov_b32 s5, 1
L_pe_367:
    s_mov_b32 s40, 0
    s_mov_b64 exec, 0
    s_branch L_pi_368
L_pr_370:
    s_cmp_lg_u32 s5, 0
    s_cbranch_scc1 L_pe_371
    s_mov_b64 exec, -1
    v_add_u32 v3, 63, v3
    v_subrev_u32 v4, 63, v4
    v_max_i32 v4, 0, v4
    v_cmp_eq_u32 vcc, 0, v4
    s_nop 1
    v_cndmask_b32 v3, v3, v5, vcc
    v_cndmask_b32 v4, v4, v6, vcc
    v_cndmask_b32 v6, v6, 0, vcc
    v_min_u32 v18, 63, v4
    v_cmp_lt_u32 s[24:25], 0, v4
    v_lshl_or_b32 v7, v3, 6, v18
    s_nop 3
    s_cmp_eq_u64 s[24:25], 0
    s_cbranch_scc0 L_pb_369
    s_mov_b32 s5, 1
L_pe_371:
    s_mov_b32 s41, 0
    s_mov_b64 exec, 0
    s_branch L_pi_372
L_pr_374:
    s_cmp_lg_u32 s5, 0
    s_cbranch_scc1 L_pe_375
    s_mov_b64 exec, -1
    v_add_u32 v3, 63, v3
    v_subrev_u32 v4, 63, v4
    v_max_i32 v4, 0, v4
    v_cmp_eq_u32 vcc, 0, v4
    s_nop 1
    v_cndmask_b32 v3, v3, v5, vcc
    v_cndmask_b32 v4, v4, v6, vcc
    v_cndmask_b32 v6, v6, 0, vcc
    v_min_u32 v18, 63, v4
    v_cmp_lt_u32 s[24:25], 0, v4
    v_lshl_or_b32 v7, v3, 6, v18
    s_nop 3
    s_cmp_eq_u64 s[24:25], 0
    s_cbranch_scc0 L_pb_373
    s_mov_b32 s5, 1
L_pe_375:
    s_mov_b32 s42, 0
    s_mov_b64 exec, 0
    s_branch L_pi_376
L_pr_378:
    s_cmp_lg_u32 s5, 0
    s_cbranch_scc1 L_pe_379
    s_mov_b64 exec, -1
    v_add_u32 v3, 63, v3
    v_subrev_u32 v4, 63, v4
    v_max_i32 v4, 0, v4
    v_cmp_eq_u32 vcc, 0, v4
    s_nop 1
    v_cndmask_b32 v3, v3, v5, vcc
    v_cndmask_b32 v4, v4, v6, vcc
    v_cndmask_b32 v6, v6, 0, vcc
    v_min_u32 v18, 63, v4
    v_cmp_lt_u32 s[24:25], 0, v4
    v_lshl_or_b32 v7, v3, 6, v18
    s_nop 3
    s_cmp_eq_u64 s[24:25], 0
    s_cbranch_scc0 L_pb_377
    s_mov_b32 s5, 1
L_pe_379:
    s_mov_b32 s43, 0
    s_mov_b64 exec, 0
    s_branch L_pi_380
L_pr_382:
    s_cmp_lg_u32 s5, 0
    s_cbranch_scc1 L_pe_383
    s_mov_b64 exec, -1
    v_add_u32 v3, 63, v3
    v_subrev_u32 v4, 63, v4
    v_max_i32 v4, 0, v4
    v_cmp_eq_u32 vcc, 0, v4
    s_nop 1
    v_cndmask_b32 v3, v3, v5, vcc
    v_cndmask_b32 v4, v4, v6, vcc
    v_cndmask_b32 v6, v6, 0, vcc
    v_min_u32 v18, 63, v4
    v_cmp_lt_u32 s[24:25], 0, v4
    v_lshl_or_b32 v7, v3, 6, v18
    s_nop 3
    s_cmp_eq_u64 s[24:25], 0
    s_cbranch_scc0 L_pb_381
    s_mov_b32 s5, 1
L_pe_383:
    s_mov_b32 s44, 0
    s_mov_b64 exec, 0
    s_branch L_pi_384
L_pr_389:
    s_cmp_lg_u32 s5, 0
    s_cbranch_scc1 L_pe_390
    s_mov_b64 exec, -1
    v_add_u32 v3, 63, v3
    v_subrev_u32 v4, 63, v4
    v_max_i32 v4, 0, v4
    v_cmp_eq_u32 vcc, 0, v4
    s_nop 1
    v_cndmask_b32 v3, v3, v5, vcc
    v_cndmask_b32 v4, v4, v6, vcc
    v_cndmask_b32 v6, v6, 0, vcc
    v_min_u32 v18, 63, v4
    v_cmp_lt_u32 s[24:25], 0, v4
    v_lshl_or_b32 v7, v3, 6, v18
    s_nop 3
    s_cmp_eq_u64 s[24:25], 0
    s_cbranch_scc0 L_pb_388
    s_mov_b32 s5, 1
L_pe_390:
    s_mov_b32 s40, 0
    s_mov_b64 exec, 0
    s_branch L_pi_391
L_pr_393:
    s_cmp_lg_u32 s5, 0
    s_cbranch_scc1 L_pe_394
    s_mov_b64 exec, -1
    v_add_u32 v3, 63, v3
    v_subrev_u32 v4, 63, v4
    v_max_i32 v4, 0, v4
    v_cmp_eq_u32 vcc, 0, v4
    s_nop 1
    v_cndmask_b32 v3, v3, v5, vcc
    v_cndmask_b32 v4, v4, v6, vcc
    v_cndmask_b32 v6, v6, 0, vcc
    v_min_u32 v18, 63, v4
    v_cmp_lt_u32 s[24:25], 0, v4
    v_lshl_or_b32 v7, v3, 6, v18
    s_nop 3
    s_cmp_eq_u64 s[24:25], 0
    s_cbranch_scc0 L_pb_392
    s_mov_b32 s5, 1
L_pe_394:
    s_mov_b32 s41, 0
    s_mov_b64 exec, 0
    s_branch L_pi_395
L_pr_397:
    s_cmp_lg_u32 s5, 0
    s_cbranch_scc1 L_pe_398
    s_mov_b64 exec, -1
    v_add_u32 v3, 63, v3
    v_subrev_u32 v4, 63, v4
    v_max_i32 v4, 0, v4
    v_cmp_eq_u32 vcc, 0, v4
    s_nop 1
    v_cndmask_b32 v3, v3, v5, vcc
    v_cndmask_b32 v4, v4, v6, vcc
    v_cndmask_b32 v6, v6, 0, vcc
    v_min_u32 v18, 63, v4
    v_cmp_lt_u32 s[24:25], 0, v4
    v_lshl_or_b32 v7, v3, 6, v18
    s_nop 3
    s_cmp_eq_u64 s[24:25], 0
    s_cbranch_scc0 L_pb_396
    s_mov_b32 s5, 1
L_pe_398:
    s_mov_b32 s42, 0
    s_mov_b64 exec, 0
    s_branch L_pi_399
L_pr_401:
    s_cmp_lg_u32 s5, 0
    s_cbranch_scc1 L_pe_402
    s_mov_b64 exec, -1
    v_add_u32 v3, 63, v3
    v_subrev_u32 v4, 63, v4
    v_max_i32 v4, 0, v4
    v_cmp_eq_u32 vcc, 0, v4
    s_nop 1
    v_cndmask_b32 v3, v3, v5, vcc
    v_cndmask_b32 v4, v4, v6, vcc
    v_cndmask_b32 v6, v6, 0, vcc
    v_min_u32 v18, 63, v4
    v_cmp_lt_u32 s[24:25], 0, v4
    v_lshl_or_b32 v7, v3, 6, v18
    s_nop 3
    s_cmp_eq_u64 s[24:25], 0
    s_cbranch_scc0 L_pb_400
    s_mov_b32 s5, 1
L_pe_402:
    s_mov_b32 s43, 0
    s_mov_b64 exec, 0
    s_branch L_pi_403
L_pr_405:
    s_cmp_lg_u32 s5, 0
    s_cbranch_scc1 L_pe_406
    s_mov_b64 exec, -1
    v_add_u32 v3, 63, v3
    v_subrev_u32 v4, 63, v4
    v_max_i32 v4, 0, v4
    v_cmp_eq_u32 vcc, 0, v4
    s_nop 1
    v_cndmask_b32 v3, v3, v5, vcc
    v_cndmask_b32 v4, v4, v6, vcc
    v_cndmask_b32 v6, v6, 0, vcc
    v_min_u32 v18, 63, v4
    v_cmp_lt_u32 s[24:25], 0, v4
    v_lshl_or_b32 v7, v3, 6, v18
    s_nop 3
    s_cmp_eq_u64 s[24:25], 0
    s_cbranch_scc0 L_pb_404
    s_mov_b32 s5, 1
L_pe_406:
    s_mov_b32 s44, 0
    s_mov_b64 exec, 0
    s_branch L_pi_407
L_k3_next:
    v_add_lshl_u32 v10, s32, v0, 2
    v_add_lshl_u32 v11, s32, v8, 2
    s_mul_i32 s26, s4, 65664
    s_add_u32 s26, s26, 81364992
    s_mov_b32 s27, 81299456
    buffer_load_dword v4, v10, s[8:11], s26 offen
    buffer_load_dword v3, v10, s[8:11], s27 offen
    buffer_load_dword v6, v11, s[8:11], s26 offen
    buffer_load_dword v5, v11, s[8:11], s27 offen
    s_waitcnt vmcnt(0)
    v_add_u32 v10, s32, v0
    v_add_u32 v11, s32, v8
    v_cmp_gt_u32 vcc, s31, v10
    v_cmp_gt_u32 s[24:25], s31, v11
    s_mov_b32 s5, 0
    s_nop 0
    v_cndmask_b32 v4, 0, v4, vcc
    v_cndmask_b32 v6, 0, v6, s[24:25]
    v_and_b32 v10, 0xffff, v4
    v_and_b32 v11, 0xffff, v6
    v_lshrrev_b32 v4, 16, v4
    v_lshrrev_b32 v6, 16, v6
    v_add_u32 v3, v3, v10
    v_add_u32 v5, v5, v11
    v_min_u32 v10, 63, v4
    v_cmp_lt_u32 s[24:25], 0, v4
    v_lshl_or_b32 v7, v3, 6, v10
    s_nop 3
    s_branch L_k3_prime
L_k3_full:
    s_mov_b64 exec, -1
    v_mov_b32 v10, 1
    ds_write_b32 v2, v10 offset:1024
    s_branch L_k3_join
L_pr_409:
    s_cmp_lg_u32 s5, 0
    s_cbranch_scc1 L_pe_410
    s_mov_b64 exec, -1
    v_add_u32 v3, 63, v3
    v_subrev_u32 v4, 63, v4
    v_max_i32 v4, 0, v4
    v_cmp_eq_u32 vcc, 0, v4
    s_nop 1
    v_cndmask_b32 v3, v3, v5, vcc
    v_cndmask_b32 v4, v4, v6, vcc
    v_cndmask_b32 v6, v6, 0, vcc
    v_min_u32 v18, 63, v4
    v_cmp_lt_u32 s[24:25], 0, v4
    v_lshl_or_b32 v7, v3, 6, v18
    s_nop 3
    s_cmp_eq_u64 s[24:25], 0
    s_cbranch_scc0 L_pb_408
    s_mov_b32 s5, 1
L_pe_410:
    s_mov_b32 s40, 0
    s_mov_b64 exec, 0
    s_branch L_pi_411
L_pr_413:
    s_cmp_lg_u32 s5, 0
    s_cbranch_scc1 L_pe_414
    s_mov_b64 exec, -1
    v_add_u32 v3, 63, v3
    v_subrev_u32 v4, 63, v4
    v_max_i32 v4, 0, v4
    v_cmp_eq_u32 vcc, 0, v4
    s_nop 1
    v_cndmask_b32 v3, v3, v5, vcc
    v_cndmask_b32 v4, v4, v6, vcc
    v_cndmask_b32 v6, v6, 0, vcc
    v_min_u32 v18, 63, v4
    v_cmp_lt_u32 s[24:25], 0, v4
    v_lshl_or_b32 v7, v3, 6, v18
    s_nop 3
    s_cmp_eq_u64 s[24:25], 0
    s_cbranch_scc0 L_pb_412
    s_mov_b32 s5, 1
L_pe_414:
    s_mov_b32 s41, 0
    s_mov_b64 exec, 0
    s_branch L_pi_415
L_pr_417:
    s_cmp_lg_u32 s5, 0
    s_cbranch_scc1 L_pe_418
    s_mov_b64 exec, -1
    v_add_u32 v3, 63, v3
    v_subrev_u32 v4, 63, v4
    v_max_i32 v4, 0, v4
    v_cmp_eq_u32 vcc, 0, v4
    s_nop 1
    v_cndmask_b32 v3, v3, v5, vcc
    v_cndmask_b32 v4, v4, v6, vcc
    v_cndmask_b32 v6, v6, 0, vcc
    v_min_u32 v18, 63, v4
    v_cmp_lt_u32 s[24:25], 0, v4
    v_lshl_or_b32 v7, v3, 6, v18
    s_nop 3
    s_cmp_eq_u64 s[24:25], 0
    s_cbranch_scc0 L_pb_416
    s_mov_b32 s5, 1
L_pe_418:
    s_mov_b32 s42, 0
    s_mov_b64 exec, 0
    s_branch L_pi_419
L_pr_421:
    s_cmp_lg_u32 s5, 0
    s_cbranch_scc1 L_pe_422
    s_mov_b64 exec, -1
    v_add_u32 v3, 63, v3
    v_subrev_u32 v4, 63, v4
    v_max_i32 v4, 0, v4
    v_cmp_eq_u32 vcc, 0, v4
    s_nop 1
    v_cndmask_b32 v3, v3, v5, vcc
    v_cndmask_b32 v4, v4, v6, vcc
    v_cndmask_b32 v6, v6, 0, vcc
    v_min_u32 v18, 63, v4
    v_cmp_lt_u32 s[24:25], 0, v4
    v_lshl_or_b32 v7, v3, 6, v18
    s_nop 3
    s_cmp_eq_u64 s[24:25], 0
    s_cbranch_scc0 L_pb_420
    s_mov_b32 s5, 1
L_pe_422:
    s_mov_b32 s43, 0
    s_mov_b64 exec, 0
    s_branch L_pi_423
L_pr_425:
    s_cmp_lg_u32 s5, 0
    s_cbranch_scc1 L_pe_426
    s_mov_b64 exec, -1
    v_add_u32 v3, 63, v3
    v_subrev_u32 v4, 63, v4
    v_max_i32 v4, 0, v4
    v_cmp_eq_u32 vcc, 0, v4
    s_nop 1
    v_cndmask_b32 v3, v3, v5, vcc
    v_cndmask_b32 v4, v4, v6, vcc
    v_cndmask_b32 v6, v6, 0, vcc
    v_min_u32 v18, 63, v4
    v_cmp_lt_u32 s[24:25], 0, v4
    v_lshl_or_b32 v7, v3, 6, v18
    s_nop 3
    s_cmp_eq_u64 s[24:25], 0
    s_cbranch_scc0 L_pb_424
    s_mov_b32 s5, 1
L_pe_426:
    s_mov_b32 s44, 0
    s_mov_b64 exec, 0
    s_branch L_pi_427
L_text_end:
.section .rodata,"a"
.p2align 6
.amdhsa_kernel part_in_kernel
  .amdhsa_next_free_vgpr 119
  .amdhsa_next_free_sgpr 56
  .amdhsa_accum_offset 120
  .amdhsa_group_segment_fixed_size 0
  .amdhsa_kernarg_size 112
  .amdhsa_user_sgpr_count 2
  .amdhsa_user_sgpr_kernarg_segment_ptr 1
  .amdhsa_system_sgpr_workgroup_id_x 1
  .amdhsa_float_denorm_mode_32 3
.end_amdhsa_kernel
.p2align 6
.amdhsa_kernel gather_part_kernel
  .amdhsa_next_free_vgpr 118
  .amdhsa_next_free_sgpr 80
  .amdhsa_accum_offset 120
  .amdhsa_group_segment_fixed_size 0
  .amdhsa_kernarg_size 112
  .amdhsa_user_sgpr_count 2
  .amdhsa_user_sgpr_kernarg_segment_ptr 1
  .amdhsa_system_sgpr_workgroup_id_x 1
  .amdhsa_float_denorm_mode_32 3
.end_amdhsa_kernel
.p2align 6
.amdhsa_kernel accum_out_kernel
  .amdhsa_next_free_vgpr 111
  .amdhsa_next_free_sgpr 96
  .amdhsa_accum_offset 112
  .amdhsa_group_segment_fixed_size 0
  .amdhsa_kernarg_size 112
  .amdhsa_user_sgpr_count 2
  .amdhsa_user_sgpr_kernarg_segment_ptr 1
  .amdhsa_system_sgpr_workgroup_id_x 1
  .amdhsa_float_denorm_mode_32 3
.end_amdhsa_kernel
```
